```python
import torch

def _softmax(x, axis=-1):
    return torch.softmax(x, dim=axis)
def _gelu(x):
    return torch.nn.functional.gelu(x, approximate="tanh")
def _silu(x):
    return torch.nn.functional.silu(x)
def _sigmoid(x):
    return torch.sigmoid(x)
def _layernorm(x, axis=-1, eps=1e-5):
    m = x.mean(dim=axis, keepdim=True)
    v = x.var(dim=axis, keepdim=True, unbiased=False)
    return (x - m) / torch.sqrt(v + eps)
def _scatter_add(tgt, idx, src, axis=0):
    return tgt.clone().index_add_(axis, idx, src)
def _segment_sum(src, seg, n):
    out = torch.zeros((n,) + src.shape[1:], dtype=src.dtype)
    return out.index_add_(0, seg, src)
def _pad(x, pw):
    flat = tuple(v for pair in reversed(pw) for v in pair)
    return torch.nn.functional.pad(x, flat)

kernel_name = 'parallel_sum__ssm_conv_h3__swiglu_ffn__prompt'

def setup_inputs():

    _w = (lambda a: (lambda t: t.to(torch.bfloat16) if t.is_floating_point() else t)(torch.as_tensor(a)))
    def _A_setup():
        B, S, D = 1, 2048, 640
        ks = 4
        return {
            "q": _w((lambda *s: torch.randn(*s, dtype=torch.bfloat16) * 0.05)(B, S, D)),
            "k": _w((lambda *s: torch.randn(*s, dtype=torch.bfloat16) * 0.8)(B, S, D)),
            "v": _w((lambda *s: torch.randn(*s, dtype=torch.bfloat16) * 0.4)(B, S, D)),
            "shift_k": _w((lambda *s: torch.randn(*s, dtype=torch.bfloat16) * 0.8)(D, ks) * 0.5),
            "ssm_k": _w((lambda *s: torch.randn(*s, dtype=torch.bfloat16) * 0.8)(D, S) * (1.0 / S ** 0.5)),
            "ssm_D": _w((lambda *s: torch.randn(*s, dtype=torch.bfloat16) * 0.4)(D)),
        }
    _A_in = _A_setup()

    def _B_setup():
        B, S, D, F = 1, 2048, 640, 1536
        return {
            "x": _w((lambda *s: torch.randn(*s, dtype=torch.bfloat16) * 0.05)(B, S, D)),
            "w_gate": _w((lambda *s: torch.randn(*s, dtype=torch.bfloat16) * 0.05)(D, F)),
            "w_up": _w((lambda *s: torch.randn(*s, dtype=torch.bfloat16) * 0.05)(D, F)),
            "w_down": _w((lambda *s: torch.randn(*s, dtype=torch.bfloat16) * 0.05)(F, D)),
        }
    _B_in = _B_setup()

    return {
        "A_q": _A_in["q"],
        "A_k": _A_in["k"],
        "A_v": _A_in["v"],
        "A_shift_k": _A_in["shift_k"],
        "A_ssm_k": _A_in["ssm_k"],
        "A_ssm_D": _A_in["ssm_D"],
        "B_x": _B_in["x"],
        "B_w_gate": _B_in["w_gate"],
        "B_w_up": _B_in["w_up"],
        "B_w_down": _B_in["w_down"],
    }

def reference(A_q, A_k, A_v, A_shift_k, A_ssm_k, A_ssm_D, B_x, B_w_gate, B_w_up, B_w_down):
    def _A_ref(q, k, v, shift_k, ssm_k, ssm_D):
        B, S, D = q.shape
        ks = shift_k.shape[-1]
        k_pad = _pad(k, ((0, 0), (ks - 1, 0), (0, 0)))
        k_shift = torch.zeros_like(k)
        for t in range(ks):
            k_shift = k_shift + k_pad[:, t:t + S, :] * shift_k[:, ks - 1 - t][None, None, :]
        kv = k_shift * v
        L = 2 * S
        kv_pad = _pad(kv, ((0, 0), (0, S), (0, 0)))
        kf_pad = _pad(ssm_k, ((0, 0), (0, S)))
        kv_f = (lambda x, axes=(-2,-1): torch.fft.rfft2(x.float(), dim=axes))(kv_pad[:, None, :, :], axes=(1, 2))
        kf_f = (lambda x, axes=(-2,-1): torch.fft.rfft2(x.float(), dim=axes))(kf_pad[:, None, :], axes=(1, 2))
        kf_f = (lambda x, *d: x.permute(*d))(kf_f, 1, 2, 0)
        y_f = kv_f * kf_f[None, :, :, :]
        y = (lambda x, s, axes=(-2,-1): torch.fft.irfft2(x, s=s, dim=axes).to(torch.bfloat16))(y_f, (1, L), axes=(1, 2))[:, 0, :S, :]
        y = y + kv * ssm_D[None, None, :]
        return q * y

    def _B_ref(x, w_gate, w_up, w_down):
        g = _silu(x @ w_gate)
        u = x @ w_up
        return (g * u) @ w_down

    x = A_q
    xn = _layernorm(x, axis=-1)
    return x + _A_ref(xn, A_k, A_v, A_shift_k, A_ssm_k, A_ssm_D) + _B_ref(xn, B_w_gate, B_w_up, B_w_down)
```

```asm
; @launch grid=(256,1,1) block=(512,1,1) lds=163840
.amdgcn_target "amdgcn-amd-amdhsa--gfx950"
.text
.globl parallel_sum__ssm_conv_h3__swiglu_ffn__prompt_kernel
.p2align 8
.type parallel_sum__ssm_conv_h3__swiglu_ffn__prompt_kernel,@function
parallel_sum__ssm_conv_h3__swiglu_ffn__prompt_kernel:
s_cmp_ge_u32 s2, 256
s_cbranch_scc1 L_end
s_load_dwordx2 s[4:5], s[0:1], 0
s_load_dwordx2 s[8:9], s[0:1], 56
s_load_dwordx2 s[12:13], s[0:1], 64
s_load_dwordx2 s[16:17], s[0:1], 96
s_load_dwordx2 s[44:45], s[0:1], 88
v_lshrrev_b32 v1, 6, v0
s_and_b32 s54, s2, 7
v_readfirstlane_b32 s52, v1
s_lshr_b32 s55, s2, 3
s_and_b32 s63, s54, 1
s_lshr_b32 s64, s54, 1
s_and_b32 s53, s52, 3
s_or_b32 s65, s2, s52
s_cmp_lg_u32 s65, 0
s_cbranch_scc1 L_noclear
s_mov_b32 s18, 20971520
s_mov_b32 s19, 0x20000
s_mov_b32 s46, 256
s_mov_b32 s47, 0x20000
v_lshlrev_b32 v1, 7, v0
v_mov_b32 v2, 0
v_mov_b32 v3, 1
s_setprio 3
s_waitcnt lgkmcnt(0)
s_mov_b32 s65, 0
buffer_store_dword v2, v1, s[16:19], s65 offen sc1
s_mov_b32 s65, 8192
buffer_store_dword v2, v1, s[16:19], s65 offen sc1
s_mov_b32 s65, 16384
buffer_store_dword v2, v1, s[16:19], s65 offen sc1
s_mov_b32 s65, 24576
buffer_store_dword v2, v1, s[16:19], s65 offen sc1
s_mov_b32 s65, 32768
buffer_store_dword v2, v1, s[16:19], s65 offen sc1
s_waitcnt vmcnt(0)
s_mov_b64 exec, 1
buffer_store_dword v3, off, s[44:47], 0 sc1
s_mov_b64 exec, -1
L_noclear:
s_cmp_ge_u32 s52, 4
s_cbranch_scc1 L_nopf
s_getpc_b64 s[68:69]
L_pc:
s_lshl_b32 s65, s55, 11
v_lshl_add_u32 v1, v0, 3, s65
v_mov_b32 v3, s69
v_add_co_u32 v2, vcc, s68, v1
s_nop 1
v_addc_co_u32 v3, vcc, 0, v3, vcc
v_cmp_gt_u32 vcc, L_end-L_pc-4, v1
s_nop 0
s_and_saveexec_b64 s[86:87], vcc
s_cbranch_execz L_nopf
global_load_dwordx2 v[254:255], v[2:3], off
L_nopf:
s_mov_b64 exec, -1
v_and_b32 v0, 63, v0
s_cmp_ge_u32 s55, 30
s_cbranch_scc1 L_geo_b
s_mul_i32 s65, s55, 52
s_lshr_b32 s65, s65, 8
s_mul_i32 s64, s64, 6
s_add_u32 s64, s64, s65
s_sub_u32 s63, s63, s65
s_mul_i32 s63, s63, 5
s_add_u32 s63, s63, s55
s_mul_i32 s56, s63, 3
s_lshl_b32 s57, s64, 2
s_mul_i32 s64, s64, 3
s_add_u32 s63, s63, s64
s_mul_i32 s64, s63, 205
s_lshr_b32 s64, s64, 11
s_mul_i32 s64, s64, 10
s_sub_u32 s58, s63, s64
s_cmp_lt_u32 s52, 4
s_cbranch_scc1 L_roleA_a
s_setprio 1
v_lshrrev_b32 v20, 3, v0
v_mul_u32_u24 v20, 1280, v20
s_mul_i32 s63, s56, 81920
s_mul_i32 s64, s53, 61440
s_add_u32 s63, s63, s64
v_add_u32 v20, s63, v20
v_and_b32 v21, 7, v0
v_lshrrev_b32 v22, 4, v0
v_xor_b32 v21, v21, v22
v_lshl_add_u32 v1, v21, 4, v20
v_xor_b32 v2, 64, v1
v_add_u32 v2, 10240, v2
s_mul_i32 s86, s53, 6144
s_mul_i32 s87, s53, 4096
s_add_u32 s87, s87, 24576
v_bfe_u32 v20, v0, 2, 2
v_mul_u32_u24 v20, 3072, v20
v_and_b32 v21, 3, v0
v_lshl_add_u32 v20, v21, 4, v20
s_mul_i32 s63, s53, 49152
s_lshl_b32 s64, s57, 5
s_add_u32 s63, s63, s64
v_add_u32 v20, s63, v20
s_mov_b32 s6, 2621440
s_mov_b32 s7, 0x20000
s_mov_b32 s10, 1966080
s_mov_b32 s11, 0x20000
s_mov_b32 s14, 1966080
s_mov_b32 s15, 0x20000
s_waitcnt lgkmcnt(0)
s_lshl_b32 s88, s58, 7
s_mul_i32 s89, s58, 196608
s_add_u32 s58, s58, 1
s_cmp_eq_u32 s58, 10
s_cselect_b32 s58, 0, s58
s_add_u32 m0, s86, 0
s_nop 0
buffer_load_dwordx4 v1, s[4:7], s88 offen lds
s_add_u32 m0, s86, 1024
s_nop 0
buffer_load_dwordx4 v2, s[4:7], s88 offen lds
s_add_u32 m0, s86, 2048
s_add_u32 s88, s88, 20480
buffer_load_dwordx4 v1, s[4:7], s88 offen lds
s_add_u32 m0, s86, 3072
s_nop 0
buffer_load_dwordx4 v2, s[4:7], s88 offen lds
s_add_u32 m0, s86, 4096
s_add_u32 s88, s88, 20480
buffer_load_dwordx4 v1, s[4:7], s88 offen lds
s_add_u32 m0, s86, 5120
s_nop 0
buffer_load_dwordx4 v2, s[4:7], s88 offen lds
s_load_dwordx2 s[20:21], s[0:1], 8
s_load_dwordx2 s[24:25], s[0:1], 16
s_load_dwordx2 s[28:29], s[0:1], 24
s_load_dwordx2 s[32:33], s[0:1], 32
s_load_dwordx2 s[36:37], s[0:1], 40
s_load_dwordx2 s[40:41], s[0:1], 80
s_load_dwordx2 s[48:49], s[0:1], 72
v_add_u32 v21, 0, v22
v_lshrrev_b32 v23, 1, v21
v_mul_u32_u24 v24, 12160, v23
v_lshl_add_u32 v24, v21, 6, v24
v_add_u32 v5, v24, v20
v_and_b32 v23, 2, v23
v_lshlrev_b32 v23, 4, v23
v_xor_b32 v5, v23, v5
s_add_u32 m0, s87, 0
s_nop 0
buffer_load_dwordx4 v5, s[8:11], s89 offen lds
v_add_u32 v21, 4, v22
v_lshrrev_b32 v23, 1, v21
v_mul_u32_u24 v24, 12160, v23
v_lshl_add_u32 v24, v21, 6, v24
v_add_u32 v6, v24, v20
v_and_b32 v23, 2, v23
v_lshlrev_b32 v23, 4, v23
v_xor_b32 v6, v23, v6
s_add_u32 m0, s87, 1024
s_nop 0
buffer_load_dwordx4 v6, s[8:11], s89 offen lds
s_add_u32 m0, s87, 2048
s_nop 0
buffer_load_dwordx4 v5, s[12:15], s89 offen lds
s_add_u32 m0, s87, 3072
s_nop 0
buffer_load_dwordx4 v6, s[12:15], s89 offen lds
s_and_b32 s63, s54, 1
s_lshr_b32 s64, s54, 1
s_lshl2_add_u32 s66, s63, s64
s_lshl_b32 s61, s66, 5
s_add_u32 s61, s61, s55
s_bfe_u32 s64, s54, 0x10001
s_lshl1_add_u32 s63, s63, s64
s_and_b32 s64, s55, 7
s_lshl3_add_u32 s59, s63, s64
s_lshr_b32 s63, s54, 2
s_lshr_b32 s64, s55, 3
s_lshl2_add_u32 s60, s63, s64
s_mov_b32 s18, 20971520
s_mov_b32 s19, 0x20000
s_mov_b32 s22, 2621440
s_mov_b32 s23, 0x20000
s_mov_b32 s26, 2621440
s_mov_b32 s27, 0x20000
s_mov_b32 s30, 5120
s_mov_b32 s31, 0x20000
s_mov_b32 s34, 2621440
s_mov_b32 s35, 0x20000
s_mov_b32 s38, 1280
s_mov_b32 s39, 0x20000
s_mov_b32 s42, 2621440
s_mov_b32 s43, 0x20000
s_mov_b32 s46, 256
s_mov_b32 s47, 0x20000
s_mov_b32 s50, 1966080
s_mov_b32 s51, 0x20000
s_waitcnt lgkmcnt(0)
s_cmp_lt_u32 s55, 20
s_cselect_b32 s90, 3, 2
s_cmp_ge_u32 s53, s90
s_cbranch_scc1 L_pathW
s_mul_i32 s63, s55, 3
s_lshl1_add_u32 s64, s55, 20
s_min_u32 s63, s63, s64
s_mul_i32 s65, s54, 80
s_add_u32 s63, s63, s53
s_add_u32 s62, s63, s65
s_and_b32 s92, s62, 63
s_lshl_b32 s92, s92, 5
s_lshr_b32 s93, s62, 6
s_mul_i32 s91, s53, 8704
s_add_u32 s91, s91, 122880
v_lshrrev_b32 v150, 3, v0
v_mul_u32_u24 v150, 1280, v150
v_and_b32 v151, 7, v0
v_lshl_add_u32 v150, v151, 4, v150
s_mul_i32 s63, s92, 1280
s_lshl_b32 s64, s93, 7
s_add_u32 s63, s63, s64
v_add_u32 v152, s63, v150
v_subrev_u32 v150, 5120, v152
v_add_u32 v151, 5120, v152
s_lshl_b32 s64, s93, 9
v_lshl_add_u32 v153, v0, 3, s64
s_mov_b32 m0, s91
s_nop 0
buffer_load_dwordx4 v150, s[20:23], 0 offen nt lds
s_add_u32 m0, s91, 1024
s_mov_b32 s63, 0
buffer_load_dwordx4 v151, s[20:23], s63 offen nt lds
s_add_u32 m0, s91, 4608
s_mov_b32 s63, 0
buffer_load_dwordx4 v152, s[24:27], s63 offen nt lds
buffer_load_dwordx2 v[54:55], v153, s[28:31], 0 offen
s_add_u32 m0, s91, 2048
s_mov_b32 s63, 10240
buffer_load_dwordx4 v151, s[20:23], s63 offen nt lds
s_add_u32 m0, s91, 5632
s_mov_b32 s63, 10240
buffer_load_dwordx4 v152, s[24:27], s63 offen nt lds
s_add_u32 m0, s91, 3072
s_mov_b32 s63, 20480
buffer_load_dwordx4 v151, s[20:23], s63 offen nt lds
s_add_u32 m0, s91, 6656
s_mov_b32 s63, 20480
buffer_load_dwordx4 v152, s[24:27], s63 offen nt lds
s_add_u32 m0, s91, 4096
s_mov_b32 s63, 30720
s_mov_b32 exec_hi, 0
buffer_load_dwordx4 v151, s[20:23], s63 offen nt lds
s_mov_b32 exec_hi, -1
s_add_u32 m0, s91, 7680
s_mov_b32 s63, 30720
buffer_load_dwordx4 v152, s[24:27], s63 offen nt lds
s_lshl_b32 s63, s62, 12
v_lshl_add_u32 v176, v0, 4, s63
s_lshl_b32 s63, s62, 1
v_mov_b32 v19, s63
buffer_load_ushort v19, v19, s[36:39], 0 offen
buffer_load_dwordx4 v[160:163], v176, s[32:35], 0 offen offset:0 nt
buffer_load_dwordx4 v[164:167], v176, s[32:35], 0 offen offset:1024 nt
buffer_load_dwordx4 v[168:171], v176, s[32:35], 0 offen offset:2048 nt
buffer_load_dwordx4 v[172:175], v176, s[32:35], 0 offen offset:3072 nt
s_lshl_b32 s88, s58, 7
s_mul_i32 s89, s58, 196608
s_add_u32 s58, s58, 1
s_cmp_eq_u32 s58, 10
s_cselect_b32 s58, 0, s58
s_add_u32 m0, s86, 40960
s_nop 0
buffer_load_dwordx4 v1, s[4:7], s88 offen lds
v_mov_b32 v56, 162304
s_add_u32 m0, s86, 41984
s_nop 0
buffer_load_dwordx4 v2, s[4:7], s88 offen lds
v_mov_b32 v58, 0
s_add_u32 m0, s86, 43008
s_add_u32 s88, s88, 20480
buffer_load_dwordx4 v1, s[4:7], s88 offen lds
v_mov_b32 v59, 0
s_add_u32 m0, s86, 44032
s_nop 0
buffer_load_dwordx4 v2, s[4:7], s88 offen lds
ds_write_b64 v56, v[58:59] offset:0
s_add_u32 m0, s86, 45056
s_add_u32 s88, s88, 20480
buffer_load_dwordx4 v1, s[4:7], s88 offen lds
ds_write_b64 v56, v[58:59] offset:8
s_add_u32 m0, s86, 46080
s_nop 0
buffer_load_dwordx4 v2, s[4:7], s88 offen lds
ds_write_b64 v56, v[58:59] offset:16
s_add_u32 m0, s87, 40960
s_nop 0
buffer_load_dwordx4 v5, s[8:11], s89 offen lds
s_waitcnt lgkmcnt(0)
v_bfe_u32 v20, v0, 2, 2
v_lshrrev_b32 v21, 4, v0
v_lshlrev_b32 v21, 5, v21
v_lshl_add_u32 v20, v20, 7, v21
v_and_b32 v21, 3, v0
v_lshl_add_u32 v20, v21, 3, v20
v_add_u32 v154, s91, v20
v_lshrrev_b32 v22, 2, v0
v_mul_u32_u24 v22, 17408, v22
v_lshl_add_u32 v157, v21, 4, v22
s_mul_i32 s94, s93, 278528
s_lshl1_add_u32 s94, s92, s94
s_add_u32 s94, s94, 262144
s_waitcnt vmcnt(22)
s_barrier
s_add_u32 m0, s87, 41984
s_nop 0
buffer_load_dwordx4 v6, s[8:11], s89 offen lds
v_lshrrev_b32 v15, 5, v0
v_mul_u32_u24 v16, 4096, v15
v_bfe_u32 v14, v0, 4, 1
v_mul_u32_u24 v15, 1024, v14
v_add_u32 v16, v16, v15
v_bfe_u32 v15, v0, 2, 2
v_lshl_add_u32 v16, v15, 6, v16
v_and_b32 v15, 3, v0
v_lshl_add_u32 v16, v15, 3, v16
v_lshlrev_b32 v14, 5, v14
s_min_u32 s64, s53, 1
s_lshl_b32 s64, s64, 8
s_add_u32 s63, s64, 24576
s_add_u32 m0, s87, 43008
s_nop 0
buffer_load_dwordx4 v5, s[12:15], s89 offen lds
v_add3_u32 v12, v16, v14, s63
v_xor_b32 v13, 32, v12
s_lshl_b32 s63, s56, 5
s_add_u32 s63, s63, s57
s_lshl_b32 s63, s63, 7
s_add_u32 s63, s63, s64
s_add_u32 s63, s63, 57344
v_lshl_add_u32 v149, v0, 2, s63
s_mov_b32 s64, 0x3f803f80
ds_read_b64_tr_b16 v[60:61], v12 offset:0
ds_read_b64_tr_b16 v[62:63], v12 offset:512
ds_read_b64_tr_b16 v[64:65], v12 offset:8192
ds_read_b64_tr_b16 v[66:67], v12 offset:8704
s_add_u32 m0, s87, 44032
s_nop 0
buffer_load_dwordx4 v6, s[12:15], s89 offen lds
ds_read_b64_tr_b16 v[68:69], v12 offset:2048
ds_read_b64_tr_b16 v[70:71], v12 offset:2560
ds_read_b64_tr_b16 v[72:73], v12 offset:10240
ds_read_b64_tr_b16 v[74:75], v12 offset:10752
ds_read_b64_tr_b16 v[76:77], v13 offset:0
ds_read_b64_tr_b16 v[78:79], v13 offset:512
ds_read_b64_tr_b16 v[80:81], v13 offset:8192
ds_read_b64_tr_b16 v[82:83], v13 offset:8704
ds_read_b64_tr_b16 v[84:85], v13 offset:2048
ds_read_b64_tr_b16 v[86:87], v13 offset:2560
ds_read_b64_tr_b16 v[88:89], v13 offset:10240
ds_read_b64_tr_b16 v[90:91], v13 offset:10752
v_mov_b32 v14, 0
s_lshl_b32 s88, s58, 7
s_mul_i32 s89, s58, 196608
s_add_u32 s58, s58, 1
s_cmp_eq_u32 s58, 10
s_cselect_b32 s58, 0, s58
s_add_u32 m0, s86, 81920
s_nop 0
buffer_load_dwordx4 v1, s[4:7], s88 offen lds
v_mov_b32 v15, 0
v_mov_b32 v16, 0
v_mov_b32 v17, 0
s_waitcnt lgkmcnt(8)
v_dot2c_f32_bf16 v14, s64, v60
v_dot2c_f32_bf16 v15, s64, v68
v_dot2c_f32_bf16 v14, s64, v61
v_dot2c_f32_bf16 v15, s64, v69
v_dot2c_f32_bf16 v14, s64, v62
v_dot2c_f32_bf16 v15, s64, v70
v_dot2c_f32_bf16 v14, s64, v63
v_dot2c_f32_bf16 v15, s64, v71
v_dot2c_f32_bf16 v14, s64, v64
s_add_u32 m0, s86, 82944
s_nop 0
buffer_load_dwordx4 v2, s[4:7], s88 offen lds
v_dot2c_f32_bf16 v15, s64, v72
v_dot2c_f32_bf16 v14, s64, v65
v_dot2c_f32_bf16 v15, s64, v73
v_dot2c_f32_bf16 v14, s64, v66
v_dot2c_f32_bf16 v15, s64, v74
v_dot2c_f32_bf16 v14, s64, v67
v_dot2c_f32_bf16 v15, s64, v75
s_waitcnt lgkmcnt(0)
v_dot2c_f32_bf16 v16, s64, v76
v_dot2c_f32_bf16 v17, s64, v84
v_dot2c_f32_bf16 v16, s64, v77
v_dot2c_f32_bf16 v17, s64, v85
s_add_u32 m0, s86, 83968
s_add_u32 s88, s88, 20480
buffer_load_dwordx4 v1, s[4:7], s88 offen lds
v_dot2c_f32_bf16 v16, s64, v78
v_dot2c_f32_bf16 v17, s64, v86
v_dot2c_f32_bf16 v16, s64, v79
v_dot2c_f32_bf16 v17, s64, v87
v_dot2c_f32_bf16 v16, s64, v80
v_dot2c_f32_bf16 v17, s64, v88
v_dot2c_f32_bf16 v16, s64, v81
v_dot2c_f32_bf16 v17, s64, v89
v_dot2c_f32_bf16 v16, s64, v82
v_dot2c_f32_bf16 v17, s64, v90
v_dot2c_f32_bf16 v16, s64, v83
v_dot2c_f32_bf16 v17, s64, v91
s_nop 1
v_permlane32_swap_b32 v14, v16
s_add_u32 m0, s86, 84992
s_nop 0
buffer_load_dwordx4 v2, s[4:7], s88 offen lds
v_permlane32_swap_b32 v15, v17
v_add_f32 v14, v14, v16
v_add_f32 v15, v15, v17
s_nop 1
v_permlane16_swap_b32 v14, v15
v_add_f32 v148, v14, v15
s_waitcnt vmcnt(25)
ds_read_b64_tr_b16 v[60:61], v154 offset:0
ds_read_b64_tr_b16 v[62:63], v154 offset:512
ds_read_b64_tr_b16 v[64:65], v154 offset:1024
ds_read_b64_tr_b16 v[78:79], v154 offset:4608
ds_read_b64_tr_b16 v[80:81], v154 offset:5120
v_lshlrev_b32 v14, 16, v54
v_and_b32 v15, 0xffff0000, v54
s_add_u32 m0, s86, 86016
s_add_u32 s88, s88, 20480
buffer_load_dwordx4 v1, s[4:7], s88 offen lds
v_lshlrev_b32 v16, 16, v55
v_and_b32 v17, 0xffff0000, v55
s_waitcnt lgkmcnt(4)
v_lshlrev_b32 v96, 16, v60
v_and_b32 v97, 0xffff0000, v60
v_lshlrev_b32 v98, 16, v61
v_and_b32 v99, 0xffff0000, v61
s_waitcnt lgkmcnt(3)
v_lshlrev_b32 v100, 16, v62
v_and_b32 v101, 0xffff0000, v62
v_mul_f32 v20, v17, v97
v_mul_f32 v21, v17, v98
s_add_u32 m0, s86, 87040
s_nop 0
buffer_load_dwordx4 v2, s[4:7], s88 offen lds
v_fmac_f32 v20, v16, v98
v_fmac_f32 v21, v16, v99
v_fmac_f32 v20, v15, v99
v_fmac_f32 v21, v15, v100
v_fmac_f32 v20, v14, v100
v_fmac_f32 v21, v14, v101
s_waitcnt lgkmcnt(1)
v_lshlrev_b32 v22, 16, v78
v_and_b32 v23, 0xffff0000, v78
v_mul_f32 v20, v20, v22
v_mul_f32 v21, v21, v23
v_cvt_pk_bf16_f32 v132, v20, v21
s_add_u32 m0, s87, 81920
s_nop 0
buffer_load_dwordx4 v5, s[8:11], s89 offen lds
v_lshlrev_b32 v102, 16, v63
v_and_b32 v103, 0xffff0000, v63
v_mul_f32 v20, v17, v99
v_mul_f32 v21, v17, v100
v_fmac_f32 v20, v16, v100
v_fmac_f32 v21, v16, v101
v_fmac_f32 v20, v15, v101
v_fmac_f32 v21, v15, v102
v_fmac_f32 v20, v14, v102
v_fmac_f32 v21, v14, v103
v_lshlrev_b32 v22, 16, v79
s_add_u32 m0, s87, 82944
s_nop 0
buffer_load_dwordx4 v6, s[8:11], s89 offen lds
v_and_b32 v23, 0xffff0000, v79
v_mul_f32 v20, v20, v22
v_mul_f32 v21, v21, v23
v_cvt_pk_bf16_f32 v133, v20, v21
v_lshlrev_b32 v104, 16, v64
v_and_b32 v105, 0xffff0000, v64
v_mul_f32 v20, v17, v101
v_mul_f32 v21, v17, v102
v_fmac_f32 v20, v16, v102
v_fmac_f32 v21, v16, v103
v_fmac_f32 v20, v15, v103
v_fmac_f32 v21, v15, v104
s_add_u32 m0, s87, 83968
s_nop 0
buffer_load_dwordx4 v5, s[12:15], s89 offen lds
v_fmac_f32 v20, v14, v104
v_fmac_f32 v21, v14, v105
s_waitcnt lgkmcnt(0)
v_lshlrev_b32 v22, 16, v80
v_and_b32 v23, 0xffff0000, v80
v_mul_f32 v20, v20, v22
v_mul_f32 v21, v21, v23
v_cvt_pk_bf16_f32 v134, v20, v21
v_lshlrev_b32 v106, 16, v65
v_and_b32 v107, 0xffff0000, v65
v_mul_f32 v20, v17, v103
v_mul_f32 v21, v17, v104
s_add_u32 m0, s87, 84992
s_nop 0
buffer_load_dwordx4 v6, s[12:15], s89 offen lds
v_fmac_f32 v20, v16, v104
v_fmac_f32 v21, v16, v105
v_fmac_f32 v20, v15, v105
v_fmac_f32 v21, v15, v106
v_fmac_f32 v20, v14, v106
v_fmac_f32 v21, v14, v107
v_lshlrev_b32 v22, 16, v81
v_and_b32 v23, 0xffff0000, v81
v_mul_f32 v20, v20, v22
v_mul_f32 v21, v21, v23
v_cvt_pk_bf16_f32 v135, v20, v21
buffer_store_dword v148, v149, s[16:19], 0 offen sc1
s_waitcnt vmcnt(11)
s_barrier
s_lshl_b32 s88, s58, 7
s_mul_i32 s89, s58, 196608
s_add_u32 s58, s58, 1
s_cmp_eq_u32 s58, 10
s_cselect_b32 s58, 0, s58
s_add_u32 m0, s86, 0
s_nop 0
buffer_load_dwordx4 v1, s[4:7], s88 offen lds
ds_read_b64_tr_b16 v[66:67], v154 offset:1536
ds_read_b64_tr_b16 v[68:69], v154 offset:2048
ds_read_b64_tr_b16 v[82:83], v154 offset:5632
ds_read_b64_tr_b16 v[84:85], v154 offset:6144
s_waitcnt lgkmcnt(3)
v_lshlrev_b32 v108, 16, v66
v_and_b32 v109, 0xffff0000, v66
s_add_u32 m0, s86, 1024
s_nop 0
buffer_load_dwordx4 v2, s[4:7], s88 offen lds
v_mul_f32 v20, v17, v105
v_mul_f32 v21, v17, v106
v_fmac_f32 v20, v16, v106
v_fmac_f32 v21, v16, v107
v_fmac_f32 v20, v15, v107
v_fmac_f32 v21, v15, v108
v_fmac_f32 v20, v14, v108
s_add_u32 m0, s86, 2048
s_add_u32 s88, s88, 20480
buffer_load_dwordx4 v1, s[4:7], s88 offen lds
v_fmac_f32 v21, v14, v109
s_waitcnt lgkmcnt(1)
v_lshlrev_b32 v22, 16, v82
v_and_b32 v23, 0xffff0000, v82
v_mul_f32 v20, v20, v22
v_mul_f32 v21, v21, v23
v_cvt_pk_bf16_f32 v136, v20, v21
s_add_u32 m0, s86, 3072
s_nop 0
buffer_load_dwordx4 v2, s[4:7], s88 offen lds
v_lshlrev_b32 v110, 16, v67
v_and_b32 v111, 0xffff0000, v67
v_mul_f32 v20, v17, v107
v_mul_f32 v21, v17, v108
v_fmac_f32 v20, v16, v108
v_fmac_f32 v21, v16, v109
v_fmac_f32 v20, v15, v109
s_add_u32 m0, s86, 4096
s_add_u32 s88, s88, 20480
buffer_load_dwordx4 v1, s[4:7], s88 offen lds
v_fmac_f32 v21, v15, v110
v_fmac_f32 v20, v14, v110
v_fmac_f32 v21, v14, v111
v_lshlrev_b32 v22, 16, v83
v_and_b32 v23, 0xffff0000, v83
v_mul_f32 v20, v20, v22
s_add_u32 m0, s86, 5120
s_nop 0
buffer_load_dwordx4 v2, s[4:7], s88 offen lds
v_mul_f32 v21, v21, v23
v_cvt_pk_bf16_f32 v137, v20, v21
v_lshlrev_b32 v112, 16, v68
v_and_b32 v113, 0xffff0000, v68
v_mul_f32 v20, v17, v109
v_mul_f32 v21, v17, v110
s_add_u32 m0, s87, 0
s_nop 0
buffer_load_dwordx4 v5, s[8:11], s89 offen lds
v_fmac_f32 v20, v16, v110
v_fmac_f32 v21, v16, v111
v_fmac_f32 v20, v15, v111
v_fmac_f32 v21, v15, v112
v_fmac_f32 v20, v14, v112
v_fmac_f32 v21, v14, v113
s_waitcnt lgkmcnt(0)
v_lshlrev_b32 v22, 16, v84
s_add_u32 m0, s87, 1024
s_nop 0
buffer_load_dwordx4 v6, s[8:11], s89 offen lds
v_and_b32 v23, 0xffff0000, v84
v_mul_f32 v20, v20, v22
v_mul_f32 v21, v21, v23
v_cvt_pk_bf16_f32 v138, v20, v21
v_lshlrev_b32 v114, 16, v69
v_and_b32 v115, 0xffff0000, v69
s_add_u32 m0, s87, 2048
s_nop 0
buffer_load_dwordx4 v5, s[12:15], s89 offen lds
v_mul_f32 v20, v17, v111
v_mul_f32 v21, v17, v112
v_fmac_f32 v20, v16, v112
v_fmac_f32 v21, v16, v113
v_fmac_f32 v20, v15, v113
v_fmac_f32 v21, v15, v114
v_fmac_f32 v20, v14, v114
s_add_u32 m0, s87, 3072
s_nop 0
buffer_load_dwordx4 v6, s[12:15], s89 offen lds
v_fmac_f32 v21, v14, v115
v_lshlrev_b32 v22, 16, v85
v_and_b32 v23, 0xffff0000, v85
v_mul_f32 v20, v20, v22
v_mul_f32 v21, v21, v23
v_cvt_pk_bf16_f32 v139, v20, v21
s_waitcnt vmcnt(10)
s_barrier
s_lshl_b32 s88, s58, 7
s_mul_i32 s89, s58, 196608
s_add_u32 s58, s58, 1
s_cmp_eq_u32 s58, 10
s_cselect_b32 s58, 0, s58
s_add_u32 m0, s86, 40960
s_nop 0
buffer_load_dwordx4 v1, s[4:7], s88 offen lds
ds_read_b64_tr_b16 v[70:71], v154 offset:2560
ds_read_b64_tr_b16 v[72:73], v154 offset:3072
ds_read_b64_tr_b16 v[86:87], v154 offset:6656
ds_read_b64_tr_b16 v[88:89], v154 offset:7168
s_waitcnt lgkmcnt(3)
v_lshlrev_b32 v116, 16, v70
v_and_b32 v117, 0xffff0000, v70
s_add_u32 m0, s86, 41984
s_nop 0
buffer_load_dwordx4 v2, s[4:7], s88 offen lds
v_mul_f32 v20, v17, v113
v_mul_f32 v21, v17, v114
v_fmac_f32 v20, v16, v114
v_fmac_f32 v21, v16, v115
v_fmac_f32 v20, v15, v115
v_fmac_f32 v21, v15, v116
v_fmac_f32 v20, v14, v116
s_add_u32 m0, s86, 43008
s_add_u32 s88, s88, 20480
buffer_load_dwordx4 v1, s[4:7], s88 offen lds
v_fmac_f32 v21, v14, v117
s_waitcnt lgkmcnt(1)
v_lshlrev_b32 v22, 16, v86
v_and_b32 v23, 0xffff0000, v86
v_mul_f32 v20, v20, v22
v_mul_f32 v21, v21, v23
v_cvt_pk_bf16_f32 v140, v20, v21
s_add_u32 m0, s86, 44032
s_nop 0
buffer_load_dwordx4 v2, s[4:7], s88 offen lds
v_lshlrev_b32 v118, 16, v71
v_and_b32 v119, 0xffff0000, v71
v_mul_f32 v20, v17, v115
v_mul_f32 v21, v17, v116
v_fmac_f32 v20, v16, v116
v_fmac_f32 v21, v16, v117
v_fmac_f32 v20, v15, v117
s_add_u32 m0, s86, 45056
s_add_u32 s88, s88, 20480
buffer_load_dwordx4 v1, s[4:7], s88 offen lds
v_fmac_f32 v21, v15, v118
v_fmac_f32 v20, v14, v118
v_fmac_f32 v21, v14, v119
v_lshlrev_b32 v22, 16, v87
v_and_b32 v23, 0xffff0000, v87
v_mul_f32 v20, v20, v22
s_add_u32 m0, s86, 46080
s_nop 0
buffer_load_dwordx4 v2, s[4:7], s88 offen lds
v_mul_f32 v21, v21, v23
v_cvt_pk_bf16_f32 v141, v20, v21
v_lshlrev_b32 v120, 16, v72
v_and_b32 v121, 0xffff0000, v72
v_mul_f32 v20, v17, v117
v_mul_f32 v21, v17, v118
s_add_u32 m0, s87, 40960
s_nop 0
buffer_load_dwordx4 v5, s[8:11], s89 offen lds
v_fmac_f32 v20, v16, v118
v_fmac_f32 v21, v16, v119
v_fmac_f32 v20, v15, v119
v_fmac_f32 v21, v15, v120
v_fmac_f32 v20, v14, v120
v_fmac_f32 v21, v14, v121
s_waitcnt lgkmcnt(0)
v_lshlrev_b32 v22, 16, v88
s_add_u32 m0, s87, 41984
s_nop 0
buffer_load_dwordx4 v6, s[8:11], s89 offen lds
v_and_b32 v23, 0xffff0000, v88
v_mul_f32 v20, v20, v22
v_mul_f32 v21, v21, v23
v_cvt_pk_bf16_f32 v142, v20, v21
v_lshlrev_b32 v122, 16, v73
v_and_b32 v123, 0xffff0000, v73
s_add_u32 m0, s87, 43008
s_nop 0
buffer_load_dwordx4 v5, s[12:15], s89 offen lds
v_mul_f32 v20, v17, v119
v_mul_f32 v21, v17, v120
v_fmac_f32 v20, v16, v120
v_fmac_f32 v21, v16, v121
v_fmac_f32 v20, v15, v121
v_fmac_f32 v21, v15, v122
v_fmac_f32 v20, v14, v122
s_add_u32 m0, s87, 44032
s_nop 0
buffer_load_dwordx4 v6, s[12:15], s89 offen lds
v_fmac_f32 v21, v14, v123
v_lshlrev_b32 v22, 16, v89
v_and_b32 v23, 0xffff0000, v89
v_mul_f32 v20, v20, v22
v_mul_f32 v21, v21, v23
v_cvt_pk_bf16_f32 v143, v20, v21
s_waitcnt vmcnt(10)
s_barrier
s_lshl_b32 s88, s58, 7
s_mul_i32 s89, s58, 196608
s_add_u32 s58, s58, 1
s_cmp_eq_u32 s58, 10
s_cselect_b32 s58, 0, s58
s_add_u32 m0, s86, 81920
s_nop 0
buffer_load_dwordx4 v1, s[4:7], s88 offen lds
ds_read_b64_tr_b16 v[74:75], v154 offset:3584
ds_read_b64_tr_b16 v[76:77], v154 offset:4096
ds_read_b64_tr_b16 v[90:91], v154 offset:7680
ds_read_b64_tr_b16 v[92:93], v154 offset:8192
s_waitcnt lgkmcnt(3)
v_lshlrev_b32 v124, 16, v74
v_and_b32 v125, 0xffff0000, v74
v_mul_f32 v20, v17, v121
v_mul_f32 v21, v17, v122
v_fmac_f32 v20, v16, v122
v_fmac_f32 v21, v16, v123
v_fmac_f32 v20, v15, v123
s_add_u32 m0, s86, 82944
s_nop 0
buffer_load_dwordx4 v2, s[4:7], s88 offen lds
v_fmac_f32 v21, v15, v124
v_fmac_f32 v20, v14, v124
v_fmac_f32 v21, v14, v125
s_waitcnt lgkmcnt(1)
v_lshlrev_b32 v22, 16, v90
v_and_b32 v23, 0xffff0000, v90
v_mul_f32 v20, v20, v22
v_mul_f32 v21, v21, v23
v_cvt_pk_bf16_f32 v144, v20, v21
v_lshlrev_b32 v126, 16, v75
v_and_b32 v127, 0xffff0000, v75
s_add_u32 m0, s86, 83968
s_add_u32 s88, s88, 20480
buffer_load_dwordx4 v1, s[4:7], s88 offen lds
v_mul_f32 v20, v17, v123
v_mul_f32 v21, v17, v124
v_fmac_f32 v20, v16, v124
v_fmac_f32 v21, v16, v125
v_fmac_f32 v20, v15, v125
v_fmac_f32 v21, v15, v126
v_fmac_f32 v20, v14, v126
v_fmac_f32 v21, v14, v127
v_lshlrev_b32 v22, 16, v91
v_and_b32 v23, 0xffff0000, v91
v_mul_f32 v20, v20, v22
s_add_u32 m0, s86, 84992
s_nop 0
buffer_load_dwordx4 v2, s[4:7], s88 offen lds
v_mul_f32 v21, v21, v23
v_cvt_pk_bf16_f32 v145, v20, v21
v_lshlrev_b32 v128, 16, v76
v_and_b32 v129, 0xffff0000, v76
v_mul_f32 v20, v17, v125
v_mul_f32 v21, v17, v126
v_fmac_f32 v20, v16, v126
v_fmac_f32 v21, v16, v127
v_fmac_f32 v20, v15, v127
v_fmac_f32 v21, v15, v128
v_fmac_f32 v20, v14, v128
s_add_u32 m0, s86, 86016
s_add_u32 s88, s88, 20480
buffer_load_dwordx4 v1, s[4:7], s88 offen lds
v_fmac_f32 v21, v14, v129
s_waitcnt lgkmcnt(0)
v_lshlrev_b32 v22, 16, v92
v_and_b32 v23, 0xffff0000, v92
v_mul_f32 v20, v20, v22
v_mul_f32 v21, v21, v23
v_cvt_pk_bf16_f32 v146, v20, v21
v_lshlrev_b32 v130, 16, v77
v_and_b32 v131, 0xffff0000, v77
v_mul_f32 v20, v17, v127
v_mul_f32 v21, v17, v128
s_add_u32 m0, s86, 87040
s_nop 0
buffer_load_dwordx4 v2, s[4:7], s88 offen lds
v_fmac_f32 v20, v16, v128
v_fmac_f32 v21, v16, v129
v_fmac_f32 v20, v15, v129
v_fmac_f32 v21, v15, v130
v_fmac_f32 v20, v14, v130
v_fmac_f32 v21, v14, v131
v_lshlrev_b32 v22, 16, v93
v_and_b32 v23, 0xffff0000, v93
v_mul_f32 v20, v20, v22
v_mul_f32 v21, v21, v23
v_cvt_pk_bf16_f32 v147, v20, v21
s_add_u32 m0, s87, 81920
s_nop 0
buffer_load_dwordx4 v5, s[8:11], s89 offen lds
s_mov_b32 vcc_lo, 0x55555555
s_mov_b32 vcc_hi, 0x55555555
v_cndmask_b32_dpp v96, v136, v132, vcc quad_perm:[1,0,3,2] row_mask:0xf bank_mask:0xf
v_cndmask_b32_dpp v97, v137, v133, vcc quad_perm:[1,0,3,2] row_mask:0xf bank_mask:0xf
v_cndmask_b32_dpp v98, v138, v134, vcc quad_perm:[1,0,3,2] row_mask:0xf bank_mask:0xf
v_cndmask_b32_dpp v99, v139, v135, vcc quad_perm:[1,0,3,2] row_mask:0xf bank_mask:0xf
s_mov_b32 vcc_lo, 0x55555555
s_mov_b32 vcc_hi, 0x55555555
v_cndmask_b32_dpp v104, v144, v140, vcc quad_perm:[1,0,3,2] row_mask:0xf bank_mask:0xf
v_cndmask_b32_dpp v105, v145, v141, vcc quad_perm:[1,0,3,2] row_mask:0xf bank_mask:0xf
v_cndmask_b32_dpp v106, v146, v142, vcc quad_perm:[1,0,3,2] row_mask:0xf bank_mask:0xf
v_cndmask_b32_dpp v107, v147, v143, vcc quad_perm:[1,0,3,2] row_mask:0xf bank_mask:0xf
s_add_u32 m0, s87, 82944
s_nop 0
buffer_load_dwordx4 v6, s[8:11], s89 offen lds
s_mov_b32 vcc_lo, 0xaaaaaaaa
s_mov_b32 vcc_hi, 0xaaaaaaaa
v_cndmask_b32_dpp v100, v132, v136, vcc quad_perm:[1,0,3,2] row_mask:0xf bank_mask:0xf
v_cndmask_b32_dpp v101, v133, v137, vcc quad_perm:[1,0,3,2] row_mask:0xf bank_mask:0xf
v_cndmask_b32_dpp v102, v134, v138, vcc quad_perm:[1,0,3,2] row_mask:0xf bank_mask:0xf
v_cndmask_b32_dpp v103, v135, v139, vcc quad_perm:[1,0,3,2] row_mask:0xf bank_mask:0xf
s_mov_b32 vcc_lo, 0xaaaaaaaa
s_mov_b32 vcc_hi, 0xaaaaaaaa
v_cndmask_b32_dpp v108, v140, v144, vcc quad_perm:[1,0,3,2] row_mask:0xf bank_mask:0xf
v_cndmask_b32_dpp v109, v141, v145, vcc quad_perm:[1,0,3,2] row_mask:0xf bank_mask:0xf
v_cndmask_b32_dpp v110, v142, v146, vcc quad_perm:[1,0,3,2] row_mask:0xf bank_mask:0xf
v_cndmask_b32_dpp v111, v143, v147, vcc quad_perm:[1,0,3,2] row_mask:0xf bank_mask:0xf
s_add_u32 m0, s87, 83968
s_nop 0
buffer_load_dwordx4 v5, s[12:15], s89 offen lds
s_mov_b32 vcc_lo, 0x33333333
s_mov_b32 vcc_hi, 0x33333333
v_cndmask_b32_dpp v132, v104, v96, vcc quad_perm:[2,3,0,1] row_mask:0xf bank_mask:0xf
v_cndmask_b32_dpp v133, v105, v97, vcc quad_perm:[2,3,0,1] row_mask:0xf bank_mask:0xf
v_cndmask_b32_dpp v134, v106, v98, vcc quad_perm:[2,3,0,1] row_mask:0xf bank_mask:0xf
v_cndmask_b32_dpp v135, v107, v99, vcc quad_perm:[2,3,0,1] row_mask:0xf bank_mask:0xf
s_mov_b32 vcc_lo, 0x33333333
s_mov_b32 vcc_hi, 0x33333333
v_cndmask_b32_dpp v136, v108, v100, vcc quad_perm:[2,3,0,1] row_mask:0xf bank_mask:0xf
v_cndmask_b32_dpp v137, v109, v101, vcc quad_perm:[2,3,0,1] row_mask:0xf bank_mask:0xf
v_cndmask_b32_dpp v138, v110, v102, vcc quad_perm:[2,3,0,1] row_mask:0xf bank_mask:0xf
v_cndmask_b32_dpp v139, v111, v103, vcc quad_perm:[2,3,0,1] row_mask:0xf bank_mask:0xf
s_add_u32 m0, s87, 84992
s_nop 0
buffer_load_dwordx4 v6, s[12:15], s89 offen lds
s_mov_b32 vcc_lo, 0xcccccccc
s_mov_b32 vcc_hi, 0xcccccccc
v_cndmask_b32_dpp v140, v96, v104, vcc quad_perm:[2,3,0,1] row_mask:0xf bank_mask:0xf
v_cndmask_b32_dpp v141, v97, v105, vcc quad_perm:[2,3,0,1] row_mask:0xf bank_mask:0xf
v_cndmask_b32_dpp v142, v98, v106, vcc quad_perm:[2,3,0,1] row_mask:0xf bank_mask:0xf
v_cndmask_b32_dpp v143, v99, v107, vcc quad_perm:[2,3,0,1] row_mask:0xf bank_mask:0xf
s_mov_b32 vcc_lo, 0xcccccccc
s_mov_b32 vcc_hi, 0xcccccccc
v_cndmask_b32_dpp v144, v100, v108, vcc quad_perm:[2,3,0,1] row_mask:0xf bank_mask:0xf
v_cndmask_b32_dpp v145, v101, v109, vcc quad_perm:[2,3,0,1] row_mask:0xf bank_mask:0xf
v_cndmask_b32_dpp v146, v102, v110, vcc quad_perm:[2,3,0,1] row_mask:0xf bank_mask:0xf
v_cndmask_b32_dpp v147, v103, v111, vcc quad_perm:[2,3,0,1] row_mask:0xf bank_mask:0xf
s_waitcnt vmcnt(10)
s_barrier
s_lshl_b32 s88, s58, 7
s_mul_i32 s89, s58, 196608
s_add_u32 s58, s58, 1
s_cmp_eq_u32 s58, 10
s_cselect_b32 s58, 0, s58
s_add_u32 m0, s86, 0
s_nop 0
buffer_load_dwordx4 v1, s[4:7], s88 offen lds
buffer_store_dwordx4 v[132:135], v157, s[16:19], s94 offen sc1
s_add_u32 s94, s94, 4352
s_add_u32 m0, s86, 1024
s_nop 0
buffer_load_dwordx4 v2, s[4:7], s88 offen lds
s_add_u32 m0, s86, 2048
s_add_u32 s88, s88, 20480
buffer_load_dwordx4 v1, s[4:7], s88 offen lds
buffer_store_dwordx4 v[136:139], v157, s[16:19], s94 offen sc1
s_add_u32 s94, s94, 4352
s_add_u32 m0, s86, 3072
s_nop 0
buffer_load_dwordx4 v2, s[4:7], s88 offen lds
s_add_u32 m0, s86, 4096
s_add_u32 s88, s88, 20480
buffer_load_dwordx4 v1, s[4:7], s88 offen lds
s_add_u32 m0, s86, 5120
s_nop 0
buffer_load_dwordx4 v2, s[4:7], s88 offen lds
buffer_store_dwordx4 v[140:143], v157, s[16:19], s94 offen sc1
s_add_u32 s94, s94, 4352
s_add_u32 m0, s87, 0
s_nop 0
buffer_load_dwordx4 v5, s[8:11], s89 offen lds
s_add_u32 m0, s87, 1024
s_nop 0
buffer_load_dwordx4 v6, s[8:11], s89 offen lds
s_add_u32 m0, s87, 2048
s_nop 0
buffer_load_dwordx4 v5, s[12:15], s89 offen lds
buffer_store_dwordx4 v[144:147], v157, s[16:19], s94 offen sc1
s_add_u32 m0, s87, 3072
s_nop 0
buffer_load_dwordx4 v6, s[12:15], s89 offen lds
s_waitcnt vmcnt(14)
s_barrier
s_lshl_b32 s88, s58, 7
s_mul_i32 s89, s58, 196608
s_add_u32 s58, s58, 1
s_cmp_eq_u32 s58, 10
s_cselect_b32 s58, 0, s58
s_add_u32 m0, s86, 40960
s_nop 0
buffer_load_dwordx4 v1, s[4:7], s88 offen lds
s_mul_i32 s92, s53, 8704
s_add_u32 m0, s86, 41984
s_nop 0
buffer_load_dwordx4 v2, s[4:7], s88 offen lds
s_add_u32 m0, s86, 43008
s_add_u32 s88, s88, 20480
buffer_load_dwordx4 v1, s[4:7], s88 offen lds
s_add_u32 m0, s86, 44032
s_nop 0
buffer_load_dwordx4 v2, s[4:7], s88 offen lds
s_add_u32 s92, s92, 122880
s_add_u32 m0, s86, 45056
s_add_u32 s88, s88, 20480
buffer_load_dwordx4 v1, s[4:7], s88 offen lds
s_add_u32 m0, s86, 46080
s_nop 0
buffer_load_dwordx4 v2, s[4:7], s88 offen lds
s_add_u32 m0, s87, 40960
s_nop 0
buffer_load_dwordx4 v5, s[8:11], s89 offen lds
v_lshlrev_b32 v18, 4, v0
s_add_u32 m0, s87, 41984
s_nop 0
buffer_load_dwordx4 v6, s[8:11], s89 offen lds
s_add_u32 m0, s87, 43008
s_nop 0
buffer_load_dwordx4 v5, s[12:15], s89 offen lds
s_add_u32 m0, s87, 44032
s_nop 0
buffer_load_dwordx4 v6, s[12:15], s89 offen lds
s_waitcnt vmcnt(10)
s_lshr_b32 s63, s62, 6
s_add_u32 s96, s63, 184
s_lshl_b32 s96, s96, 7
s_mov_b32 s100, 1
s_atomic_add s100, s[16:17], s96 offset:0
s_barrier
s_lshl_b32 s88, s58, 7
s_mul_i32 s89, s58, 196608
s_add_u32 s58, s58, 1
s_cmp_eq_u32 s58, 10
s_cselect_b32 s58, 0, s58
s_add_u32 m0, s86, 81920
s_nop 0
buffer_load_dwordx4 v1, s[4:7], s88 offen lds
s_add_u32 m0, s86, 82944
s_nop 0
buffer_load_dwordx4 v2, s[4:7], s88 offen lds
s_add_u32 m0, s86, 83968
s_add_u32 s88, s88, 20480
buffer_load_dwordx4 v1, s[4:7], s88 offen lds
s_add_u32 m0, s86, 84992
s_nop 0
buffer_load_dwordx4 v2, s[4:7], s88 offen lds
s_add_u32 m0, s86, 86016
s_add_u32 s88, s88, 20480
buffer_load_dwordx4 v1, s[4:7], s88 offen lds
s_add_u32 m0, s86, 87040
s_nop 0
buffer_load_dwordx4 v2, s[4:7], s88 offen lds
s_add_u32 m0, s87, 81920
s_nop 0
buffer_load_dwordx4 v5, s[8:11], s89 offen lds
s_add_u32 m0, s87, 82944
s_nop 0
buffer_load_dwordx4 v6, s[8:11], s89 offen lds
s_add_u32 m0, s87, 83968
s_nop 0
buffer_load_dwordx4 v5, s[12:15], s89 offen lds
s_add_u32 m0, s87, 84992
s_nop 0
buffer_load_dwordx4 v6, s[12:15], s89 offen lds
s_waitcnt vmcnt(10)
s_barrier
s_lshl_b32 s88, s58, 7
s_mul_i32 s89, s58, 196608
s_add_u32 s58, s58, 1
s_cmp_eq_u32 s58, 10
s_cselect_b32 s58, 0, s58
s_add_u32 m0, s86, 0
s_nop 0
buffer_load_dwordx4 v1, s[4:7], s88 offen lds
s_add_u32 m0, s86, 1024
s_nop 0
buffer_load_dwordx4 v2, s[4:7], s88 offen lds
s_add_u32 m0, s86, 2048
s_add_u32 s88, s88, 20480
buffer_load_dwordx4 v1, s[4:7], s88 offen lds
s_add_u32 m0, s86, 3072
s_nop 0
buffer_load_dwordx4 v2, s[4:7], s88 offen lds
s_add_u32 m0, s86, 4096
s_add_u32 s88, s88, 20480
buffer_load_dwordx4 v1, s[4:7], s88 offen lds
s_add_u32 m0, s86, 5120
s_nop 0
buffer_load_dwordx4 v2, s[4:7], s88 offen lds
s_add_u32 m0, s87, 0
s_nop 0
buffer_load_dwordx4 v5, s[8:11], s89 offen lds
s_add_u32 m0, s87, 1024
s_nop 0
buffer_load_dwordx4 v6, s[8:11], s89 offen lds
s_add_u32 m0, s87, 2048
s_nop 0
buffer_load_dwordx4 v5, s[12:15], s89 offen lds
s_add_u32 m0, s87, 3072
s_nop 0
buffer_load_dwordx4 v6, s[12:15], s89 offen lds
s_waitcnt vmcnt(10)
s_barrier
v_min_u32 v14, 47, v0
v_lshlrev_b32 v14, 3, v14
s_mul_i32 s64, s53, 384
v_add_u32 v14, s64, v14
s_lshl_b32 s63, s56, 9
s_add_u32 s63, s63, 40960
v_min_u32 v15, 31, v0
s_mul_i32 s64, s53, 32
v_add_u32 v15, s64, v15
v_lshlrev_b32 v15, 2, v15
s_lshl_b32 s64, s57, 7
s_add_u32 s64, s64, 57344
buffer_load_dwordx2 v[24:25], v14, s[16:19], s63 offen sc1
buffer_load_dword v26, v15, s[16:19], s64 offen sc1
s_add_u32 s64, s64, 12288
buffer_load_dword v27, v15, s[16:19], s64 offen sc1
s_add_u32 s64, s64, 12288
buffer_load_dword v28, v15, s[16:19], s64 offen sc1
s_add_u32 s64, s64, 12288
buffer_load_dword v29, v15, s[16:19], s64 offen sc1
s_add_u32 s64, s64, 12288
buffer_load_dword v30, v15, s[16:19], s64 offen sc1
s_add_u32 s64, s64, 12288
buffer_load_dword v31, v15, s[16:19], s64 offen sc1
s_add_u32 s64, s64, 12288
buffer_load_dword v32, v15, s[16:19], s64 offen sc1
s_add_u32 s64, s64, 12288
buffer_load_dword v33, v15, s[16:19], s64 offen sc1
s_add_u32 s64, s64, 12288
buffer_load_dword v34, v15, s[16:19], s64 offen sc1
s_add_u32 s64, s64, 12288
buffer_load_dword v35, v15, s[16:19], s64 offen sc1
s_lshr_b32 s63, s62, 6
s_add_u32 s63, s63, 184
s_lshl_b32 s63, s63, 7
v_mov_b32 v22, s63
s_mov_b64 exec, 1
buffer_load_dword v23, v22, s[16:19], 0 offen sc1
s_mov_b64 exec, -1
v_lshlrev_b32 v4, 2, v0
v_add_u32 v4, s92, v4
v_mov_b32 v5, 0
s_mov_b32 exec_hi, 0
s_mov_b32 exec_lo, 0xffffff
ds_write_b32 v4, v5
s_mov_b32 exec_lo, -1
s_mov_b32 exec_hi, 0xff
ds_write_b32 v4, v5 offset:4192
s_mov_b64 exec, -1
v_and_b32 v4, 3, v0
v_lshrrev_b32 v5, 4, v0
v_bfe_u32 v6, v0, 2, 2
v_lshlrev_b32 v7, 6, v5
v_lshl_add_u32 v7, v6, 3, v7
v_lshl_add_u32 v1, v4, 5, v7
v_add_u32 v1, s92, v1
v_lshlrev_b32 v4, 3, v4
v_sub_u32 v2, v4, v7
s_add_u32 s63, s92, 4416
v_add_u32 v2, s63, v2
v_lshl_add_u32 v3, v0, 1, s92
v_lshl_add_u32 v12, v0, 4, s92
s_mul_i32 s91, s62, 4352
s_add_u32 s91, s91, 3407872
s_waitcnt vmcnt(12)
s_barrier
s_setprio 3
v_add_u32 v14, 159232, v14
v_lshlrev_b32 v15, 1, v15
v_add_u32 v15, 160768, v15
s_waitcnt vmcnt(1)
ds_write_b64 v14, v[24:25]
v_add_f32 v26, v26, v31
v_add_f32 v27, v27, v32
v_add_f32 v28, v28, v33
v_add_f32 v29, v29, v34
v_add_f32 v30, v30, v35
v_add_f32 v26, v26, v29
v_add_f32 v27, v27, v30
v_add_f32 v26, v26, v28
v_add_f32 v26, v26, v27
v_cvt_pk_bf16_f32 v27, v26, v26
v_and_b32 v27, 0xffff0000, v27
v_sub_f32 v27, v26, v27
v_cvt_pk_bf16_f32 v28, v26, v27
v_and_b32 v30, 0xffff0000, v28
v_sub_f32 v27, v27, v30
v_cvt_pk_bf16_f32 v29, v27, 0
ds_write_b64 v15, v[28:29]
v_mov_b32 v14, 162320
v_mov_b32 v15, 1
s_mov_b64 exec, 1
ds_add_u32 v14, v15
s_mov_b64 exec, -1
s_waitcnt vmcnt(0)
s_mov_b64 exec, 1
s_mov_b32 s67, 0
L_vc_1:
v_cmp_le_u32 vcc, 64, v23
s_nop 0
s_cmp_eq_u64 vcc, exec
s_cbranch_scc1 L_vcok_2
s_sleep 8
buffer_load_dword v23, v22, s[16:19], 0 offen sc1
s_add_u32 s67, s67, 1
s_cmp_lt_u32 s67, 131072
s_waitcnt vmcnt(0)
s_cbranch_scc1 L_vc_1
L_vcok_2:
s_mov_b64 exec, -1
L_vcskip_3:
s_mul_i32 s63, s62, 4352
s_add_u32 m0, s92, 4352
s_add_u32 s63, s63, 262144
buffer_load_dwordx4 v18, s[16:19], s63 offen offset:0 sc1  lds
buffer_load_dwordx4 v18, s[16:19], s63 offen offset:1024 sc1  lds
buffer_load_dwordx4 v18, s[16:19], s63 offen offset:2048 sc1  lds
buffer_load_dwordx4 v18, s[16:19], s63 offen offset:3072 sc1  lds
s_setprio 1
s_lshl2_add_u32 s63, s59, s53
s_mul_i32 s64, s63, 20480
s_mul_i32 s65, s60, 160
s_add_u32 s64, s64, s65
v_add_u32 v20, 0, v0
v_mul_u32_u24 v21, 205, v20
v_lshrrev_b32 v21, 11, v21
v_mul_u32_u24 v21, 1120, v21
v_lshl_add_u32 v21, v20, 4, v21
v_add_u32 v13, s64, v21
v_add_u32 v20, 64, v0
v_mul_u32_u24 v21, 205, v20
v_lshrrev_b32 v21, 11, v21
v_mul_u32_u24 v21, 1120, v21
v_lshl_add_u32 v21, v20, 4, v21
v_add_u32 v14, s64, v21
v_add_u32 v20, 128, v0
v_mul_u32_u24 v21, 205, v20
v_lshrrev_b32 v21, 11, v21
v_mul_u32_u24 v21, 1120, v21
v_lshl_add_u32 v21, v20, 4, v21
v_add_u32 v15, s64, v21
s_lshl_b32 s63, s63, 7
s_add_u32 s63, s63, 40960
v_and_b32 v20, 15, v0
v_lshlrev_b32 v20, 3, v20
buffer_load_dwordx2 v[16:17], v20, s[16:19], s63 offen sc1
v_add_u32 v176, s92, v18
s_mov_b64 exec, 1
v_lshlrev_b32 v177, 16, v160
v_lshlrev_b32 v19, 16, v19
v_add_f32 v177, v177, v19
v_and_b32 v160, 0xffff0000, v160
v_cvt_pk_bf16_f32 v160, v177, v160
s_mov_b64 exec, -1
ds_write_b128 v176, v[160:163] offset:96
ds_write_b128 v176, v[164:167] offset:1120
ds_write_b128 v176, v[168:171] offset:2144
ds_write_b128 v176, v[172:175] offset:3168
ds_read_b64_tr_b16 v[24:25], v1 offset:0
ds_read_b64_tr_b16 v[26:27], v1 offset:32
ds_read_b64_tr_b16 v[28:29], v1 offset:256
ds_read_b64_tr_b16 v[30:31], v1 offset:288
ds_read_b64_tr_b16 v[32:33], v1 offset:512
ds_read_b64_tr_b16 v[34:35], v1 offset:544
ds_read_b64_tr_b16 v[36:37], v1 offset:768
ds_read_b64_tr_b16 v[38:39], v1 offset:800
ds_read_b64_tr_b16 v[40:41], v1 offset:1024
ds_read_b64_tr_b16 v[42:43], v1 offset:1056
ds_read_b64_tr_b16 v[44:45], v1 offset:1280
ds_read_b64_tr_b16 v[46:47], v1 offset:1312
ds_read_b64_tr_b16 v[48:49], v1 offset:1536
ds_read_b64_tr_b16 v[50:51], v1 offset:1568
ds_read_b64_tr_b16 v[52:53], v1 offset:1792
ds_read_b64_tr_b16 v[54:55], v1 offset:1824
ds_read_b64_tr_b16 v[56:57], v1 offset:2048
ds_read_b64_tr_b16 v[58:59], v1 offset:2080
ds_read_b64_tr_b16 v[60:61], v1 offset:2304
ds_read_b64_tr_b16 v[62:63], v1 offset:2336
ds_read_b64_tr_b16 v[64:65], v1 offset:2560
ds_read_b64_tr_b16 v[66:67], v1 offset:2592
ds_read_b64_tr_b16 v[68:69], v1 offset:2816
ds_read_b64_tr_b16 v[70:71], v1 offset:2848
ds_read_b64_tr_b16 v[72:73], v1 offset:3072
ds_read_b64_tr_b16 v[74:75], v1 offset:3104
ds_read_b64_tr_b16 v[76:77], v1 offset:3328
ds_read_b64_tr_b16 v[78:79], v1 offset:3360
ds_read_b64_tr_b16 v[80:81], v1 offset:3584
ds_read_b64_tr_b16 v[82:83], v1 offset:3616
ds_read_b64_tr_b16 v[84:85], v1 offset:3840
ds_read_b64_tr_b16 v[86:87], v1 offset:3872
s_waitcnt vmcnt(4)
ds_read_b64_tr_b16 v[88:89], v2 offset:32
ds_read_b64_tr_b16 v[90:91], v2 offset:0
ds_read_b64_tr_b16 v[92:93], v2 offset:160
ds_read_b64_tr_b16 v[94:95], v2 offset:128
ds_read_b64_tr_b16 v[96:97], v2 offset:288
ds_read_b64_tr_b16 v[98:99], v2 offset:256
ds_read_b64_tr_b16 v[100:101], v2 offset:416
ds_read_b64_tr_b16 v[102:103], v2 offset:384
ds_read_b64_tr_b16 v[104:105], v2 offset:544
ds_read_b64_tr_b16 v[106:107], v2 offset:512
ds_read_b64_tr_b16 v[108:109], v2 offset:672
ds_read_b64_tr_b16 v[110:111], v2 offset:640
ds_read_b64_tr_b16 v[112:113], v2 offset:800
ds_read_b64_tr_b16 v[114:115], v2 offset:768
ds_read_b64_tr_b16 v[116:117], v2 offset:928
ds_read_b64_tr_b16 v[118:119], v2 offset:896
s_waitcnt lgkmcnt(14)
v_mfma_f32_16x16x32_bf16 v[216:219], v[24:27], v[88:91], 0
s_waitcnt lgkmcnt(12)
v_mfma_f32_16x16x32_bf16 v[220:223], v[24:27], v[92:95], 0
v_mfma_f32_16x16x32_bf16 v[224:227], v[28:31], v[88:91], 0
s_waitcnt lgkmcnt(10)
v_mfma_f32_16x16x32_bf16 v[224:227], v[24:27], v[96:99], v[224:227]
v_mfma_f32_16x16x32_bf16 v[228:231], v[28:31], v[92:95], 0
s_waitcnt lgkmcnt(8)
v_mfma_f32_16x16x32_bf16 v[228:231], v[24:27], v[100:103], v[228:231]
v_mfma_f32_16x16x32_bf16 v[232:235], v[32:35], v[88:91], 0
v_mfma_f32_16x16x32_bf16 v[232:235], v[28:31], v[96:99], v[232:235]
s_waitcnt lgkmcnt(6)
v_mfma_f32_16x16x32_bf16 v[232:235], v[24:27], v[104:107], v[232:235]
v_add_f32_dpp v4, v219, v218 wave_shr:1 row_mask:0xf bank_mask:0xf bound_ctrl:0
s_nop 1
v_add_f32_dpp v6, v4, v217 wave_shr:1 row_mask:0xf bank_mask:0xf bound_ctrl:0
v_mfma_f32_16x16x32_bf16 v[236:239], v[32:35], v[92:95], 0
s_waitcnt vmcnt(3)
ds_read_b64_tr_b16 v[120:121], v2 offset:1056
ds_read_b64_tr_b16 v[122:123], v2 offset:1024
v_mfma_f32_16x16x32_bf16 v[236:239], v[28:31], v[100:103], v[236:239]
v_add_f32_dpp v8, v6, v216 wave_shr:1 row_mask:0xf bank_mask:0xf bound_ctrl:0
v_add_f32_dpp v5, v219, v222 wave_ror:1 row_mask:0xf bank_mask:0xf
s_waitcnt lgkmcnt(6)
v_mfma_f32_16x16x32_bf16 v[236:239], v[24:27], v[108:111], v[236:239]
v_add_f32_dpp v5, v223, v222 wave_shr:1 row_mask:0xf bank_mask:0xf
v_add_f32_dpp v7, v4, v221 wave_ror:1 row_mask:0xf bank_mask:0xf
v_mfma_f32_16x16x32_bf16 v[240:243], v[36:39], v[88:91], 0
ds_read_b64_tr_b16 v[124:125], v2 offset:1184
ds_read_b64_tr_b16 v[126:127], v2 offset:1152
v_mfma_f32_16x16x32_bf16 v[240:243], v[32:35], v[96:99], v[240:243]
v_add_f32_dpp v7, v5, v221 wave_shr:1 row_mask:0xf bank_mask:0xf
v_add_f32_dpp v9, v6, v220 wave_ror:1 row_mask:0xf bank_mask:0xf
v_mfma_f32_16x16x32_bf16 v[240:243], v[28:31], v[104:107], v[240:243]
v_add_f32_dpp v9, v7, v220 wave_shr:1 row_mask:0xf bank_mask:0xf
v_cvt_pk_bf16_f32 v10, v8, v9
s_waitcnt lgkmcnt(6)
v_mfma_f32_16x16x32_bf16 v[240:243], v[24:27], v[112:115], v[240:243]
ds_write_b16 v3, v10 offset:0
ds_write_b16_d16_hi v3, v10 offset:128
v_mfma_f32_16x16x32_bf16 v[244:247], v[36:39], v[92:95], 0
ds_read_b64_tr_b16 v[128:129], v2 offset:1312
ds_read_b64_tr_b16 v[130:131], v2 offset:1280
v_mfma_f32_16x16x32_bf16 v[244:247], v[32:35], v[100:103], v[244:247]
v_add_f32_dpp v4, v223, v226 wave_ror:1 row_mask:0xf bank_mask:0xf
v_add_f32_dpp v4, v227, v226 wave_shr:1 row_mask:0xf bank_mask:0xf
v_mfma_f32_16x16x32_bf16 v[244:247], v[28:31], v[108:111], v[244:247]
v_add_f32_dpp v6, v5, v225 wave_ror:1 row_mask:0xf bank_mask:0xf
v_add_f32_dpp v6, v4, v225 wave_shr:1 row_mask:0xf bank_mask:0xf
s_waitcnt lgkmcnt(8)
v_mfma_f32_16x16x32_bf16 v[244:247], v[24:27], v[116:119], v[244:247]
v_add_f32_dpp v8, v7, v224 wave_ror:1 row_mask:0xf bank_mask:0xf
v_add_f32_dpp v8, v6, v224 wave_shr:1 row_mask:0xf bank_mask:0xf
v_mfma_f32_16x16x32_bf16 v[248:251], v[40:43], v[88:91], 0
ds_read_b64_tr_b16 v[132:133], v2 offset:1440
ds_read_b64_tr_b16 v[134:135], v2 offset:1408
v_mfma_f32_16x16x32_bf16 v[248:251], v[36:39], v[96:99], v[248:251]
v_add_f32_dpp v5, v227, v230 wave_ror:1 row_mask:0xf bank_mask:0xf
v_add_f32_dpp v5, v231, v230 wave_shr:1 row_mask:0xf bank_mask:0xf
v_mfma_f32_16x16x32_bf16 v[248:251], v[32:35], v[104:107], v[248:251]
v_add_f32_dpp v7, v4, v229 wave_ror:1 row_mask:0xf bank_mask:0xf
v_add_f32_dpp v7, v5, v229 wave_shr:1 row_mask:0xf bank_mask:0xf
v_mfma_f32_16x16x32_bf16 v[248:251], v[28:31], v[112:115], v[248:251]
v_add_f32_dpp v9, v6, v228 wave_ror:1 row_mask:0xf bank_mask:0xf
v_add_f32_dpp v9, v7, v228 wave_shr:1 row_mask:0xf bank_mask:0xf
s_waitcnt lgkmcnt(8)
v_mfma_f32_16x16x32_bf16 v[248:251], v[24:27], v[120:123], v[248:251]
v_cvt_pk_bf16_f32 v10, v8, v9
ds_write_b16 v3, v10 offset:256
v_mfma_f32_16x16x32_bf16 v[252:255], v[40:43], v[92:95], 0
ds_read_b64_tr_b16 v[136:137], v2 offset:1568
ds_read_b64_tr_b16 v[138:139], v2 offset:1536
v_mfma_f32_16x16x32_bf16 v[252:255], v[36:39], v[100:103], v[252:255]
ds_write_b16_d16_hi v3, v10 offset:384
v_add_f32_dpp v4, v231, v234 wave_ror:1 row_mask:0xf bank_mask:0xf
v_mfma_f32_16x16x32_bf16 v[252:255], v[32:35], v[108:111], v[252:255]
v_add_f32_dpp v4, v235, v234 wave_shr:1 row_mask:0xf bank_mask:0xf
v_add_f32_dpp v6, v5, v233 wave_ror:1 row_mask:0xf bank_mask:0xf
v_mfma_f32_16x16x32_bf16 v[252:255], v[28:31], v[116:119], v[252:255]
v_add_f32_dpp v6, v4, v233 wave_shr:1 row_mask:0xf bank_mask:0xf
v_add_f32_dpp v8, v7, v232 wave_ror:1 row_mask:0xf bank_mask:0xf
s_waitcnt lgkmcnt(10)
v_mfma_f32_16x16x32_bf16 v[252:255], v[24:27], v[124:127], v[252:255]
v_add_f32_dpp v8, v6, v232 wave_shr:1 row_mask:0xf bank_mask:0xf
v_add_f32_dpp v5, v235, v238 wave_ror:1 row_mask:0xf bank_mask:0xf
v_mfma_f32_16x16x32_bf16 v[216:219], v[44:47], v[88:91], 0
ds_read_b64_tr_b16 v[140:141], v2 offset:1696
ds_read_b64_tr_b16 v[142:143], v2 offset:1664
v_mfma_f32_16x16x32_bf16 v[216:219], v[40:43], v[96:99], v[216:219]
v_add_f32_dpp v5, v239, v238 wave_shr:1 row_mask:0xf bank_mask:0xf
v_add_f32_dpp v7, v4, v237 wave_ror:1 row_mask:0xf bank_mask:0xf
v_mfma_f32_16x16x32_bf16 v[216:219], v[36:39], v[104:107], v[216:219]
v_add_f32_dpp v7, v5, v237 wave_shr:1 row_mask:0xf bank_mask:0xf
v_add_f32_dpp v9, v6, v236 wave_ror:1 row_mask:0xf bank_mask:0xf
v_mfma_f32_16x16x32_bf16 v[216:219], v[32:35], v[112:115], v[216:219]
v_add_f32_dpp v9, v7, v236 wave_shr:1 row_mask:0xf bank_mask:0xf
v_cvt_pk_bf16_f32 v10, v8, v9
v_mfma_f32_16x16x32_bf16 v[216:219], v[28:31], v[120:123], v[216:219]
ds_write_b16 v3, v10 offset:512
ds_write_b16_d16_hi v3, v10 offset:640
s_waitcnt lgkmcnt(10)
v_mfma_f32_16x16x32_bf16 v[216:219], v[24:27], v[128:131], v[216:219]
v_add_f32_dpp v4, v239, v242 wave_ror:1 row_mask:0xf bank_mask:0xf
v_add_f32_dpp v4, v243, v242 wave_shr:1 row_mask:0xf bank_mask:0xf
v_mfma_f32_16x16x32_bf16 v[220:223], v[44:47], v[92:95], 0
ds_read_b64_tr_b16 v[144:145], v2 offset:1824
ds_read_b64_tr_b16 v[146:147], v2 offset:1792
v_mfma_f32_16x16x32_bf16 v[220:223], v[40:43], v[100:103], v[220:223]
v_add_f32_dpp v6, v5, v241 wave_ror:1 row_mask:0xf bank_mask:0xf
v_add_f32_dpp v6, v4, v241 wave_shr:1 row_mask:0xf bank_mask:0xf
v_mfma_f32_16x16x32_bf16 v[220:223], v[36:39], v[108:111], v[220:223]
v_add_f32_dpp v8, v7, v240 wave_ror:1 row_mask:0xf bank_mask:0xf
v_add_f32_dpp v8, v6, v240 wave_shr:1 row_mask:0xf bank_mask:0xf
v_mfma_f32_16x16x32_bf16 v[220:223], v[32:35], v[116:119], v[220:223]
v_add_f32_dpp v5, v243, v246 wave_ror:1 row_mask:0xf bank_mask:0xf
v_add_f32_dpp v5, v247, v246 wave_shr:1 row_mask:0xf bank_mask:0xf
v_mfma_f32_16x16x32_bf16 v[220:223], v[28:31], v[124:127], v[220:223]
v_add_f32_dpp v7, v4, v245 wave_ror:1 row_mask:0xf bank_mask:0xf
v_add_f32_dpp v7, v5, v245 wave_shr:1 row_mask:0xf bank_mask:0xf
s_waitcnt lgkmcnt(10)
v_mfma_f32_16x16x32_bf16 v[220:223], v[24:27], v[132:135], v[220:223]
v_add_f32_dpp v9, v6, v244 wave_ror:1 row_mask:0xf bank_mask:0xf
v_add_f32_dpp v9, v7, v244 wave_shr:1 row_mask:0xf bank_mask:0xf
v_mfma_f32_16x16x32_bf16 v[224:227], v[48:51], v[88:91], 0
ds_read_b64_tr_b16 v[148:149], v2 offset:1952
ds_read_b64_tr_b16 v[150:151], v2 offset:1920
v_mfma_f32_16x16x32_bf16 v[224:227], v[44:47], v[96:99], v[224:227]
v_cvt_pk_bf16_f32 v10, v8, v9
ds_write_b16 v3, v10 offset:768
v_mfma_f32_16x16x32_bf16 v[224:227], v[40:43], v[104:107], v[224:227]
ds_write_b16_d16_hi v3, v10 offset:896
v_add_f32_dpp v4, v247, v250 wave_ror:1 row_mask:0xf bank_mask:0xf
v_mfma_f32_16x16x32_bf16 v[224:227], v[36:39], v[112:115], v[224:227]
v_add_f32_dpp v4, v251, v250 wave_shr:1 row_mask:0xf bank_mask:0xf
v_add_f32_dpp v6, v5, v249 wave_ror:1 row_mask:0xf bank_mask:0xf
v_mfma_f32_16x16x32_bf16 v[224:227], v[32:35], v[120:123], v[224:227]
v_add_f32_dpp v6, v4, v249 wave_shr:1 row_mask:0xf bank_mask:0xf
v_add_f32_dpp v8, v7, v248 wave_ror:1 row_mask:0xf bank_mask:0xf
v_mfma_f32_16x16x32_bf16 v[224:227], v[28:31], v[128:131], v[224:227]
v_add_f32_dpp v8, v6, v248 wave_shr:1 row_mask:0xf bank_mask:0xf
v_add_f32_dpp v5, v251, v254 wave_ror:1 row_mask:0xf bank_mask:0xf
s_waitcnt lgkmcnt(11)
v_mfma_f32_16x16x32_bf16 v[224:227], v[24:27], v[136:139], v[224:227]
v_add_f32_dpp v5, v255, v254 wave_shr:1 row_mask:0xf bank_mask:0xf
v_add_f32_dpp v7, v4, v253 wave_ror:1 row_mask:0xf bank_mask:0xf
v_mfma_f32_16x16x32_bf16 v[228:231], v[48:51], v[92:95], 0
s_waitcnt vmcnt(2)
ds_read_b64_tr_b16 v[152:153], v2 offset:2080
ds_read_b64_tr_b16 v[154:155], v2 offset:2048
v_mfma_f32_16x16x32_bf16 v[228:231], v[44:47], v[100:103], v[228:231]
v_add_f32_dpp v7, v5, v253 wave_shr:1 row_mask:0xf bank_mask:0xf
v_add_f32_dpp v9, v6, v252 wave_ror:1 row_mask:0xf bank_mask:0xf
v_mfma_f32_16x16x32_bf16 v[228:231], v[40:43], v[108:111], v[228:231]
v_add_f32_dpp v9, v7, v252 wave_shr:1 row_mask:0xf bank_mask:0xf
v_cvt_pk_bf16_f32 v10, v8, v9
v_mfma_f32_16x16x32_bf16 v[228:231], v[36:39], v[116:119], v[228:231]
ds_write_b16 v3, v10 offset:1024
ds_write_b16_d16_hi v3, v10 offset:1152
v_mfma_f32_16x16x32_bf16 v[228:231], v[32:35], v[124:127], v[228:231]
v_add_f32_dpp v4, v255, v218 wave_ror:1 row_mask:0xf bank_mask:0xf
v_add_f32_dpp v4, v219, v218 wave_shr:1 row_mask:0xf bank_mask:0xf
v_mfma_f32_16x16x32_bf16 v[228:231], v[28:31], v[132:135], v[228:231]
v_add_f32_dpp v6, v5, v217 wave_ror:1 row_mask:0xf bank_mask:0xf
v_add_f32_dpp v6, v4, v217 wave_shr:1 row_mask:0xf bank_mask:0xf
s_waitcnt lgkmcnt(12)
v_mfma_f32_16x16x32_bf16 v[228:231], v[24:27], v[140:143], v[228:231]
v_add_f32_dpp v8, v7, v216 wave_ror:1 row_mask:0xf bank_mask:0xf
v_add_f32_dpp v8, v6, v216 wave_shr:1 row_mask:0xf bank_mask:0xf
v_mfma_f32_16x16x32_bf16 v[232:235], v[52:55], v[88:91], 0
ds_read_b64_tr_b16 v[156:157], v2 offset:2208
ds_read_b64_tr_b16 v[158:159], v2 offset:2176
v_mfma_f32_16x16x32_bf16 v[232:235], v[48:51], v[96:99], v[232:235]
v_add_f32_dpp v5, v219, v222 wave_ror:1 row_mask:0xf bank_mask:0xf
v_add_f32_dpp v5, v223, v222 wave_shr:1 row_mask:0xf bank_mask:0xf
v_mfma_f32_16x16x32_bf16 v[232:235], v[44:47], v[104:107], v[232:235]
v_add_f32_dpp v7, v4, v221 wave_ror:1 row_mask:0xf bank_mask:0xf
v_add_f32_dpp v7, v5, v221 wave_shr:1 row_mask:0xf bank_mask:0xf
v_mfma_f32_16x16x32_bf16 v[232:235], v[40:43], v[112:115], v[232:235]
v_add_f32_dpp v9, v6, v220 wave_ror:1 row_mask:0xf bank_mask:0xf
v_add_f32_dpp v9, v7, v220 wave_shr:1 row_mask:0xf bank_mask:0xf
v_mfma_f32_16x16x32_bf16 v[232:235], v[36:39], v[120:123], v[232:235]
v_cvt_pk_bf16_f32 v10, v8, v9
ds_write_b16 v3, v10 offset:1280
v_mfma_f32_16x16x32_bf16 v[232:235], v[32:35], v[128:131], v[232:235]
ds_write_b16_d16_hi v3, v10 offset:1408
v_add_f32_dpp v4, v223, v226 wave_ror:1 row_mask:0xf bank_mask:0xf
v_mfma_f32_16x16x32_bf16 v[232:235], v[28:31], v[136:139], v[232:235]
v_add_f32_dpp v4, v227, v226 wave_shr:1 row_mask:0xf bank_mask:0xf
v_add_f32_dpp v6, v5, v225 wave_ror:1 row_mask:0xf bank_mask:0xf
s_waitcnt lgkmcnt(12)
v_mfma_f32_16x16x32_bf16 v[232:235], v[24:27], v[144:147], v[232:235]
v_add_f32_dpp v6, v4, v225 wave_shr:1 row_mask:0xf bank_mask:0xf
v_add_f32_dpp v8, v7, v224 wave_ror:1 row_mask:0xf bank_mask:0xf
v_mfma_f32_16x16x32_bf16 v[236:239], v[52:55], v[92:95], 0
ds_read_b64_tr_b16 v[160:161], v2 offset:2336
ds_read_b64_tr_b16 v[162:163], v2 offset:2304
v_mfma_f32_16x16x32_bf16 v[236:239], v[48:51], v[100:103], v[236:239]
v_add_f32_dpp v8, v6, v224 wave_shr:1 row_mask:0xf bank_mask:0xf
v_add_f32_dpp v5, v227, v230 wave_ror:1 row_mask:0xf bank_mask:0xf
v_mfma_f32_16x16x32_bf16 v[236:239], v[44:47], v[108:111], v[236:239]
v_add_f32_dpp v5, v231, v230 wave_shr:1 row_mask:0xf bank_mask:0xf
v_add_f32_dpp v7, v4, v229 wave_ror:1 row_mask:0xf bank_mask:0xf
v_mfma_f32_16x16x32_bf16 v[236:239], v[40:43], v[116:119], v[236:239]
v_add_f32_dpp v7, v5, v229 wave_shr:1 row_mask:0xf bank_mask:0xf
v_add_f32_dpp v9, v6, v228 wave_ror:1 row_mask:0xf bank_mask:0xf
v_mfma_f32_16x16x32_bf16 v[236:239], v[36:39], v[124:127], v[236:239]
v_add_f32_dpp v9, v7, v228 wave_shr:1 row_mask:0xf bank_mask:0xf
v_cvt_pk_bf16_f32 v10, v8, v9
v_mfma_f32_16x16x32_bf16 v[236:239], v[32:35], v[132:135], v[236:239]
ds_write_b16 v3, v10 offset:1536
ds_write_b16_d16_hi v3, v10 offset:1664
v_mfma_f32_16x16x32_bf16 v[236:239], v[28:31], v[140:143], v[236:239]
s_waitcnt lgkmcnt(14)
v_mfma_f32_16x16x32_bf16 v[236:239], v[24:27], v[148:151], v[236:239]
v_add_f32_dpp v4, v231, v234 wave_ror:1 row_mask:0xf bank_mask:0xf
v_add_f32_dpp v4, v235, v234 wave_shr:1 row_mask:0xf bank_mask:0xf
v_mfma_f32_16x16x32_bf16 v[240:243], v[56:59], v[88:91], 0
ds_read_b64_tr_b16 v[164:165], v2 offset:2464
ds_read_b64_tr_b16 v[166:167], v2 offset:2432
v_mfma_f32_16x16x32_bf16 v[240:243], v[52:55], v[96:99], v[240:243]
v_add_f32_dpp v6, v5, v233 wave_ror:1 row_mask:0xf bank_mask:0xf
v_add_f32_dpp v6, v4, v233 wave_shr:1 row_mask:0xf bank_mask:0xf
v_mfma_f32_16x16x32_bf16 v[240:243], v[48:51], v[104:107], v[240:243]
v_add_f32_dpp v8, v7, v232 wave_ror:1 row_mask:0xf bank_mask:0xf
v_add_f32_dpp v8, v6, v232 wave_shr:1 row_mask:0xf bank_mask:0xf
v_mfma_f32_16x16x32_bf16 v[240:243], v[44:47], v[112:115], v[240:243]
v_mfma_f32_16x16x32_bf16 v[240:243], v[40:43], v[120:123], v[240:243]
v_mfma_f32_16x16x32_bf16 v[240:243], v[36:39], v[128:131], v[240:243]
v_mfma_f32_16x16x32_bf16 v[240:243], v[32:35], v[136:139], v[240:243]
v_mfma_f32_16x16x32_bf16 v[240:243], v[28:31], v[144:147], v[240:243]
v_add_f32_dpp v5, v235, v238 wave_ror:1 row_mask:0xf bank_mask:0xf
v_add_f32_dpp v5, v239, v238 wave_shr:1 row_mask:0xf bank_mask:0xf
s_waitcnt lgkmcnt(12)
v_mfma_f32_16x16x32_bf16 v[240:243], v[24:27], v[152:155], v[240:243]
v_add_f32_dpp v7, v4, v237 wave_ror:1 row_mask:0xf bank_mask:0xf
v_add_f32_dpp v7, v5, v237 wave_shr:1 row_mask:0xf bank_mask:0xf
v_mfma_f32_16x16x32_bf16 v[244:247], v[56:59], v[92:95], 0
ds_read_b64_tr_b16 v[168:169], v2 offset:2592
ds_read_b64_tr_b16 v[170:171], v2 offset:2560
v_mfma_f32_16x16x32_bf16 v[244:247], v[52:55], v[100:103], v[244:247]
v_add_f32_dpp v9, v6, v236 wave_ror:1 row_mask:0xf bank_mask:0xf
v_add_f32_dpp v9, v7, v236 wave_shr:1 row_mask:0xf bank_mask:0xf
v_mfma_f32_16x16x32_bf16 v[244:247], v[48:51], v[108:111], v[244:247]
v_cvt_pk_bf16_f32 v10, v8, v9
ds_write_b16 v3, v10 offset:1792
v_mfma_f32_16x16x32_bf16 v[244:247], v[44:47], v[116:119], v[244:247]
ds_write_b16_d16_hi v3, v10 offset:1920
v_mfma_f32_16x16x32_bf16 v[244:247], v[40:43], v[124:127], v[244:247]
v_mfma_f32_16x16x32_bf16 v[244:247], v[36:39], v[132:135], v[244:247]
v_mfma_f32_16x16x32_bf16 v[244:247], v[32:35], v[140:143], v[244:247]
v_mfma_f32_16x16x32_bf16 v[244:247], v[28:31], v[148:151], v[244:247]
v_add_f32_dpp v4, v239, v242 wave_ror:1 row_mask:0xf bank_mask:0xf
v_add_f32_dpp v4, v243, v242 wave_shr:1 row_mask:0xf bank_mask:0xf
s_waitcnt lgkmcnt(12)
v_mfma_f32_16x16x32_bf16 v[244:247], v[24:27], v[156:159], v[244:247]
v_add_f32_dpp v6, v5, v241 wave_ror:1 row_mask:0xf bank_mask:0xf
v_add_f32_dpp v6, v4, v241 wave_shr:1 row_mask:0xf bank_mask:0xf
v_mfma_f32_16x16x32_bf16 v[248:251], v[60:63], v[88:91], 0
ds_read_b64_tr_b16 v[172:173], v2 offset:2720
ds_read_b64_tr_b16 v[174:175], v2 offset:2688
v_mfma_f32_16x16x32_bf16 v[248:251], v[56:59], v[96:99], v[248:251]
v_add_f32_dpp v8, v7, v240 wave_ror:1 row_mask:0xf bank_mask:0xf
v_add_f32_dpp v8, v6, v240 wave_shr:1 row_mask:0xf bank_mask:0xf
v_mfma_f32_16x16x32_bf16 v[248:251], v[52:55], v[104:107], v[248:251]
v_mfma_f32_16x16x32_bf16 v[248:251], v[48:51], v[112:115], v[248:251]
v_mfma_f32_16x16x32_bf16 v[248:251], v[44:47], v[120:123], v[248:251]
v_mfma_f32_16x16x32_bf16 v[248:251], v[40:43], v[128:131], v[248:251]
v_mfma_f32_16x16x32_bf16 v[248:251], v[36:39], v[136:139], v[248:251]
v_mfma_f32_16x16x32_bf16 v[248:251], v[32:35], v[144:147], v[248:251]
v_add_f32_dpp v5, v243, v246 wave_ror:1 row_mask:0xf bank_mask:0xf
v_add_f32_dpp v5, v247, v246 wave_shr:1 row_mask:0xf bank_mask:0xf
v_mfma_f32_16x16x32_bf16 v[248:251], v[28:31], v[152:155], v[248:251]
v_add_f32_dpp v7, v4, v245 wave_ror:1 row_mask:0xf bank_mask:0xf
v_add_f32_dpp v7, v5, v245 wave_shr:1 row_mask:0xf bank_mask:0xf
s_waitcnt lgkmcnt(10)
v_mfma_f32_16x16x32_bf16 v[248:251], v[24:27], v[160:163], v[248:251]
v_add_f32_dpp v9, v6, v244 wave_ror:1 row_mask:0xf bank_mask:0xf
v_add_f32_dpp v9, v7, v244 wave_shr:1 row_mask:0xf bank_mask:0xf
v_mfma_f32_16x16x32_bf16 v[252:255], v[60:63], v[92:95], 0
ds_read_b64_tr_b16 v[176:177], v2 offset:2848
ds_read_b64_tr_b16 v[178:179], v2 offset:2816
v_mfma_f32_16x16x32_bf16 v[252:255], v[56:59], v[100:103], v[252:255]
v_cvt_pk_bf16_f32 v10, v8, v9
ds_write_b16 v3, v10 offset:2048
v_mfma_f32_16x16x32_bf16 v[252:255], v[52:55], v[108:111], v[252:255]
ds_write_b16_d16_hi v3, v10 offset:2176
v_mfma_f32_16x16x32_bf16 v[252:255], v[48:51], v[116:119], v[252:255]
v_mfma_f32_16x16x32_bf16 v[252:255], v[44:47], v[124:127], v[252:255]
v_mfma_f32_16x16x32_bf16 v[252:255], v[40:43], v[132:135], v[252:255]
v_mfma_f32_16x16x32_bf16 v[252:255], v[36:39], v[140:143], v[252:255]
v_mfma_f32_16x16x32_bf16 v[252:255], v[32:35], v[148:151], v[252:255]
v_add_f32_dpp v4, v247, v250 wave_ror:1 row_mask:0xf bank_mask:0xf
v_add_f32_dpp v4, v251, v250 wave_shr:1 row_mask:0xf bank_mask:0xf
v_mfma_f32_16x16x32_bf16 v[252:255], v[28:31], v[156:159], v[252:255]
v_add_f32_dpp v6, v5, v249 wave_ror:1 row_mask:0xf bank_mask:0xf
v_add_f32_dpp v6, v4, v249 wave_shr:1 row_mask:0xf bank_mask:0xf
s_waitcnt lgkmcnt(10)
v_mfma_f32_16x16x32_bf16 v[252:255], v[24:27], v[164:167], v[252:255]
v_add_f32_dpp v8, v7, v248 wave_ror:1 row_mask:0xf bank_mask:0xf
v_add_f32_dpp v8, v6, v248 wave_shr:1 row_mask:0xf bank_mask:0xf
v_mfma_f32_16x16x32_bf16 v[216:219], v[64:67], v[88:91], 0
ds_read_b64_tr_b16 v[180:181], v2 offset:2976
ds_read_b64_tr_b16 v[182:183], v2 offset:2944
v_mfma_f32_16x16x32_bf16 v[216:219], v[60:63], v[96:99], v[216:219]
v_mfma_f32_16x16x32_bf16 v[216:219], v[56:59], v[104:107], v[216:219]
v_mfma_f32_16x16x32_bf16 v[216:219], v[52:55], v[112:115], v[216:219]
v_mfma_f32_16x16x32_bf16 v[216:219], v[48:51], v[120:123], v[216:219]
v_mfma_f32_16x16x32_bf16 v[216:219], v[44:47], v[128:131], v[216:219]
v_mfma_f32_16x16x32_bf16 v[216:219], v[40:43], v[136:139], v[216:219]
v_mfma_f32_16x16x32_bf16 v[216:219], v[36:39], v[144:147], v[216:219]
v_add_f32_dpp v5, v251, v254 wave_ror:1 row_mask:0xf bank_mask:0xf
v_add_f32_dpp v5, v255, v254 wave_shr:1 row_mask:0xf bank_mask:0xf
v_mfma_f32_16x16x32_bf16 v[216:219], v[32:35], v[152:155], v[216:219]
v_add_f32_dpp v7, v4, v253 wave_ror:1 row_mask:0xf bank_mask:0xf
v_add_f32_dpp v7, v5, v253 wave_shr:1 row_mask:0xf bank_mask:0xf
v_mfma_f32_16x16x32_bf16 v[216:219], v[28:31], v[160:163], v[216:219]
v_add_f32_dpp v9, v6, v252 wave_ror:1 row_mask:0xf bank_mask:0xf
v_add_f32_dpp v9, v7, v252 wave_shr:1 row_mask:0xf bank_mask:0xf
s_waitcnt lgkmcnt(10)
v_mfma_f32_16x16x32_bf16 v[216:219], v[24:27], v[168:171], v[216:219]
v_cvt_pk_bf16_f32 v10, v8, v9
ds_write_b16 v3, v10 offset:2304
v_mfma_f32_16x16x32_bf16 v[220:223], v[64:67], v[92:95], 0
s_waitcnt vmcnt(1)
ds_read_b64_tr_b16 v[184:185], v2 offset:3104
ds_read_b64_tr_b16 v[186:187], v2 offset:3072
v_mfma_f32_16x16x32_bf16 v[220:223], v[60:63], v[100:103], v[220:223]
ds_write_b16_d16_hi v3, v10 offset:2432
v_mfma_f32_16x16x32_bf16 v[220:223], v[56:59], v[108:111], v[220:223]
v_mfma_f32_16x16x32_bf16 v[220:223], v[52:55], v[116:119], v[220:223]
v_mfma_f32_16x16x32_bf16 v[220:223], v[48:51], v[124:127], v[220:223]
v_mfma_f32_16x16x32_bf16 v[220:223], v[44:47], v[132:135], v[220:223]
v_mfma_f32_16x16x32_bf16 v[220:223], v[40:43], v[140:143], v[220:223]
v_mfma_f32_16x16x32_bf16 v[220:223], v[36:39], v[148:151], v[220:223]
v_add_f32_dpp v4, v255, v218 wave_ror:1 row_mask:0xf bank_mask:0xf
v_add_f32_dpp v4, v219, v218 wave_shr:1 row_mask:0xf bank_mask:0xf
v_mfma_f32_16x16x32_bf16 v[220:223], v[32:35], v[156:159], v[220:223]
v_add_f32_dpp v6, v5, v217 wave_ror:1 row_mask:0xf bank_mask:0xf
v_add_f32_dpp v6, v4, v217 wave_shr:1 row_mask:0xf bank_mask:0xf
v_mfma_f32_16x16x32_bf16 v[220:223], v[28:31], v[164:167], v[220:223]
v_add_f32_dpp v8, v7, v216 wave_ror:1 row_mask:0xf bank_mask:0xf
v_add_f32_dpp v8, v6, v216 wave_shr:1 row_mask:0xf bank_mask:0xf
s_waitcnt lgkmcnt(10)
v_mfma_f32_16x16x32_bf16 v[220:223], v[24:27], v[172:175], v[220:223]
v_mfma_f32_16x16x32_bf16 v[224:227], v[68:71], v[88:91], 0
ds_read_b64_tr_b16 v[188:189], v2 offset:3232
ds_read_b64_tr_b16 v[190:191], v2 offset:3200
v_mfma_f32_16x16x32_bf16 v[224:227], v[64:67], v[96:99], v[224:227]
v_mfma_f32_16x16x32_bf16 v[224:227], v[60:63], v[104:107], v[224:227]
v_mfma_f32_16x16x32_bf16 v[224:227], v[56:59], v[112:115], v[224:227]
v_mfma_f32_16x16x32_bf16 v[224:227], v[52:55], v[120:123], v[224:227]
v_mfma_f32_16x16x32_bf16 v[224:227], v[48:51], v[128:131], v[224:227]
v_mfma_f32_16x16x32_bf16 v[224:227], v[44:47], v[136:139], v[224:227]
v_mfma_f32_16x16x32_bf16 v[224:227], v[40:43], v[144:147], v[224:227]
v_add_f32_dpp v5, v219, v222 wave_ror:1 row_mask:0xf bank_mask:0xf
v_add_f32_dpp v5, v223, v222 wave_shr:1 row_mask:0xf bank_mask:0xf
v_mfma_f32_16x16x32_bf16 v[224:227], v[36:39], v[152:155], v[224:227]
v_add_f32_dpp v7, v4, v221 wave_ror:1 row_mask:0xf bank_mask:0xf
v_add_f32_dpp v7, v5, v221 wave_shr:1 row_mask:0xf bank_mask:0xf
v_mfma_f32_16x16x32_bf16 v[224:227], v[32:35], v[160:163], v[224:227]
v_add_f32_dpp v9, v6, v220 wave_ror:1 row_mask:0xf bank_mask:0xf
v_add_f32_dpp v9, v7, v220 wave_shr:1 row_mask:0xf bank_mask:0xf
v_mfma_f32_16x16x32_bf16 v[224:227], v[28:31], v[168:171], v[224:227]
v_cvt_pk_bf16_f32 v10, v8, v9
ds_write_b16 v3, v10 offset:2560
s_waitcnt lgkmcnt(11)
v_mfma_f32_16x16x32_bf16 v[224:227], v[24:27], v[176:179], v[224:227]
ds_write_b16_d16_hi v3, v10 offset:2688
v_mfma_f32_16x16x32_bf16 v[228:231], v[68:71], v[92:95], 0
ds_read_b64_tr_b16 v[192:193], v2 offset:3360
ds_read_b64_tr_b16 v[194:195], v2 offset:3328
v_mfma_f32_16x16x32_bf16 v[228:231], v[64:67], v[100:103], v[228:231]
v_mfma_f32_16x16x32_bf16 v[228:231], v[60:63], v[108:111], v[228:231]
v_mfma_f32_16x16x32_bf16 v[228:231], v[56:59], v[116:119], v[228:231]
v_mfma_f32_16x16x32_bf16 v[228:231], v[52:55], v[124:127], v[228:231]
v_mfma_f32_16x16x32_bf16 v[228:231], v[48:51], v[132:135], v[228:231]
v_mfma_f32_16x16x32_bf16 v[228:231], v[44:47], v[140:143], v[228:231]
v_mfma_f32_16x16x32_bf16 v[228:231], v[40:43], v[148:151], v[228:231]
v_add_f32_dpp v4, v223, v226 wave_ror:1 row_mask:0xf bank_mask:0xf
v_add_f32_dpp v4, v227, v226 wave_shr:1 row_mask:0xf bank_mask:0xf
v_mfma_f32_16x16x32_bf16 v[228:231], v[36:39], v[156:159], v[228:231]
v_add_f32_dpp v6, v5, v225 wave_ror:1 row_mask:0xf bank_mask:0xf
v_add_f32_dpp v6, v4, v225 wave_shr:1 row_mask:0xf bank_mask:0xf
v_mfma_f32_16x16x32_bf16 v[228:231], v[32:35], v[164:167], v[228:231]
v_add_f32_dpp v8, v7, v224 wave_ror:1 row_mask:0xf bank_mask:0xf
v_add_f32_dpp v8, v6, v224 wave_shr:1 row_mask:0xf bank_mask:0xf
v_mfma_f32_16x16x32_bf16 v[228:231], v[28:31], v[172:175], v[228:231]
s_waitcnt lgkmcnt(10)
v_mfma_f32_16x16x32_bf16 v[228:231], v[24:27], v[180:183], v[228:231]
v_mfma_f32_16x16x32_bf16 v[232:235], v[72:75], v[88:91], 0
ds_read_b64_tr_b16 v[196:197], v2 offset:3488
ds_read_b64_tr_b16 v[198:199], v2 offset:3456
v_mfma_f32_16x16x32_bf16 v[232:235], v[68:71], v[96:99], v[232:235]
v_mfma_f32_16x16x32_bf16 v[232:235], v[64:67], v[104:107], v[232:235]
v_mfma_f32_16x16x32_bf16 v[232:235], v[60:63], v[112:115], v[232:235]
v_mfma_f32_16x16x32_bf16 v[232:235], v[56:59], v[120:123], v[232:235]
v_mfma_f32_16x16x32_bf16 v[232:235], v[52:55], v[128:131], v[232:235]
v_mfma_f32_16x16x32_bf16 v[232:235], v[48:51], v[136:139], v[232:235]
v_mfma_f32_16x16x32_bf16 v[232:235], v[44:47], v[144:147], v[232:235]
v_add_f32_dpp v5, v227, v230 wave_ror:1 row_mask:0xf bank_mask:0xf
v_add_f32_dpp v5, v231, v230 wave_shr:1 row_mask:0xf bank_mask:0xf
v_mfma_f32_16x16x32_bf16 v[232:235], v[40:43], v[152:155], v[232:235]
v_add_f32_dpp v7, v4, v229 wave_ror:1 row_mask:0xf bank_mask:0xf
v_add_f32_dpp v7, v5, v229 wave_shr:1 row_mask:0xf bank_mask:0xf
v_mfma_f32_16x16x32_bf16 v[232:235], v[36:39], v[160:163], v[232:235]
v_add_f32_dpp v9, v6, v228 wave_ror:1 row_mask:0xf bank_mask:0xf
v_add_f32_dpp v9, v7, v228 wave_shr:1 row_mask:0xf bank_mask:0xf
v_mfma_f32_16x16x32_bf16 v[232:235], v[32:35], v[168:171], v[232:235]
v_cvt_pk_bf16_f32 v10, v8, v9
ds_write_b16 v3, v10 offset:2816
v_mfma_f32_16x16x32_bf16 v[232:235], v[28:31], v[176:179], v[232:235]
ds_write_b16_d16_hi v3, v10 offset:2944
s_waitcnt lgkmcnt(11)
v_mfma_f32_16x16x32_bf16 v[232:235], v[24:27], v[184:187], v[232:235]
v_mfma_f32_16x16x32_bf16 v[236:239], v[72:75], v[92:95], 0
ds_read_b64_tr_b16 v[200:201], v2 offset:3616
ds_read_b64_tr_b16 v[202:203], v2 offset:3584
v_mfma_f32_16x16x32_bf16 v[236:239], v[68:71], v[100:103], v[236:239]
v_mfma_f32_16x16x32_bf16 v[236:239], v[64:67], v[108:111], v[236:239]
v_mfma_f32_16x16x32_bf16 v[236:239], v[60:63], v[116:119], v[236:239]
v_mfma_f32_16x16x32_bf16 v[236:239], v[56:59], v[124:127], v[236:239]
v_mfma_f32_16x16x32_bf16 v[236:239], v[52:55], v[132:135], v[236:239]
v_mfma_f32_16x16x32_bf16 v[236:239], v[48:51], v[140:143], v[236:239]
v_mfma_f32_16x16x32_bf16 v[236:239], v[44:47], v[148:151], v[236:239]
v_add_f32_dpp v4, v231, v234 wave_ror:1 row_mask:0xf bank_mask:0xf
v_add_f32_dpp v4, v235, v234 wave_shr:1 row_mask:0xf bank_mask:0xf
v_mfma_f32_16x16x32_bf16 v[236:239], v[40:43], v[156:159], v[236:239]
v_add_f32_dpp v6, v5, v233 wave_ror:1 row_mask:0xf bank_mask:0xf
v_add_f32_dpp v6, v4, v233 wave_shr:1 row_mask:0xf bank_mask:0xf
v_mfma_f32_16x16x32_bf16 v[236:239], v[36:39], v[164:167], v[236:239]
v_add_f32_dpp v8, v7, v232 wave_ror:1 row_mask:0xf bank_mask:0xf
v_add_f32_dpp v8, v6, v232 wave_shr:1 row_mask:0xf bank_mask:0xf
v_mfma_f32_16x16x32_bf16 v[236:239], v[32:35], v[172:175], v[236:239]
v_mfma_f32_16x16x32_bf16 v[236:239], v[28:31], v[180:183], v[236:239]
s_waitcnt lgkmcnt(10)
v_mfma_f32_16x16x32_bf16 v[236:239], v[24:27], v[188:191], v[236:239]
v_mfma_f32_16x16x32_bf16 v[240:243], v[76:79], v[88:91], 0
ds_read_b64_tr_b16 v[204:205], v2 offset:3744
ds_read_b64_tr_b16 v[206:207], v2 offset:3712
v_mfma_f32_16x16x32_bf16 v[240:243], v[72:75], v[96:99], v[240:243]
v_mfma_f32_16x16x32_bf16 v[240:243], v[68:71], v[104:107], v[240:243]
v_mfma_f32_16x16x32_bf16 v[240:243], v[64:67], v[112:115], v[240:243]
v_mfma_f32_16x16x32_bf16 v[240:243], v[60:63], v[120:123], v[240:243]
v_mfma_f32_16x16x32_bf16 v[240:243], v[56:59], v[128:131], v[240:243]
v_mfma_f32_16x16x32_bf16 v[240:243], v[52:55], v[136:139], v[240:243]
v_mfma_f32_16x16x32_bf16 v[240:243], v[48:51], v[144:147], v[240:243]
v_add_f32_dpp v5, v235, v238 wave_ror:1 row_mask:0xf bank_mask:0xf
v_add_f32_dpp v5, v239, v238 wave_shr:1 row_mask:0xf bank_mask:0xf
v_mfma_f32_16x16x32_bf16 v[240:243], v[44:47], v[152:155], v[240:243]
v_add_f32_dpp v7, v4, v237 wave_ror:1 row_mask:0xf bank_mask:0xf
v_add_f32_dpp v7, v5, v237 wave_shr:1 row_mask:0xf bank_mask:0xf
v_mfma_f32_16x16x32_bf16 v[240:243], v[40:43], v[160:163], v[240:243]
v_add_f32_dpp v9, v6, v236 wave_ror:1 row_mask:0xf bank_mask:0xf
v_add_f32_dpp v9, v7, v236 wave_shr:1 row_mask:0xf bank_mask:0xf
v_mfma_f32_16x16x32_bf16 v[240:243], v[36:39], v[168:171], v[240:243]
v_cvt_pk_bf16_f32 v10, v8, v9
ds_write_b16 v3, v10 offset:3072
v_mfma_f32_16x16x32_bf16 v[240:243], v[32:35], v[176:179], v[240:243]
ds_write_b16_d16_hi v3, v10 offset:3200
v_mfma_f32_16x16x32_bf16 v[240:243], v[28:31], v[184:187], v[240:243]
s_waitcnt lgkmcnt(10)
v_mfma_f32_16x16x32_bf16 v[240:243], v[24:27], v[192:195], v[240:243]
v_mfma_f32_16x16x32_bf16 v[244:247], v[76:79], v[92:95], 0
ds_read_b64_tr_b16 v[208:209], v2 offset:3872
ds_read_b64_tr_b16 v[210:211], v2 offset:3840
v_mfma_f32_16x16x32_bf16 v[244:247], v[72:75], v[100:103], v[244:247]
v_mfma_f32_16x16x32_bf16 v[244:247], v[68:71], v[108:111], v[244:247]
v_mfma_f32_16x16x32_bf16 v[244:247], v[64:67], v[116:119], v[244:247]
v_mfma_f32_16x16x32_bf16 v[244:247], v[60:63], v[124:127], v[244:247]
v_mfma_f32_16x16x32_bf16 v[244:247], v[56:59], v[132:135], v[244:247]
v_mfma_f32_16x16x32_bf16 v[244:247], v[52:55], v[140:143], v[244:247]
v_mfma_f32_16x16x32_bf16 v[244:247], v[48:51], v[148:151], v[244:247]
v_add_f32_dpp v4, v239, v242 wave_ror:1 row_mask:0xf bank_mask:0xf
v_add_f32_dpp v4, v243, v242 wave_shr:1 row_mask:0xf bank_mask:0xf
v_mfma_f32_16x16x32_bf16 v[244:247], v[44:47], v[156:159], v[244:247]
v_add_f32_dpp v6, v5, v241 wave_ror:1 row_mask:0xf bank_mask:0xf
v_add_f32_dpp v6, v4, v241 wave_shr:1 row_mask:0xf bank_mask:0xf
v_mfma_f32_16x16x32_bf16 v[244:247], v[40:43], v[164:167], v[244:247]
v_add_f32_dpp v8, v7, v240 wave_ror:1 row_mask:0xf bank_mask:0xf
v_add_f32_dpp v8, v6, v240 wave_shr:1 row_mask:0xf bank_mask:0xf
v_mfma_f32_16x16x32_bf16 v[244:247], v[36:39], v[172:175], v[244:247]
v_mfma_f32_16x16x32_bf16 v[244:247], v[32:35], v[180:183], v[244:247]
v_mfma_f32_16x16x32_bf16 v[244:247], v[28:31], v[188:191], v[244:247]
s_waitcnt lgkmcnt(10)
v_mfma_f32_16x16x32_bf16 v[244:247], v[24:27], v[196:199], v[244:247]
v_mfma_f32_16x16x32_bf16 v[248:251], v[80:83], v[88:91], 0
ds_read_b64_tr_b16 v[212:213], v2 offset:4000
ds_read_b64_tr_b16 v[214:215], v2 offset:3968
v_mfma_f32_16x16x32_bf16 v[248:251], v[76:79], v[96:99], v[248:251]
v_mfma_f32_16x16x32_bf16 v[248:251], v[72:75], v[104:107], v[248:251]
v_mfma_f32_16x16x32_bf16 v[248:251], v[68:71], v[112:115], v[248:251]
v_mfma_f32_16x16x32_bf16 v[248:251], v[64:67], v[120:123], v[248:251]
v_mfma_f32_16x16x32_bf16 v[248:251], v[60:63], v[128:131], v[248:251]
v_mfma_f32_16x16x32_bf16 v[248:251], v[56:59], v[136:139], v[248:251]
v_mfma_f32_16x16x32_bf16 v[248:251], v[52:55], v[144:147], v[248:251]
v_add_f32_dpp v5, v243, v246 wave_ror:1 row_mask:0xf bank_mask:0xf
v_add_f32_dpp v5, v247, v246 wave_shr:1 row_mask:0xf bank_mask:0xf
v_mfma_f32_16x16x32_bf16 v[248:251], v[48:51], v[152:155], v[248:251]
v_add_f32_dpp v7, v4, v245 wave_ror:1 row_mask:0xf bank_mask:0xf
v_add_f32_dpp v7, v5, v245 wave_shr:1 row_mask:0xf bank_mask:0xf
v_mfma_f32_16x16x32_bf16 v[248:251], v[44:47], v[160:163], v[248:251]
v_add_f32_dpp v9, v6, v244 wave_ror:1 row_mask:0xf bank_mask:0xf
v_add_f32_dpp v9, v7, v244 wave_shr:1 row_mask:0xf bank_mask:0xf
v_mfma_f32_16x16x32_bf16 v[248:251], v[40:43], v[168:171], v[248:251]
v_cvt_pk_bf16_f32 v10, v8, v9
ds_write_b16 v3, v10 offset:3328
v_mfma_f32_16x16x32_bf16 v[248:251], v[36:39], v[176:179], v[248:251]
ds_write_b16_d16_hi v3, v10 offset:3456
v_mfma_f32_16x16x32_bf16 v[248:251], v[32:35], v[184:187], v[248:251]
v_mfma_f32_16x16x32_bf16 v[248:251], v[28:31], v[192:195], v[248:251]
s_waitcnt lgkmcnt(10)
v_mfma_f32_16x16x32_bf16 v[248:251], v[24:27], v[200:203], v[248:251]
v_mfma_f32_16x16x32_bf16 v[252:255], v[80:83], v[92:95], 0
v_mfma_f32_16x16x32_bf16 v[252:255], v[76:79], v[100:103], v[252:255]
v_mfma_f32_16x16x32_bf16 v[252:255], v[72:75], v[108:111], v[252:255]
v_mfma_f32_16x16x32_bf16 v[252:255], v[68:71], v[116:119], v[252:255]
v_mfma_f32_16x16x32_bf16 v[252:255], v[64:67], v[124:127], v[252:255]
v_mfma_f32_16x16x32_bf16 v[252:255], v[60:63], v[132:135], v[252:255]
v_mfma_f32_16x16x32_bf16 v[252:255], v[56:59], v[140:143], v[252:255]
v_mfma_f32_16x16x32_bf16 v[252:255], v[52:55], v[148:151], v[252:255]
v_add_f32_dpp v4, v247, v250 wave_ror:1 row_mask:0xf bank_mask:0xf
v_add_f32_dpp v4, v251, v250 wave_shr:1 row_mask:0xf bank_mask:0xf
v_mfma_f32_16x16x32_bf16 v[252:255], v[48:51], v[156:159], v[252:255]
v_add_f32_dpp v6, v5, v249 wave_ror:1 row_mask:0xf bank_mask:0xf
v_add_f32_dpp v6, v4, v249 wave_shr:1 row_mask:0xf bank_mask:0xf
v_mfma_f32_16x16x32_bf16 v[252:255], v[44:47], v[164:167], v[252:255]
v_add_f32_dpp v8, v7, v248 wave_ror:1 row_mask:0xf bank_mask:0xf
v_add_f32_dpp v8, v6, v248 wave_shr:1 row_mask:0xf bank_mask:0xf
v_mfma_f32_16x16x32_bf16 v[252:255], v[40:43], v[172:175], v[252:255]
ds_read_b128 v[224:227], v12 offset:0
ds_read_b128 v[228:231], v12 offset:1024
v_mfma_f32_16x16x32_bf16 v[252:255], v[36:39], v[180:183], v[252:255]
ds_read_b128 v[232:235], v12 offset:2048
v_mfma_f32_16x16x32_bf16 v[252:255], v[32:35], v[188:191], v[252:255]
v_mfma_f32_16x16x32_bf16 v[252:255], v[28:31], v[196:199], v[252:255]
s_waitcnt lgkmcnt(11)
v_mfma_f32_16x16x32_bf16 v[252:255], v[24:27], v[204:207], v[252:255]
v_mfma_f32_16x16x32_bf16 v[216:219], v[84:87], v[88:91], 0
v_mfma_f32_16x16x32_bf16 v[216:219], v[80:83], v[96:99], v[216:219]
v_mfma_f32_16x16x32_bf16 v[216:219], v[76:79], v[104:107], v[216:219]
v_mfma_f32_16x16x32_bf16 v[216:219], v[72:75], v[112:115], v[216:219]
v_mfma_f32_16x16x32_bf16 v[216:219], v[68:71], v[120:123], v[216:219]
v_mfma_f32_16x16x32_bf16 v[216:219], v[64:67], v[128:131], v[216:219]
v_mfma_f32_16x16x32_bf16 v[216:219], v[60:63], v[136:139], v[216:219]
v_mfma_f32_16x16x32_bf16 v[216:219], v[56:59], v[144:147], v[216:219]
v_add_f32_dpp v5, v251, v254 wave_ror:1 row_mask:0xf bank_mask:0xf
v_add_f32_dpp v5, v255, v254 wave_shr:1 row_mask:0xf bank_mask:0xf
v_mfma_f32_16x16x32_bf16 v[216:219], v[52:55], v[152:155], v[216:219]
v_add_f32_dpp v7, v4, v253 wave_ror:1 row_mask:0xf bank_mask:0xf
v_add_f32_dpp v7, v5, v253 wave_shr:1 row_mask:0xf bank_mask:0xf
v_mfma_f32_16x16x32_bf16 v[216:219], v[48:51], v[160:163], v[216:219]
v_add_f32_dpp v9, v6, v252 wave_ror:1 row_mask:0xf bank_mask:0xf
v_add_f32_dpp v9, v7, v252 wave_shr:1 row_mask:0xf bank_mask:0xf
v_mfma_f32_16x16x32_bf16 v[216:219], v[44:47], v[168:171], v[216:219]
v_cvt_pk_bf16_f32 v10, v8, v9
ds_write_b16 v3, v10 offset:3584
v_mfma_f32_16x16x32_bf16 v[216:219], v[40:43], v[176:179], v[216:219]
ds_write_b16_d16_hi v3, v10 offset:3712
s_waitcnt lgkmcnt(4)
buffer_store_dwordx4 v[224:227], v18, s[16:19], s91 offen offset:0 sc1
v_mfma_f32_16x16x32_bf16 v[216:219], v[36:39], v[184:187], v[216:219]
s_waitcnt lgkmcnt(3)
buffer_store_dwordx4 v[228:231], v18, s[16:19], s91 offen offset:1024 sc1
s_waitcnt lgkmcnt(2)
buffer_store_dwordx4 v[232:235], v18, s[16:19], s91 offen offset:2048 sc1
v_mfma_f32_16x16x32_bf16 v[216:219], v[32:35], v[192:195], v[216:219]
v_mfma_f32_16x16x32_bf16 v[216:219], v[28:31], v[200:203], v[216:219]
v_mfma_f32_16x16x32_bf16 v[216:219], v[24:27], v[208:211], v[216:219]
v_mfma_f32_16x16x32_bf16 v[220:223], v[84:87], v[92:95], 0
v_mfma_f32_16x16x32_bf16 v[220:223], v[80:83], v[100:103], v[220:223]
v_mfma_f32_16x16x32_bf16 v[220:223], v[76:79], v[108:111], v[220:223]
v_mfma_f32_16x16x32_bf16 v[220:223], v[72:75], v[116:119], v[220:223]
v_mfma_f32_16x16x32_bf16 v[220:223], v[68:71], v[124:127], v[220:223]
v_mfma_f32_16x16x32_bf16 v[220:223], v[64:67], v[132:135], v[220:223]
v_mfma_f32_16x16x32_bf16 v[220:223], v[60:63], v[140:143], v[220:223]
v_mfma_f32_16x16x32_bf16 v[220:223], v[56:59], v[148:151], v[220:223]
v_add_f32_dpp v4, v255, v218 wave_ror:1 row_mask:0xf bank_mask:0xf
v_add_f32_dpp v4, v219, v218 wave_shr:1 row_mask:0xf bank_mask:0xf
v_mfma_f32_16x16x32_bf16 v[220:223], v[52:55], v[156:159], v[220:223]
v_add_f32_dpp v6, v5, v217 wave_ror:1 row_mask:0xf bank_mask:0xf
v_add_f32_dpp v6, v4, v217 wave_shr:1 row_mask:0xf bank_mask:0xf
v_mfma_f32_16x16x32_bf16 v[220:223], v[48:51], v[164:167], v[220:223]
v_add_f32_dpp v8, v7, v216 wave_ror:1 row_mask:0xf bank_mask:0xf
v_add_f32_dpp v8, v6, v216 wave_shr:1 row_mask:0xf bank_mask:0xf
v_mfma_f32_16x16x32_bf16 v[220:223], v[44:47], v[172:175], v[220:223]
v_mfma_f32_16x16x32_bf16 v[220:223], v[40:43], v[180:183], v[220:223]
v_mfma_f32_16x16x32_bf16 v[220:223], v[36:39], v[188:191], v[220:223]
v_mfma_f32_16x16x32_bf16 v[220:223], v[32:35], v[196:199], v[220:223]
v_mfma_f32_16x16x32_bf16 v[220:223], v[28:31], v[204:207], v[220:223]
v_mfma_f32_16x16x32_bf16 v[220:223], v[24:27], v[212:215], v[220:223]
s_nop 7
v_add_f32_dpp v5, v219, v222 wave_ror:1 row_mask:0xf bank_mask:0xf
v_add_f32_dpp v5, v223, v222 wave_shr:1 row_mask:0xf bank_mask:0xf
v_add_f32_dpp v7, v4, v221 wave_ror:1 row_mask:0xf bank_mask:0xf
s_nop 0
v_add_f32_dpp v7, v5, v221 wave_shr:1 row_mask:0xf bank_mask:0xf
v_add_f32_dpp v9, v6, v220 wave_ror:1 row_mask:0xf bank_mask:0xf
s_nop 0
v_add_f32_dpp v9, v7, v220 wave_shr:1 row_mask:0xf bank_mask:0xf
v_cvt_pk_bf16_f32 v10, v8, v9
ds_write_b16 v3, v10 offset:3840
ds_write_b16_d16_hi v3, v10 offset:3968
ds_read_b128 v[20:23], v12 offset:3072
s_waitcnt lgkmcnt(0)
buffer_store_dwordx4 v[20:23], v18, s[16:19], s91 offen offset:3072 sc1
s_nop 1
v_mov_b32 v20, 162308
v_mov_b32 v21, 1
s_lshl_b32 s63, s54, 2
s_add_u32 s95, s63, 228
s_lshl_b32 s95, s95, 7
s_waitcnt vmcnt(0)
s_mov_b64 exec, 1
ds_add_rtn_u32 v21, v20, v21
s_waitcnt lgkmcnt(0)
v_readfirstlane_b32 s63, v21
s_mov_b64 exec, -1
s_add_u32 s63, s63, 1
s_cmp_lg_u32 s63, s90
s_cbranch_scc1 L_ysig_4
s_mov_b32 s98, 1
s_atomic_add s98, s[16:17], s95 offset:0
s_atomic_add s98, s[16:17], s95 offset:128
s_atomic_add s98, s[16:17], s95 offset:256
s_atomic_add s98, s[16:17], s95 offset:384
L_ysig_4:
s_branch L_bjoin
L_pathW:
s_lshl1_add_u32 s64, s55, s53
s_sub_u32 s64, s64, 22
s_cmp_lt_u32 s55, 20
s_cselect_b32 s63, s55, s64
s_mul_i32 s65, s54, 48
s_add_u32 s62, s63, s65
s_lshr_b32 s92, s62, 3
s_and_b32 s64, s62, 3
s_lshl2_add_u32 s92, s92, s64
s_mul_i32 s92, s92, 10240
s_bfe_u32 s64, s62, 0x10002
s_mul_i32 s64, s64, 640
s_add_u32 s92, s92, s64
s_mul_i32 s91, s53, 8704
s_add_u32 s91, s91, 122880
v_add_u32 v151, 0, v0
v_mul_u32_u24 v152, 1639, v151
v_lshrrev_b32 v152, 16, v152
v_mul_u32_u24 v152, 640, v152
v_lshl_add_u32 v152, v151, 4, v152
s_add_u32 m0, s91, 0
s_nop 0
buffer_load_dwordx4 v152, s[48:51], s92 offen nt lds
v_add_u32 v151, 64, v0
v_mul_u32_u24 v152, 1639, v151
v_lshrrev_b32 v152, 16, v152
v_mul_u32_u24 v152, 640, v152
v_lshl_add_u32 v152, v151, 4, v152
s_add_u32 m0, s91, 1024
s_nop 0
buffer_load_dwordx4 v152, s[48:51], s92 offen nt lds
v_add_u32 v151, 128, v0
v_mul_u32_u24 v152, 1639, v151
v_lshrrev_b32 v152, 16, v152
v_mul_u32_u24 v152, 640, v152
v_lshl_add_u32 v152, v151, 4, v152
s_add_u32 m0, s91, 2048
s_nop 0
buffer_load_dwordx4 v152, s[48:51], s92 offen nt lds
v_add_u32 v151, 192, v0
v_mul_u32_u24 v152, 1639, v151
v_lshrrev_b32 v152, 16, v152
v_mul_u32_u24 v152, 640, v152
v_lshl_add_u32 v152, v151, 4, v152
s_add_u32 m0, s91, 3072
s_nop 0
buffer_load_dwordx4 v152, s[48:51], s92 offen nt lds
v_add_u32 v151, 256, v0
v_mul_u32_u24 v152, 1639, v151
v_lshrrev_b32 v152, 16, v152
v_mul_u32_u24 v152, 640, v152
v_lshl_add_u32 v152, v151, 4, v152
s_add_u32 m0, s91, 4096
s_nop 0
buffer_load_dwordx4 v152, s[48:51], s92 offen nt lds
s_lshl_b32 s88, s58, 7
s_mul_i32 s89, s58, 196608
s_add_u32 s58, s58, 1
s_cmp_eq_u32 s58, 10
s_cselect_b32 s58, 0, s58
s_add_u32 m0, s86, 40960
s_nop 0
buffer_load_dwordx4 v1, s[4:7], s88 offen lds
v_mov_b32 v56, 162304
s_add_u32 m0, s86, 41984
s_nop 0
buffer_load_dwordx4 v2, s[4:7], s88 offen lds
v_mov_b32 v58, 0
s_add_u32 m0, s86, 43008
s_add_u32 s88, s88, 20480
buffer_load_dwordx4 v1, s[4:7], s88 offen lds
v_mov_b32 v59, 0
s_add_u32 m0, s86, 44032
s_nop 0
buffer_load_dwordx4 v2, s[4:7], s88 offen lds
ds_write_b64 v56, v[58:59] offset:0
s_add_u32 m0, s86, 45056
s_add_u32 s88, s88, 20480
buffer_load_dwordx4 v1, s[4:7], s88 offen lds
ds_write_b64 v56, v[58:59] offset:8
s_add_u32 m0, s86, 46080
s_nop 0
buffer_load_dwordx4 v2, s[4:7], s88 offen lds
ds_write_b64 v56, v[58:59] offset:16
s_add_u32 m0, s87, 40960
s_nop 0
buffer_load_dwordx4 v5, s[8:11], s89 offen lds
s_waitcnt lgkmcnt(0)
s_waitcnt vmcnt(12)
s_barrier
s_add_u32 m0, s87, 41984
s_nop 0
buffer_load_dwordx4 v6, s[8:11], s89 offen lds
v_lshrrev_b32 v15, 5, v0
v_mul_u32_u24 v16, 4096, v15
v_bfe_u32 v14, v0, 4, 1
v_mul_u32_u24 v15, 1024, v14
v_add_u32 v16, v16, v15
v_bfe_u32 v15, v0, 2, 2
v_lshl_add_u32 v16, v15, 6, v16
s_add_u32 m0, s87, 43008
s_nop 0
buffer_load_dwordx4 v5, s[12:15], s89 offen lds
v_and_b32 v15, 3, v0
v_lshl_add_u32 v16, v15, 3, v16
v_lshlrev_b32 v14, 5, v14
s_min_u32 s64, s53, 1
s_lshl_b32 s64, s64, 8
s_add_u32 s63, s64, 24576
s_add_u32 m0, s87, 44032
s_nop 0
buffer_load_dwordx4 v6, s[12:15], s89 offen lds
v_add3_u32 v12, v16, v14, s63
v_xor_b32 v13, 32, v12
s_lshl_b32 s63, s56, 5
s_add_u32 s63, s63, s57
s_lshl_b32 s63, s63, 7
s_add_u32 s63, s63, s64
s_lshl_b32 s88, s58, 7
s_mul_i32 s89, s58, 196608
s_add_u32 s58, s58, 1
s_cmp_eq_u32 s58, 10
s_cselect_b32 s58, 0, s58
s_add_u32 m0, s86, 81920
s_nop 0
buffer_load_dwordx4 v1, s[4:7], s88 offen lds
s_add_u32 s63, s63, 57344
v_lshl_add_u32 v149, v0, 2, s63
s_mov_b32 s64, 0x3f803f80
ds_read_b64_tr_b16 v[60:61], v12 offset:0
ds_read_b64_tr_b16 v[62:63], v12 offset:512
ds_read_b64_tr_b16 v[64:65], v12 offset:8192
ds_read_b64_tr_b16 v[66:67], v12 offset:8704
s_add_u32 m0, s86, 82944
s_nop 0
buffer_load_dwordx4 v2, s[4:7], s88 offen lds
ds_read_b64_tr_b16 v[68:69], v12 offset:2048
ds_read_b64_tr_b16 v[70:71], v12 offset:2560
ds_read_b64_tr_b16 v[72:73], v12 offset:10240
ds_read_b64_tr_b16 v[74:75], v12 offset:10752
ds_read_b64_tr_b16 v[76:77], v13 offset:0
ds_read_b64_tr_b16 v[78:79], v13 offset:512
s_add_u32 m0, s86, 83968
s_add_u32 s88, s88, 20480
buffer_load_dwordx4 v1, s[4:7], s88 offen lds
ds_read_b64_tr_b16 v[80:81], v13 offset:8192
ds_read_b64_tr_b16 v[82:83], v13 offset:8704
ds_read_b64_tr_b16 v[84:85], v13 offset:2048
ds_read_b64_tr_b16 v[86:87], v13 offset:2560
ds_read_b64_tr_b16 v[88:89], v13 offset:10240
ds_read_b64_tr_b16 v[90:91], v13 offset:10752
s_add_u32 m0, s86, 84992
s_nop 0
buffer_load_dwordx4 v2, s[4:7], s88 offen lds
v_mov_b32 v14, 0
v_mov_b32 v15, 0
v_mov_b32 v16, 0
v_mov_b32 v17, 0
s_waitcnt lgkmcnt(8)
v_dot2c_f32_bf16 v14, s64, v60
v_dot2c_f32_bf16 v15, s64, v68
s_add_u32 m0, s86, 86016
s_add_u32 s88, s88, 20480
buffer_load_dwordx4 v1, s[4:7], s88 offen lds
v_dot2c_f32_bf16 v14, s64, v61
v_dot2c_f32_bf16 v15, s64, v69
v_dot2c_f32_bf16 v14, s64, v62
v_dot2c_f32_bf16 v15, s64, v70
v_dot2c_f32_bf16 v14, s64, v63
v_dot2c_f32_bf16 v15, s64, v71
s_add_u32 m0, s86, 87040
s_nop 0
buffer_load_dwordx4 v2, s[4:7], s88 offen lds
v_dot2c_f32_bf16 v14, s64, v64
v_dot2c_f32_bf16 v15, s64, v72
v_dot2c_f32_bf16 v14, s64, v65
v_dot2c_f32_bf16 v15, s64, v73
v_dot2c_f32_bf16 v14, s64, v66
v_dot2c_f32_bf16 v15, s64, v74
s_add_u32 m0, s87, 81920
s_nop 0
buffer_load_dwordx4 v5, s[8:11], s89 offen lds
v_dot2c_f32_bf16 v14, s64, v67
v_dot2c_f32_bf16 v15, s64, v75
s_waitcnt lgkmcnt(0)
v_dot2c_f32_bf16 v16, s64, v76
v_dot2c_f32_bf16 v17, s64, v84
v_dot2c_f32_bf16 v16, s64, v77
v_dot2c_f32_bf16 v17, s64, v85
s_add_u32 m0, s87, 82944
s_nop 0
buffer_load_dwordx4 v6, s[8:11], s89 offen lds
v_dot2c_f32_bf16 v16, s64, v78
v_dot2c_f32_bf16 v17, s64, v86
v_dot2c_f32_bf16 v16, s64, v79
v_dot2c_f32_bf16 v17, s64, v87
v_dot2c_f32_bf16 v16, s64, v80
v_dot2c_f32_bf16 v17, s64, v88
s_add_u32 m0, s87, 83968
s_nop 0
buffer_load_dwordx4 v5, s[12:15], s89 offen lds
v_dot2c_f32_bf16 v16, s64, v81
v_dot2c_f32_bf16 v17, s64, v89
v_dot2c_f32_bf16 v16, s64, v82
v_dot2c_f32_bf16 v17, s64, v90
v_dot2c_f32_bf16 v16, s64, v83
v_dot2c_f32_bf16 v17, s64, v91
s_add_u32 m0, s87, 84992
s_nop 0
buffer_load_dwordx4 v6, s[12:15], s89 offen lds
v_permlane32_swap_b32 v14, v16
v_permlane32_swap_b32 v15, v17
v_add_f32 v14, v14, v16
v_add_f32 v15, v15, v17
s_nop 1
v_permlane16_swap_b32 v14, v15
v_add_f32 v148, v14, v15
buffer_store_dword v148, v149, s[16:19], 0 offen sc1
s_cmp_lg_u32 s53, 3
s_cbranch_scc1 L_vi_15
s_mov_b64 exec, 1
buffer_load_dword v58, v59, s[44:47], 0 offen sc1
s_mov_b64 exec, -1
L_vi_15:
s_waitcnt vmcnt(11)
s_barrier
s_lshl_b32 s88, s58, 7
s_mul_i32 s89, s58, 196608
s_add_u32 s58, s58, 1
s_cmp_eq_u32 s58, 10
s_cselect_b32 s58, 0, s58
s_add_u32 m0, s86, 0
s_nop 0
buffer_load_dwordx4 v1, s[4:7], s88 offen lds
s_add_u32 m0, s86, 1024
s_nop 0
buffer_load_dwordx4 v2, s[4:7], s88 offen lds
s_add_u32 m0, s86, 2048
s_add_u32 s88, s88, 20480
buffer_load_dwordx4 v1, s[4:7], s88 offen lds
s_add_u32 m0, s86, 3072
s_nop 0
buffer_load_dwordx4 v2, s[4:7], s88 offen lds
s_add_u32 m0, s86, 4096
s_add_u32 s88, s88, 20480
buffer_load_dwordx4 v1, s[4:7], s88 offen lds
s_add_u32 m0, s86, 5120
s_nop 0
buffer_load_dwordx4 v2, s[4:7], s88 offen lds
s_add_u32 m0, s87, 0
s_nop 0
buffer_load_dwordx4 v5, s[8:11], s89 offen lds
s_add_u32 m0, s87, 1024
s_nop 0
buffer_load_dwordx4 v6, s[8:11], s89 offen lds
s_add_u32 m0, s87, 2048
s_nop 0
buffer_load_dwordx4 v5, s[12:15], s89 offen lds
s_add_u32 m0, s87, 3072
s_nop 0
buffer_load_dwordx4 v6, s[12:15], s89 offen lds
s_waitcnt vmcnt(9)
s_cmp_lg_u32 s53, 3
s_cbranch_scc1 L_vcskip_18
s_mov_b64 exec, 1
s_mov_b32 s67, 0
L_vc_16:
v_cmp_le_u32 vcc, 1, v58
s_nop 0
s_cmp_eq_u64 vcc, exec
s_cbranch_scc1 L_vcok_17
s_sleep 8
buffer_load_dword v58, v59, s[44:47], 0 offen sc1
s_add_u32 s67, s67, 1
s_cmp_lt_u32 s67, 131072
s_waitcnt vmcnt(0)
s_cbranch_scc1 L_vc_16
L_vcok_17:
s_mov_b64 exec, -1
L_vcskip_18:
s_barrier
s_cmp_lg_u32 s53, 3
s_cbranch_scc1 L_w3_19
s_lshr_b32 s63, s61, 3
s_add_u32 s95, s63, 128
s_lshl_b32 s95, s95, 7
s_lshr_b32 s63, s57, 2
s_add_u32 s101, s63, 160
s_lshl_b32 s101, s101, 7
s_mov_b32 s98, 1
s_atomic_add s98, s[16:17], s95 offset:0
s_atomic_add s98, s[16:17], s101 offset:0
L_w3_19:
s_lshl_b32 s88, s58, 7
s_mul_i32 s89, s58, 196608
s_add_u32 s58, s58, 1
s_cmp_eq_u32 s58, 10
s_cselect_b32 s58, 0, s58
s_add_u32 m0, s86, 40960
s_nop 0
buffer_load_dwordx4 v1, s[4:7], s88 offen lds
v_bfe_u32 v20, v0, 2, 2
v_mul_u32_u24 v20, 640, v20
v_lshrrev_b32 v22, 4, v0
v_lshl_add_u32 v20, v22, 5, v20
v_and_b32 v21, 3, v0
v_lshl_add_u32 v20, v21, 3, v20
v_add_u32 v20, s91, v20
s_add_u32 m0, s86, 41984
s_nop 0
buffer_load_dwordx4 v2, s[4:7], s88 offen lds
s_bfe_u32 s94, s62, 0x10002
s_mul_i32 s94, s94, 196
s_lshr_b32 s64, s62, 3
s_add_u32 s94, s94, s64
s_mul_i32 s94, s94, 5120
s_and_b32 s64, s62, 3
s_add_u32 m0, s86, 43008
s_add_u32 s88, s88, 20480
buffer_load_dwordx4 v1, s[4:7], s88 offen lds
s_lshl_b32 s64, s64, 8
s_add_u32 s94, s94, s64
s_add_u32 s94, s94, 6553600
v_and_b32 v21, 15, v0
v_lshlrev_b32 v21, 4, v21
v_add_u32 v23, 0, v22
s_add_u32 m0, s86, 44032
s_nop 0
buffer_load_dwordx4 v2, s[4:7], s88 offen lds
v_mul_u32_u24 v150, 13, v23
v_lshrrev_b32 v150, 6, v150
v_mul_u32_u24 v150, 245760, v150
v_lshl_add_u32 v150, v23, 10, v150
v_add_u32 v150, v150, v21
v_add_u32 v23, 4, v22
s_add_u32 m0, s86, 45056
s_add_u32 s88, s88, 20480
buffer_load_dwordx4 v1, s[4:7], s88 offen lds
v_mul_u32_u24 v151, 13, v23
v_lshrrev_b32 v151, 6, v151
v_mul_u32_u24 v151, 245760, v151
v_lshl_add_u32 v151, v23, 10, v151
v_add_u32 v151, v151, v21
v_add_u32 v23, 8, v22
s_add_u32 m0, s86, 46080
s_nop 0
buffer_load_dwordx4 v2, s[4:7], s88 offen lds
v_mul_u32_u24 v152, 13, v23
v_lshrrev_b32 v152, 6, v152
v_mul_u32_u24 v152, 245760, v152
v_lshl_add_u32 v152, v23, 10, v152
v_add_u32 v152, v152, v21
v_add_u32 v23, 12, v22
v_mul_u32_u24 v153, 13, v23
s_add_u32 m0, s87, 40960
s_nop 0
buffer_load_dwordx4 v5, s[8:11], s89 offen lds
v_lshrrev_b32 v153, 6, v153
v_mul_u32_u24 v153, 245760, v153
v_lshl_add_u32 v153, v23, 10, v153
v_add_u32 v153, v153, v21
v_add_u32 v23, 16, v22
v_mul_u32_u24 v154, 13, v23
s_add_u32 m0, s87, 41984
s_nop 0
buffer_load_dwordx4 v6, s[8:11], s89 offen lds
v_lshrrev_b32 v154, 6, v154
v_mul_u32_u24 v154, 245760, v154
v_lshl_add_u32 v154, v23, 10, v154
v_add_u32 v154, v154, v21
ds_read_b64_tr_b16 v[96:97], v20 offset:0
s_add_u32 m0, s87, 43008
s_nop 0
buffer_load_dwordx4 v5, s[12:15], s89 offen lds
ds_read_b64_tr_b16 v[98:99], v20 offset:2560
ds_read_b64_tr_b16 v[100:101], v20 offset:128
ds_read_b64_tr_b16 v[102:103], v20 offset:2688
ds_read_b64_tr_b16 v[104:105], v20 offset:256
ds_read_b64_tr_b16 v[106:107], v20 offset:2816
ds_read_b64_tr_b16 v[108:109], v20 offset:384
s_add_u32 m0, s87, 44032
s_nop 0
buffer_load_dwordx4 v6, s[12:15], s89 offen lds
ds_read_b64_tr_b16 v[110:111], v20 offset:2944
ds_read_b64_tr_b16 v[112:113], v20 offset:512
ds_read_b64_tr_b16 v[114:115], v20 offset:3072
s_waitcnt lgkmcnt(0)
buffer_store_dwordx4 v[96:99], v150, s[16:19], s94 offen sc1
buffer_store_dwordx4 v[100:103], v151, s[16:19], s94 offen sc1
s_waitcnt vmcnt(12)
s_barrier
s_lshl_b32 s88, s58, 7
s_mul_i32 s89, s58, 196608
s_add_u32 s58, s58, 1
s_cmp_eq_u32 s58, 10
s_cselect_b32 s58, 0, s58
s_add_u32 m0, s86, 81920
s_nop 0
buffer_load_dwordx4 v1, s[4:7], s88 offen lds
buffer_store_dwordx4 v[104:107], v152, s[16:19], s94 offen sc1
s_add_u32 m0, s86, 82944
s_nop 0
buffer_load_dwordx4 v2, s[4:7], s88 offen lds
s_add_u32 m0, s86, 83968
s_add_u32 s88, s88, 20480
buffer_load_dwordx4 v1, s[4:7], s88 offen lds
s_add_u32 m0, s86, 84992
s_nop 0
buffer_load_dwordx4 v2, s[4:7], s88 offen lds
buffer_store_dwordx4 v[108:111], v153, s[16:19], s94 offen sc1
s_add_u32 m0, s86, 86016
s_add_u32 s88, s88, 20480
buffer_load_dwordx4 v1, s[4:7], s88 offen lds
s_add_u32 m0, s86, 87040
s_nop 0
buffer_load_dwordx4 v2, s[4:7], s88 offen lds
s_add_u32 m0, s87, 81920
s_nop 0
buffer_load_dwordx4 v5, s[8:11], s89 offen lds
buffer_store_dwordx4 v[112:115], v154, s[16:19], s94 offen sc1
s_add_u32 m0, s87, 82944
s_nop 0
buffer_load_dwordx4 v6, s[8:11], s89 offen lds
s_add_u32 m0, s87, 83968
s_nop 0
buffer_load_dwordx4 v5, s[12:15], s89 offen lds
s_add_u32 m0, s87, 84992
s_nop 0
buffer_load_dwordx4 v6, s[12:15], s89 offen lds
s_waitcnt vmcnt(15)
s_barrier
s_lshl_b32 s88, s58, 7
s_mul_i32 s89, s58, 196608
s_add_u32 s58, s58, 1
s_cmp_eq_u32 s58, 10
s_cselect_b32 s58, 0, s58
s_add_u32 m0, s86, 0
s_nop 0
buffer_load_dwordx4 v1, s[4:7], s88 offen lds
s_mul_i32 s93, s59, 81920
s_mul_i32 s65, s60, 160
s_add_u32 s93, s93, s65
s_add_u32 m0, s86, 1024
s_nop 0
buffer_load_dwordx4 v2, s[4:7], s88 offen lds
s_cmp_lg_u32 s53, 3
s_cbranch_scc1 L_xt_5
v_add_u32 v20, 0, v0
v_mul_u32_u24 v21, 6554, v20
v_lshrrev_b32 v21, 16, v21
v_mul_u32_u24 v21, 1120, v21
v_lshl_add_u32 v21, v20, 4, v21
s_mov_b32 m0, 148992
s_nop 0
buffer_load_dwordx4 v21, s[4:7], s93 offen lds
L_xt_5:
s_add_u32 m0, s86, 2048
s_add_u32 s88, s88, 20480
buffer_load_dwordx4 v1, s[4:7], s88 offen lds
s_add_u32 m0, s86, 3072
s_nop 0
buffer_load_dwordx4 v2, s[4:7], s88 offen lds
s_add_u32 m0, s86, 4096
s_add_u32 s88, s88, 20480
buffer_load_dwordx4 v1, s[4:7], s88 offen lds
s_add_u32 m0, s86, 5120
s_nop 0
buffer_load_dwordx4 v2, s[4:7], s88 offen lds
s_cmp_lg_u32 s53, 3
s_cbranch_scc1 L_xt_6
v_add_u32 v20, 64, v0
v_mul_u32_u24 v21, 6554, v20
v_lshrrev_b32 v21, 16, v21
v_mul_u32_u24 v21, 1120, v21
v_lshl_add_u32 v21, v20, 4, v21
s_mov_b32 m0, 150016
s_nop 0
buffer_load_dwordx4 v21, s[4:7], s93 offen lds
L_xt_6:
s_add_u32 m0, s87, 0
s_nop 0
buffer_load_dwordx4 v5, s[8:11], s89 offen lds
s_add_u32 m0, s87, 1024
s_nop 0
buffer_load_dwordx4 v6, s[8:11], s89 offen lds
s_add_u32 m0, s87, 2048
s_nop 0
buffer_load_dwordx4 v5, s[12:15], s89 offen lds
s_add_u32 m0, s87, 3072
s_nop 0
buffer_load_dwordx4 v6, s[12:15], s89 offen lds
s_waitcnt vmcnt(10)
s_lshr_b32 s63, s62, 3
s_mul_i32 s63, s63, 43
s_lshr_b32 s63, s63, 9
s_and_b32 s64, s62, 4
s_lshl2_add_u32 s63, s64, s63
s_add_u32 s96, s63, 196
s_lshl_b32 s96, s96, 7
s_mov_b32 s100, 1
s_atomic_add s100, s[16:17], s96 offset:0
s_atomic_add s100, s[16:17], s96 offset:512
s_atomic_add s100, s[16:17], s96 offset:1024
s_atomic_add s100, s[16:17], s96 offset:1536
s_barrier
s_lshl_b32 s88, s58, 7
s_mul_i32 s89, s58, 196608
s_add_u32 s58, s58, 1
s_cmp_eq_u32 s58, 10
s_cselect_b32 s58, 0, s58
s_add_u32 m0, s86, 40960
s_nop 0
buffer_load_dwordx4 v1, s[4:7], s88 offen lds
s_cmp_lg_u32 s53, 3
s_cbranch_scc1 L_xt_7
v_add_u32 v20, 128, v0
v_mul_u32_u24 v21, 6554, v20
v_lshrrev_b32 v21, 16, v21
v_mul_u32_u24 v21, 1120, v21
v_lshl_add_u32 v21, v20, 4, v21
s_mov_b32 m0, 151040
s_nop 0
buffer_load_dwordx4 v21, s[4:7], s93 offen lds
L_xt_7:
s_add_u32 m0, s86, 41984
s_nop 0
buffer_load_dwordx4 v2, s[4:7], s88 offen lds
s_add_u32 m0, s86, 43008
s_add_u32 s88, s88, 20480
buffer_load_dwordx4 v1, s[4:7], s88 offen lds
s_add_u32 m0, s86, 44032
s_nop 0
buffer_load_dwordx4 v2, s[4:7], s88 offen lds
s_cmp_lg_u32 s53, 3
s_cbranch_scc1 L_xt_8
v_add_u32 v20, 192, v0
v_mul_u32_u24 v21, 6554, v20
v_lshrrev_b32 v21, 16, v21
v_mul_u32_u24 v21, 1120, v21
v_lshl_add_u32 v21, v20, 4, v21
s_mov_b32 m0, 152064
s_nop 0
buffer_load_dwordx4 v21, s[4:7], s93 offen lds
L_xt_8:
s_add_u32 m0, s86, 45056
s_add_u32 s88, s88, 20480
buffer_load_dwordx4 v1, s[4:7], s88 offen lds
s_add_u32 m0, s86, 46080
s_nop 0
buffer_load_dwordx4 v2, s[4:7], s88 offen lds
s_add_u32 m0, s87, 40960
s_nop 0
buffer_load_dwordx4 v5, s[8:11], s89 offen lds
s_cmp_lg_u32 s53, 3
s_cbranch_scc1 L_xt_9
v_add_u32 v20, 256, v0
v_mul_u32_u24 v21, 6554, v20
v_lshrrev_b32 v21, 16, v21
v_mul_u32_u24 v21, 1120, v21
v_lshl_add_u32 v21, v20, 4, v21
s_mov_b32 m0, 153088
s_nop 0
buffer_load_dwordx4 v21, s[4:7], s93 offen lds
L_xt_9:
s_add_u32 m0, s87, 41984
s_nop 0
buffer_load_dwordx4 v6, s[8:11], s89 offen lds
s_add_u32 m0, s87, 43008
s_nop 0
buffer_load_dwordx4 v5, s[12:15], s89 offen lds
s_add_u32 m0, s87, 44032
s_nop 0
buffer_load_dwordx4 v6, s[12:15], s89 offen lds
s_mul_i32 s92, s53, 8704
s_add_u32 s92, s92, 122880
v_lshlrev_b32 v18, 4, v0
s_waitcnt vmcnt(10)
s_barrier
s_lshl_b32 s88, s58, 7
s_mul_i32 s89, s58, 196608
s_add_u32 s58, s58, 1
s_cmp_eq_u32 s58, 10
s_cselect_b32 s58, 0, s58
s_add_u32 m0, s86, 81920
s_nop 0
buffer_load_dwordx4 v1, s[4:7], s88 offen lds
s_cmp_lg_u32 s53, 3
s_cbranch_scc1 L_xt_10
v_add_u32 v20, 320, v0
v_mul_u32_u24 v21, 6554, v20
v_lshrrev_b32 v21, 16, v21
v_mul_u32_u24 v21, 1120, v21
v_lshl_add_u32 v21, v20, 4, v21
s_mov_b32 m0, 154112
s_nop 0
buffer_load_dwordx4 v21, s[4:7], s93 offen lds
L_xt_10:
s_add_u32 m0, s86, 82944
s_nop 0
buffer_load_dwordx4 v2, s[4:7], s88 offen lds
s_add_u32 m0, s86, 83968
s_add_u32 s88, s88, 20480
buffer_load_dwordx4 v1, s[4:7], s88 offen lds
s_add_u32 m0, s86, 84992
s_nop 0
buffer_load_dwordx4 v2, s[4:7], s88 offen lds
s_add_u32 m0, s86, 86016
s_add_u32 s88, s88, 20480
buffer_load_dwordx4 v1, s[4:7], s88 offen lds
s_add_u32 m0, s86, 87040
s_nop 0
buffer_load_dwordx4 v2, s[4:7], s88 offen lds
s_cmp_lg_u32 s53, 3
s_cbranch_scc1 L_xt_11
v_add_u32 v20, 384, v0
v_mul_u32_u24 v21, 6554, v20
v_lshrrev_b32 v21, 16, v21
v_mul_u32_u24 v21, 1120, v21
v_lshl_add_u32 v21, v20, 4, v21
s_mov_b32 m0, 155136
s_nop 0
buffer_load_dwordx4 v21, s[4:7], s93 offen lds
L_xt_11:
s_add_u32 m0, s87, 81920
s_nop 0
buffer_load_dwordx4 v5, s[8:11], s89 offen lds
s_add_u32 m0, s87, 82944
s_nop 0
buffer_load_dwordx4 v6, s[8:11], s89 offen lds
s_add_u32 m0, s87, 83968
s_nop 0
buffer_load_dwordx4 v5, s[12:15], s89 offen lds
s_add_u32 m0, s87, 84992
s_nop 0
buffer_load_dwordx4 v6, s[12:15], s89 offen lds
s_waitcnt vmcnt(10)
s_barrier
s_cmp_lg_u32 s53, 3
s_cbranch_scc1 L_w3_20
s_waitcnt lgkmcnt(0)
s_add_u32 s95, s56, 128
s_lshl_b32 s95, s95, 7
s_lshr_b32 s63, s57, 2
s_add_u32 s96, s63, 160
s_lshl_b32 s96, s96, 7
s_add_u32 s97, s59, 128
s_lshl_b32 s97, s97, 7
s_load_dword s98, s[16:17], s95 offset:0 glc
s_load_dword s99, s[16:17], s95 offset:128 glc
s_load_dword s100, s[16:17], s95 offset:256 glc
s_load_dword s101, s[16:17], s96 offset:0 glc
s_load_dword s3, s[16:17], s97 offset:0 glc
L_w3_20:
s_lshl_b32 s88, s58, 7
s_mul_i32 s89, s58, 196608
s_add_u32 s58, s58, 1
s_cmp_eq_u32 s58, 10
s_cselect_b32 s58, 0, s58
s_add_u32 m0, s86, 0
s_nop 0
buffer_load_dwordx4 v1, s[4:7], s88 offen lds
s_cmp_lg_u32 s53, 3
s_cbranch_scc1 L_xt_12
v_add_u32 v20, 448, v0
v_mul_u32_u24 v21, 6554, v20
v_lshrrev_b32 v21, 16, v21
v_mul_u32_u24 v21, 1120, v21
v_lshl_add_u32 v21, v20, 4, v21
s_mov_b32 m0, 156160
s_nop 0
buffer_load_dwordx4 v21, s[4:7], s93 offen lds
L_xt_12:
s_add_u32 m0, s86, 1024
s_nop 0
buffer_load_dwordx4 v2, s[4:7], s88 offen lds
s_add_u32 m0, s86, 2048
s_add_u32 s88, s88, 20480
buffer_load_dwordx4 v1, s[4:7], s88 offen lds
s_add_u32 m0, s86, 3072
s_nop 0
buffer_load_dwordx4 v2, s[4:7], s88 offen lds
s_cmp_lg_u32 s53, 3
s_cbranch_scc1 L_xt_13
v_add_u32 v20, 512, v0
v_mul_u32_u24 v21, 6554, v20
v_lshrrev_b32 v21, 16, v21
v_mul_u32_u24 v21, 1120, v21
v_lshl_add_u32 v21, v20, 4, v21
s_mov_b32 m0, 157184
s_nop 0
buffer_load_dwordx4 v21, s[4:7], s93 offen lds
L_xt_13:
s_add_u32 m0, s86, 4096
s_add_u32 s88, s88, 20480
buffer_load_dwordx4 v1, s[4:7], s88 offen lds
s_add_u32 m0, s86, 5120
s_nop 0
buffer_load_dwordx4 v2, s[4:7], s88 offen lds
s_add_u32 m0, s87, 0
s_nop 0
buffer_load_dwordx4 v5, s[8:11], s89 offen lds
s_cmp_lg_u32 s53, 3
s_cbranch_scc1 L_xt_14
v_add_u32 v20, 576, v0
v_mul_u32_u24 v21, 6554, v20
v_lshrrev_b32 v21, 16, v21
v_mul_u32_u24 v21, 1120, v21
v_lshl_add_u32 v21, v20, 4, v21
s_mov_b32 m0, 158208
s_nop 0
buffer_load_dwordx4 v21, s[4:7], s93 offen lds
L_xt_14:
s_add_u32 m0, s87, 1024
s_nop 0
buffer_load_dwordx4 v6, s[8:11], s89 offen lds
s_add_u32 m0, s87, 2048
s_nop 0
buffer_load_dwordx4 v5, s[12:15], s89 offen lds
s_add_u32 m0, s87, 3072
s_nop 0
buffer_load_dwordx4 v6, s[12:15], s89 offen lds
s_waitcnt vmcnt(10)
s_cmp_lg_u32 s53, 3
s_cbranch_scc1 L_w3_24
s_waitcnt lgkmcnt(0)
s_mov_b32 s67, 0
L_poll_21:
s_cmp_ge_u32 s98, 8
s_cbranch_scc0 L_again_22
s_cmp_ge_u32 s99, 8
s_cbranch_scc0 L_again_22
s_cmp_ge_u32 s100, 8
s_cbranch_scc0 L_again_22
s_cmp_ge_u32 s101, 10
s_cbranch_scc0 L_again_22
s_cmp_ge_u32 s3, 8
s_cbranch_scc1 L_pollok_23
L_again_22:
s_sleep 2
s_load_dword s98, s[16:17], s95 offset:0 glc
s_load_dword s99, s[16:17], s95 offset:128 glc
s_load_dword s100, s[16:17], s95 offset:256 glc
s_load_dword s101, s[16:17], s96 offset:0 glc
s_load_dword s3, s[16:17], s97 offset:0 glc
s_add_u32 s67, s67, 1
s_cmp_lt_u32 s67, 131072
s_waitcnt lgkmcnt(0)
s_cbranch_scc1 L_poll_21
L_pollok_23:
L_w3_24:
s_barrier
s_cmp_lg_u32 s53, 3
s_cbranch_scc1 L_w3_25
s_waitcnt lgkmcnt(0)
s_lshl_b32 s63, s54, 2
s_add_u32 s95, s63, 196
s_lshl_b32 s95, s95, 7
s_load_dword s98, s[16:17], s95 offset:0 glc
s_load_dword s99, s[16:17], s95 offset:128 glc
s_load_dword s100, s[16:17], s95 offset:256 glc
s_load_dword s101, s[16:17], s95 offset:384 glc
L_w3_25:
v_min_u32 v14, 47, v0
v_lshlrev_b32 v14, 3, v14
s_mul_i32 s64, s53, 384
v_add_u32 v14, s64, v14
s_lshl_b32 s63, s56, 9
s_add_u32 s63, s63, 40960
v_min_u32 v15, 31, v0
s_mul_i32 s64, s53, 32
v_add_u32 v15, s64, v15
v_lshlrev_b32 v15, 2, v15
s_lshl_b32 s64, s57, 7
s_add_u32 s64, s64, 57344
buffer_load_dwordx2 v[24:25], v14, s[16:19], s63 offen sc1
buffer_load_dword v26, v15, s[16:19], s64 offen sc1
s_add_u32 s64, s64, 12288
buffer_load_dword v27, v15, s[16:19], s64 offen sc1
s_add_u32 s64, s64, 12288
buffer_load_dword v28, v15, s[16:19], s64 offen sc1
s_add_u32 s64, s64, 12288
buffer_load_dword v29, v15, s[16:19], s64 offen sc1
s_add_u32 s64, s64, 12288
buffer_load_dword v30, v15, s[16:19], s64 offen sc1
s_add_u32 s64, s64, 12288
buffer_load_dword v31, v15, s[16:19], s64 offen sc1
s_add_u32 s64, s64, 12288
buffer_load_dword v32, v15, s[16:19], s64 offen sc1
s_add_u32 s64, s64, 12288
buffer_load_dword v33, v15, s[16:19], s64 offen sc1
s_add_u32 s64, s64, 12288
buffer_load_dword v34, v15, s[16:19], s64 offen sc1
s_add_u32 s64, s64, 12288
buffer_load_dword v35, v15, s[16:19], s64 offen sc1
s_waitcnt vmcnt(11)
s_cmp_lg_u32 s53, 3
s_cbranch_scc1 L_w3_29
s_waitcnt lgkmcnt(0)
s_mov_b32 s67, 0
L_poll_26:
s_cmp_ge_u32 s98, 48
s_cbranch_scc0 L_again_27
s_cmp_ge_u32 s99, 48
s_cbranch_scc0 L_again_27
s_cmp_ge_u32 s100, 48
s_cbranch_scc0 L_again_27
s_cmp_ge_u32 s101, 48
s_cbranch_scc1 L_pollok_28
L_again_27:
s_sleep 4
s_load_dword s98, s[16:17], s95 offset:0 glc
s_load_dword s99, s[16:17], s95 offset:128 glc
s_load_dword s100, s[16:17], s95 offset:256 glc
s_load_dword s101, s[16:17], s95 offset:384 glc
s_add_u32 s67, s67, 1
s_cmp_lt_u32 s67, 131072
s_waitcnt lgkmcnt(0)
s_cbranch_scc1 L_poll_26
L_pollok_28:
L_w3_29:
s_mul_i32 s100, s54, 3
s_lshr_b32 s100, s100, 1
s_mul_i32 s63, s53, 12
s_mul_i32 s64, s60, 49
s_add_u32 s64, s64, s63
s_mul_i32 s101, s64, 5120
s_add_u32 s101, s101, 6553600
s_mul_i32 s63, s53, 61440
s_sub_u32 s101, s101, s63
s_barrier
L_wpost:
s_setprio 3
v_add_u32 v14, 159232, v14
v_lshlrev_b32 v15, 1, v15
v_add_u32 v15, 160768, v15
s_waitcnt vmcnt(0)
ds_write_b64 v14, v[24:25]
v_add_f32 v26, v26, v31
v_add_f32 v27, v27, v32
v_add_f32 v28, v28, v33
v_add_f32 v29, v29, v34
v_add_f32 v30, v30, v35
v_add_f32 v26, v26, v29
v_add_f32 v27, v27, v30
v_add_f32 v26, v26, v28
v_add_f32 v26, v26, v27
v_cvt_pk_bf16_f32 v27, v26, v26
v_and_b32 v27, 0xffff0000, v27
v_sub_f32 v27, v26, v27
v_cvt_pk_bf16_f32 v28, v26, v27
v_and_b32 v30, 0xffff0000, v28
v_sub_f32 v27, v27, v30
v_cvt_pk_bf16_f32 v29, v27, 0
ds_write_b64 v15, v[28:29]
v_mov_b32 v14, 162320
v_mov_b32 v15, 1
s_mov_b64 exec, 1
ds_add_u32 v14, v15
s_mov_b64 exec, -1
s_setprio 1
s_lshl2_add_u32 s63, s59, s53
s_mul_i32 s64, s63, 20480
s_mul_i32 s65, s60, 160
s_add_u32 s64, s64, s65
v_add_u32 v20, 0, v0
v_mul_u32_u24 v21, 205, v20
v_lshrrev_b32 v21, 11, v21
v_mul_u32_u24 v21, 1120, v21
v_lshl_add_u32 v21, v20, 4, v21
v_add_u32 v13, s64, v21
v_add_u32 v20, 64, v0
v_mul_u32_u24 v21, 205, v20
v_lshrrev_b32 v21, 11, v21
v_mul_u32_u24 v21, 1120, v21
v_lshl_add_u32 v21, v20, 4, v21
v_add_u32 v14, s64, v21
v_add_u32 v20, 128, v0
v_mul_u32_u24 v21, 205, v20
v_lshrrev_b32 v21, 11, v21
v_mul_u32_u24 v21, 1120, v21
v_lshl_add_u32 v21, v20, 4, v21
v_add_u32 v15, s64, v21
s_lshl_b32 s63, s63, 7
s_add_u32 s63, s63, 40960
v_and_b32 v20, 15, v0
v_lshlrev_b32 v20, 3, v20
buffer_load_dwordx2 v[16:17], v20, s[16:19], s63 offen sc1
s_cmp_lg_u32 s53, 3
s_cbranch_scc1 L_bjoin
s_add_u32 s3, s100, 6
s_sub_u32 s66, s3, 12
s_cmp_ge_u32 s3, 12
s_cselect_b32 s3, s66, s3
s_mul_i32 s3, s3, 5120
s_add_u32 s3, s3, s101
s_mov_b32 m0, 40960
s_add_u32 s96, s3, 0
buffer_load_dwordx4 v18, s[16:19], s96 offen offset:0 sc1 lds
buffer_load_dwordx4 v18, s[16:19], s96 offen offset:1024 sc1 lds
buffer_load_dwordx4 v18, s[16:19], s96 offen offset:2048 sc1 lds
buffer_load_dwordx4 v18, s[16:19], s96 offen offset:3072 sc1 lds
s_mov_b32 m0, 45056
s_add_u32 s96, s3, 4096
buffer_load_dwordx4 v18, s[16:19], s96 offen offset:0 sc1 lds
s_mov_b32 m0, 51200
s_add_u32 s96, s3, 61440
buffer_load_dwordx4 v18, s[16:19], s96 offen offset:0 sc1 lds
buffer_load_dwordx4 v18, s[16:19], s96 offen offset:1024 sc1 lds
buffer_load_dwordx4 v18, s[16:19], s96 offen offset:2048 sc1 lds
buffer_load_dwordx4 v18, s[16:19], s96 offen offset:3072 sc1 lds
s_mov_b32 m0, 55296
s_add_u32 s96, s3, 65536
buffer_load_dwordx4 v18, s[16:19], s96 offen offset:0 sc1 lds
s_mov_b32 m0, 61440
s_add_u32 s96, s3, 122880
buffer_load_dwordx4 v18, s[16:19], s96 offen offset:0 sc1 lds
buffer_load_dwordx4 v18, s[16:19], s96 offen offset:1024 sc1 lds
buffer_load_dwordx4 v18, s[16:19], s96 offen offset:2048 sc1 lds
buffer_load_dwordx4 v18, s[16:19], s96 offen offset:3072 sc1 lds
s_mov_b32 m0, 65536
s_add_u32 s96, s3, 126976
buffer_load_dwordx4 v18, s[16:19], s96 offen offset:0 sc1 lds
s_mov_b32 m0, 71680
s_add_u32 s96, s3, 184320
buffer_load_dwordx4 v18, s[16:19], s96 offen offset:0 sc1 lds
buffer_load_dwordx4 v18, s[16:19], s96 offen offset:1024 sc1 lds
buffer_load_dwordx4 v18, s[16:19], s96 offen offset:2048 sc1 lds
buffer_load_dwordx4 v18, s[16:19], s96 offen offset:3072 sc1 lds
s_mov_b32 m0, 75776
s_add_u32 s96, s3, 188416
buffer_load_dwordx4 v18, s[16:19], s96 offen offset:0 sc1 lds
s_add_u32 s3, s100, 7
s_sub_u32 s66, s3, 12
s_cmp_ge_u32 s3, 12
s_cselect_b32 s3, s66, s3
s_mul_i32 s3, s3, 5120
s_add_u32 s3, s3, s101
s_mov_b32 m0, 46080
s_add_u32 s96, s3, 0
buffer_load_dwordx4 v18, s[16:19], s96 offen offset:0 sc1 lds
buffer_load_dwordx4 v18, s[16:19], s96 offen offset:1024 sc1 lds
buffer_load_dwordx4 v18, s[16:19], s96 offen offset:2048 sc1 lds
buffer_load_dwordx4 v18, s[16:19], s96 offen offset:3072 sc1 lds
s_mov_b32 m0, 50176
s_add_u32 s96, s3, 4096
buffer_load_dwordx4 v18, s[16:19], s96 offen offset:0 sc1 lds
s_mov_b32 m0, 56320
s_add_u32 s96, s3, 61440
buffer_load_dwordx4 v18, s[16:19], s96 offen offset:0 sc1 lds
buffer_load_dwordx4 v18, s[16:19], s96 offen offset:1024 sc1 lds
buffer_load_dwordx4 v18, s[16:19], s96 offen offset:2048 sc1 lds
buffer_load_dwordx4 v18, s[16:19], s96 offen offset:3072 sc1 lds
s_mov_b32 m0, 60416
s_add_u32 s96, s3, 65536
buffer_load_dwordx4 v18, s[16:19], s96 offen offset:0 sc1 lds
s_mov_b32 m0, 66560
s_add_u32 s96, s3, 122880
buffer_load_dwordx4 v18, s[16:19], s96 offen offset:0 sc1 lds
buffer_load_dwordx4 v18, s[16:19], s96 offen offset:1024 sc1 lds
buffer_load_dwordx4 v18, s[16:19], s96 offen offset:2048 sc1 lds
buffer_load_dwordx4 v18, s[16:19], s96 offen offset:3072 sc1 lds
s_mov_b32 m0, 70656
s_add_u32 s96, s3, 126976
buffer_load_dwordx4 v18, s[16:19], s96 offen offset:0 sc1 lds
s_mov_b32 m0, 76800
s_add_u32 s96, s3, 184320
buffer_load_dwordx4 v18, s[16:19], s96 offen offset:0 sc1 lds
buffer_load_dwordx4 v18, s[16:19], s96 offen offset:1024 sc1 lds
buffer_load_dwordx4 v18, s[16:19], s96 offen offset:2048 sc1 lds
buffer_load_dwordx4 v18, s[16:19], s96 offen offset:3072 sc1 lds
s_mov_b32 m0, 80896
s_add_u32 s96, s3, 188416
buffer_load_dwordx4 v18, s[16:19], s96 offen offset:0 sc1 lds
s_add_u32 s3, s100, 8
s_sub_u32 s66, s3, 12
s_cmp_ge_u32 s3, 12
s_cselect_b32 s3, s66, s3
s_mul_i32 s3, s3, 5120
s_add_u32 s3, s3, s101
s_mov_b32 m0, 81920
s_add_u32 s96, s3, 0
buffer_load_dwordx4 v18, s[16:19], s96 offen offset:0 sc1 lds
buffer_load_dwordx4 v18, s[16:19], s96 offen offset:1024 sc1 lds
buffer_load_dwordx4 v18, s[16:19], s96 offen offset:2048 sc1 lds
buffer_load_dwordx4 v18, s[16:19], s96 offen offset:3072 sc1 lds
s_mov_b32 m0, 86016
s_add_u32 s96, s3, 4096
buffer_load_dwordx4 v18, s[16:19], s96 offen offset:0 sc1 lds
s_mov_b32 m0, 92160
s_add_u32 s96, s3, 61440
buffer_load_dwordx4 v18, s[16:19], s96 offen offset:0 sc1 lds
buffer_load_dwordx4 v18, s[16:19], s96 offen offset:1024 sc1 lds
buffer_load_dwordx4 v18, s[16:19], s96 offen offset:2048 sc1 lds
buffer_load_dwordx4 v18, s[16:19], s96 offen offset:3072 sc1 lds
s_mov_b32 m0, 96256
s_add_u32 s96, s3, 65536
buffer_load_dwordx4 v18, s[16:19], s96 offen offset:0 sc1 lds
s_mov_b32 m0, 102400
s_add_u32 s96, s3, 122880
buffer_load_dwordx4 v18, s[16:19], s96 offen offset:0 sc1 lds
buffer_load_dwordx4 v18, s[16:19], s96 offen offset:1024 sc1 lds
buffer_load_dwordx4 v18, s[16:19], s96 offen offset:2048 sc1 lds
buffer_load_dwordx4 v18, s[16:19], s96 offen offset:3072 sc1 lds
s_mov_b32 m0, 106496
s_add_u32 s96, s3, 126976
buffer_load_dwordx4 v18, s[16:19], s96 offen offset:0 sc1 lds
s_mov_b32 m0, 112640
s_add_u32 s96, s3, 184320
buffer_load_dwordx4 v18, s[16:19], s96 offen offset:0 sc1 lds
buffer_load_dwordx4 v18, s[16:19], s96 offen offset:1024 sc1 lds
buffer_load_dwordx4 v18, s[16:19], s96 offen offset:2048 sc1 lds
buffer_load_dwordx4 v18, s[16:19], s96 offen offset:3072 sc1 lds
s_mov_b32 m0, 116736
s_add_u32 s96, s3, 188416
buffer_load_dwordx4 v18, s[16:19], s96 offen offset:0 sc1 lds
s_add_u32 s3, s100, 9
s_sub_u32 s66, s3, 12
s_cmp_ge_u32 s3, 12
s_cselect_b32 s3, s66, s3
s_mul_i32 s3, s3, 5120
s_add_u32 s3, s3, s101
s_mov_b32 m0, 87040
s_add_u32 s96, s3, 0
buffer_load_dwordx4 v18, s[16:19], s96 offen offset:0 sc1 lds
buffer_load_dwordx4 v18, s[16:19], s96 offen offset:1024 sc1 lds
buffer_load_dwordx4 v18, s[16:19], s96 offen offset:2048 sc1 lds
buffer_load_dwordx4 v18, s[16:19], s96 offen offset:3072 sc1 lds
s_mov_b32 m0, 91136
s_add_u32 s96, s3, 4096
buffer_load_dwordx4 v18, s[16:19], s96 offen offset:0 sc1 lds
s_mov_b32 m0, 97280
s_add_u32 s96, s3, 61440
buffer_load_dwordx4 v18, s[16:19], s96 offen offset:0 sc1 lds
buffer_load_dwordx4 v18, s[16:19], s96 offen offset:1024 sc1 lds
buffer_load_dwordx4 v18, s[16:19], s96 offen offset:2048 sc1 lds
buffer_load_dwordx4 v18, s[16:19], s96 offen offset:3072 sc1 lds
s_mov_b32 m0, 101376
s_add_u32 s96, s3, 65536
buffer_load_dwordx4 v18, s[16:19], s96 offen offset:0 sc1 lds
s_mov_b32 m0, 107520
s_add_u32 s96, s3, 122880
buffer_load_dwordx4 v18, s[16:19], s96 offen offset:0 sc1 lds
buffer_load_dwordx4 v18, s[16:19], s96 offen offset:1024 sc1 lds
buffer_load_dwordx4 v18, s[16:19], s96 offen offset:2048 sc1 lds
buffer_load_dwordx4 v18, s[16:19], s96 offen offset:3072 sc1 lds
s_mov_b32 m0, 111616
s_add_u32 s96, s3, 126976
buffer_load_dwordx4 v18, s[16:19], s96 offen offset:0 sc1 lds
s_mov_b32 m0, 117760
s_add_u32 s96, s3, 184320
buffer_load_dwordx4 v18, s[16:19], s96 offen offset:0 sc1 lds
buffer_load_dwordx4 v18, s[16:19], s96 offen offset:1024 sc1 lds
buffer_load_dwordx4 v18, s[16:19], s96 offen offset:2048 sc1 lds
buffer_load_dwordx4 v18, s[16:19], s96 offen offset:3072 sc1 lds
s_mov_b32 m0, 121856
s_add_u32 s96, s3, 188416
buffer_load_dwordx4 v18, s[16:19], s96 offen offset:0 sc1 lds
v_mov_b32 v20, 162312
s_mov_b32 s67, 0
L_lf_31:
ds_read_b32 v21, v20
s_add_u32 s67, s67, 1
s_waitcnt lgkmcnt(0)
v_readfirstlane_b32 s63, v21
s_nop 0
s_cmp_eq_u32 s63, 4
s_cbranch_scc1 L_ringfree_30
s_sleep 1
s_cmp_lt_u32 s67, 2097152
s_cbranch_scc1 L_lf_31
L_ringfree_30:
s_add_u32 s3, s100, 10
s_sub_u32 s66, s3, 12
s_cmp_ge_u32 s3, 12
s_cselect_b32 s3, s66, s3
s_mul_i32 s3, s3, 5120
s_add_u32 s3, s3, s101
s_mov_b32 m0, 0
s_add_u32 s96, s3, 0
buffer_load_dwordx4 v18, s[16:19], s96 offen offset:0 sc1 lds
buffer_load_dwordx4 v18, s[16:19], s96 offen offset:1024 sc1 lds
buffer_load_dwordx4 v18, s[16:19], s96 offen offset:2048 sc1 lds
buffer_load_dwordx4 v18, s[16:19], s96 offen offset:3072 sc1 lds
s_mov_b32 m0, 4096
s_add_u32 s96, s3, 4096
buffer_load_dwordx4 v18, s[16:19], s96 offen offset:0 sc1 lds
s_mov_b32 m0, 10240
s_add_u32 s96, s3, 61440
buffer_load_dwordx4 v18, s[16:19], s96 offen offset:0 sc1 lds
buffer_load_dwordx4 v18, s[16:19], s96 offen offset:1024 sc1 lds
buffer_load_dwordx4 v18, s[16:19], s96 offen offset:2048 sc1 lds
buffer_load_dwordx4 v18, s[16:19], s96 offen offset:3072 sc1 lds
s_mov_b32 m0, 14336
s_add_u32 s96, s3, 65536
buffer_load_dwordx4 v18, s[16:19], s96 offen offset:0 sc1 lds
s_mov_b32 m0, 20480
s_add_u32 s96, s3, 122880
buffer_load_dwordx4 v18, s[16:19], s96 offen offset:0 sc1 lds
buffer_load_dwordx4 v18, s[16:19], s96 offen offset:1024 sc1 lds
buffer_load_dwordx4 v18, s[16:19], s96 offen offset:2048 sc1 lds
buffer_load_dwordx4 v18, s[16:19], s96 offen offset:3072 sc1 lds
s_mov_b32 m0, 24576
s_add_u32 s96, s3, 126976
buffer_load_dwordx4 v18, s[16:19], s96 offen offset:0 sc1 lds
s_mov_b32 m0, 30720
s_add_u32 s96, s3, 184320
buffer_load_dwordx4 v18, s[16:19], s96 offen offset:0 sc1 lds
buffer_load_dwordx4 v18, s[16:19], s96 offen offset:1024 sc1 lds
buffer_load_dwordx4 v18, s[16:19], s96 offen offset:2048 sc1 lds
buffer_load_dwordx4 v18, s[16:19], s96 offen offset:3072 sc1 lds
s_mov_b32 m0, 34816
s_add_u32 s96, s3, 188416
buffer_load_dwordx4 v18, s[16:19], s96 offen offset:0 sc1 lds
s_add_u32 s3, s100, 11
s_sub_u32 s66, s3, 12
s_cmp_ge_u32 s3, 12
s_cselect_b32 s3, s66, s3
s_mul_i32 s3, s3, 5120
s_add_u32 s3, s3, s101
s_mov_b32 m0, 5120
s_add_u32 s96, s3, 0
buffer_load_dwordx4 v18, s[16:19], s96 offen offset:0 sc1 lds
buffer_load_dwordx4 v18, s[16:19], s96 offen offset:1024 sc1 lds
buffer_load_dwordx4 v18, s[16:19], s96 offen offset:2048 sc1 lds
buffer_load_dwordx4 v18, s[16:19], s96 offen offset:3072 sc1 lds
s_mov_b32 m0, 9216
s_add_u32 s96, s3, 4096
buffer_load_dwordx4 v18, s[16:19], s96 offen offset:0 sc1 lds
s_mov_b32 m0, 15360
s_add_u32 s96, s3, 61440
buffer_load_dwordx4 v18, s[16:19], s96 offen offset:0 sc1 lds
buffer_load_dwordx4 v18, s[16:19], s96 offen offset:1024 sc1 lds
buffer_load_dwordx4 v18, s[16:19], s96 offen offset:2048 sc1 lds
buffer_load_dwordx4 v18, s[16:19], s96 offen offset:3072 sc1 lds
s_mov_b32 m0, 19456
s_add_u32 s96, s3, 65536
buffer_load_dwordx4 v18, s[16:19], s96 offen offset:0 sc1 lds
s_mov_b32 m0, 25600
s_add_u32 s96, s3, 122880
buffer_load_dwordx4 v18, s[16:19], s96 offen offset:0 sc1 lds
buffer_load_dwordx4 v18, s[16:19], s96 offen offset:1024 sc1 lds
buffer_load_dwordx4 v18, s[16:19], s96 offen offset:2048 sc1 lds
buffer_load_dwordx4 v18, s[16:19], s96 offen offset:3072 sc1 lds
s_mov_b32 m0, 29696
s_add_u32 s96, s3, 126976
buffer_load_dwordx4 v18, s[16:19], s96 offen offset:0 sc1 lds
s_mov_b32 m0, 35840
s_add_u32 s96, s3, 184320
buffer_load_dwordx4 v18, s[16:19], s96 offen offset:0 sc1 lds
buffer_load_dwordx4 v18, s[16:19], s96 offen offset:1024 sc1 lds
buffer_load_dwordx4 v18, s[16:19], s96 offen offset:2048 sc1 lds
buffer_load_dwordx4 v18, s[16:19], s96 offen offset:3072 sc1 lds
s_mov_b32 m0, 39936
s_add_u32 s96, s3, 188416
buffer_load_dwordx4 v18, s[16:19], s96 offen offset:0 sc1 lds
v_mov_b32 v20, 162316
v_mov_b32 v21, 1
s_waitcnt vmcnt(0)
ds_write_b32 v20, v21
L_bjoin:
v_and_b32 v20, 15, v0
v_mul_u32_u24 v20, 160, v20
v_lshrrev_b32 v21, 4, v0
v_lshl_add_u32 v20, v21, 3, v20
s_mul_i32 s64, s53, 2560
s_add_u32 s64, s64, 148992
v_add_u32 v1, s64, v20
v_lshl_add_u32 v2, v0, 4, s64
s_waitcnt vmcnt(0)
ds_read_b64 v[24:25], v1 offset:0
ds_read_b64 v[26:27], v1 offset:32
ds_read_b64 v[28:29], v1 offset:64
ds_read_b64 v[30:31], v1 offset:96
ds_read_b64 v[32:33], v1 offset:128
v_rcp_f32 v17, v17
s_waitcnt lgkmcnt(0)
v_lshlrev_b32 v40, 16, v24
v_and_b32 v41, 0xffff0000, v24
v_sub_f32 v60, v40, v16
v_sub_f32 v61, v41, v16
v_cvt_pk_bf16_f32 v61, v60, v61
v_lshlrev_b32 v60, 16, v61
v_and_b32 v61, 0xffff0000, v61
v_mul_f32 v60, v60, v17
v_mul_f32 v61, v61, v17
v_cvt_pk_bf16_f32 v61, v60, v61
v_lshlrev_b32 v60, 16, v61
v_and_b32 v61, 0xffff0000, v61
v_lshlrev_b32 v42, 16, v25
v_and_b32 v43, 0xffff0000, v25
v_sub_f32 v62, v42, v16
v_sub_f32 v63, v43, v16
v_cvt_pk_bf16_f32 v63, v62, v63
v_lshlrev_b32 v62, 16, v63
v_and_b32 v63, 0xffff0000, v63
v_mul_f32 v62, v62, v17
v_mul_f32 v63, v63, v17
v_cvt_pk_bf16_f32 v63, v62, v63
v_lshlrev_b32 v62, 16, v63
v_and_b32 v63, 0xffff0000, v63
v_lshlrev_b32 v44, 16, v26
v_and_b32 v45, 0xffff0000, v26
v_sub_f32 v64, v44, v16
v_sub_f32 v65, v45, v16
v_cvt_pk_bf16_f32 v65, v64, v65
v_lshlrev_b32 v64, 16, v65
v_and_b32 v65, 0xffff0000, v65
v_mul_f32 v64, v64, v17
v_mul_f32 v65, v65, v17
v_cvt_pk_bf16_f32 v65, v64, v65
v_lshlrev_b32 v64, 16, v65
v_and_b32 v65, 0xffff0000, v65
v_lshlrev_b32 v46, 16, v27
v_and_b32 v47, 0xffff0000, v27
v_sub_f32 v66, v46, v16
v_sub_f32 v67, v47, v16
v_cvt_pk_bf16_f32 v67, v66, v67
v_lshlrev_b32 v66, 16, v67
v_and_b32 v67, 0xffff0000, v67
v_mul_f32 v66, v66, v17
v_mul_f32 v67, v67, v17
v_cvt_pk_bf16_f32 v67, v66, v67
v_lshlrev_b32 v66, 16, v67
v_and_b32 v67, 0xffff0000, v67
v_lshlrev_b32 v48, 16, v28
v_and_b32 v49, 0xffff0000, v28
v_sub_f32 v68, v48, v16
v_sub_f32 v69, v49, v16
v_cvt_pk_bf16_f32 v69, v68, v69
v_lshlrev_b32 v68, 16, v69
v_and_b32 v69, 0xffff0000, v69
v_mul_f32 v68, v68, v17
v_mul_f32 v69, v69, v17
v_cvt_pk_bf16_f32 v69, v68, v69
v_lshlrev_b32 v68, 16, v69
v_and_b32 v69, 0xffff0000, v69
v_lshlrev_b32 v50, 16, v29
v_and_b32 v51, 0xffff0000, v29
v_sub_f32 v70, v50, v16
v_sub_f32 v71, v51, v16
v_cvt_pk_bf16_f32 v71, v70, v71
v_lshlrev_b32 v70, 16, v71
v_and_b32 v71, 0xffff0000, v71
v_mul_f32 v70, v70, v17
v_mul_f32 v71, v71, v17
v_cvt_pk_bf16_f32 v71, v70, v71
v_lshlrev_b32 v70, 16, v71
v_and_b32 v71, 0xffff0000, v71
v_lshlrev_b32 v52, 16, v30
v_and_b32 v53, 0xffff0000, v30
v_sub_f32 v72, v52, v16
v_sub_f32 v73, v53, v16
v_cvt_pk_bf16_f32 v73, v72, v73
v_lshlrev_b32 v72, 16, v73
v_and_b32 v73, 0xffff0000, v73
v_mul_f32 v72, v72, v17
v_mul_f32 v73, v73, v17
v_cvt_pk_bf16_f32 v73, v72, v73
v_lshlrev_b32 v72, 16, v73
v_and_b32 v73, 0xffff0000, v73
v_lshlrev_b32 v54, 16, v31
v_and_b32 v55, 0xffff0000, v31
v_sub_f32 v74, v54, v16
v_sub_f32 v75, v55, v16
v_cvt_pk_bf16_f32 v75, v74, v75
v_lshlrev_b32 v74, 16, v75
v_and_b32 v75, 0xffff0000, v75
v_mul_f32 v74, v74, v17
v_mul_f32 v75, v75, v17
v_cvt_pk_bf16_f32 v75, v74, v75
v_lshlrev_b32 v74, 16, v75
v_and_b32 v75, 0xffff0000, v75
v_lshlrev_b32 v56, 16, v32
v_and_b32 v57, 0xffff0000, v32
v_sub_f32 v76, v56, v16
v_sub_f32 v77, v57, v16
v_cvt_pk_bf16_f32 v77, v76, v77
v_lshlrev_b32 v76, 16, v77
v_and_b32 v77, 0xffff0000, v77
v_mul_f32 v76, v76, v17
v_mul_f32 v77, v77, v17
v_cvt_pk_bf16_f32 v77, v76, v77
v_lshlrev_b32 v76, 16, v77
v_and_b32 v77, 0xffff0000, v77
v_lshlrev_b32 v58, 16, v33
v_and_b32 v59, 0xffff0000, v33
v_sub_f32 v78, v58, v16
v_sub_f32 v79, v59, v16
v_cvt_pk_bf16_f32 v79, v78, v79
v_lshlrev_b32 v78, 16, v79
v_and_b32 v79, 0xffff0000, v79
v_mul_f32 v78, v78, v17
v_mul_f32 v79, v79, v17
v_cvt_pk_bf16_f32 v79, v78, v79
v_lshlrev_b32 v78, 16, v79
v_and_b32 v79, 0xffff0000, v79
v_lshlrev_b32 v3, 4, v0
s_mov_b32 s63, 40960
s_cmp_eq_u32 s53, 1
s_cselect_b32 s63, 46080, s63
s_cmp_eq_u32 s53, 2
s_cselect_b32 s63, 81920, s63
s_cmp_eq_u32 s53, 3
s_cselect_b32 s63, 87040, s63
v_add_u32 v3, s63, v3
v_lshrrev_b32 v20, 2, v0
v_and_b32 v21, 3, v0
v_lshlrev_b32 v21, 3, v21
v_lshl_add_u32 v20, v20, 7, v21
s_lshl_b32 s63, s53, 5
s_add_u32 s63, s63, 122880
v_add_u32 v20, s63, v20
v_mov_b32 v21, 162304
s_cmp_lg_u32 s53, 3
s_cbranch_scc1 L_ywait_32
s_and_b32 s63, s54, 3
s_lshl2_add_u32 s63, s60, s63
s_add_u32 s95, s63, 228
s_lshl_b32 s95, s95, 7
v_mov_b32 v6, 162308
s_mov_b32 s67, 0
L_lf_35:
ds_read_b32 v7, v6
s_add_u32 s67, s67, 1
s_waitcnt lgkmcnt(0)
v_readfirstlane_b32 s63, v7
s_nop 0
s_cmp_eq_u32 s63, s90
s_cbranch_scc1 L_convdone_34
s_sleep 1
s_cmp_lt_u32 s67, 2097152
s_cbranch_scc1 L_lf_35
L_convdone_34:
s_mov_b32 s99, 0
s_atomic_add s99, s[16:17], s95 offset:0 glc
v_lshrrev_b32 v22, 3, v0
v_and_b32 v23, 7, v0
v_mul_u32_u24 v22, 4352, v22
v_lshl_add_u32 v22, v23, 4, v22
s_mul_i32 s63, s60, 348160
s_lshl_b32 s64, s59, 7
s_add_u32 s63, s63, s64
s_add_u32 s63, s63, 3407872
s_setprio 3
s_waitcnt lgkmcnt(0)
s_mov_b32 s67, 0
L_poll_36:
s_cmp_ge_u32 s99, 30
s_cbranch_scc1 L_pollok_38
L_again_37:
s_sleep 1
s_mov_b32 s99, 0
s_atomic_add s99, s[16:17], s95 offset:0 glc
s_add_u32 s67, s67, 1
s_cmp_lt_u32 s67, 131072
s_waitcnt lgkmcnt(0)
s_cbranch_scc1 L_poll_36
L_pollok_38:
s_mov_b32 m0, 122880
s_nop 0
buffer_load_dwordx4 v22, s[16:19], s63 offen sc1  lds
s_add_u32 s63, s63, 34816
s_mov_b32 m0, 123904
s_nop 0
buffer_load_dwordx4 v22, s[16:19], s63 offen sc1  lds
s_add_u32 s63, s63, 34816
s_mov_b32 m0, 124928
s_nop 0
buffer_load_dwordx4 v22, s[16:19], s63 offen sc1  lds
s_add_u32 s63, s63, 34816
s_mov_b32 m0, 125952
s_nop 0
buffer_load_dwordx4 v22, s[16:19], s63 offen sc1  lds
s_add_u32 s63, s63, 34816
s_mov_b32 m0, 126976
s_nop 0
buffer_load_dwordx4 v22, s[16:19], s63 offen sc1  lds
s_add_u32 s63, s63, 34816
s_mov_b32 m0, 128000
s_nop 0
buffer_load_dwordx4 v22, s[16:19], s63 offen sc1  lds
s_add_u32 s63, s63, 34816
s_mov_b32 m0, 129024
s_nop 0
buffer_load_dwordx4 v22, s[16:19], s63 offen sc1  lds
s_add_u32 s63, s63, 34816
s_mov_b32 m0, 130048
s_nop 0
buffer_load_dwordx4 v22, s[16:19], s63 offen sc1  lds
s_add_u32 s63, s63, 34816
s_mov_b32 m0, 131072
s_nop 0
buffer_load_dwordx4 v22, s[16:19], s63 offen sc1  lds
s_add_u32 s63, s63, 34816
s_mov_b32 m0, 132096
s_nop 0
buffer_load_dwordx4 v22, s[16:19], s63 offen sc1  lds
s_add_u32 s63, s63, 34816
v_mov_b32 v22, 1
s_waitcnt vmcnt(0)
ds_write_b32 v21, v22
s_branch L_ygo_33
L_ywait_32:
s_mov_b32 s67, 0
L_lf_39:
ds_read_b32 v23, v21
s_add_u32 s67, s67, 1
s_waitcnt lgkmcnt(0)
v_readfirstlane_b32 s63, v23
s_nop 0
s_cmp_eq_u32 s63, 1
s_cbranch_scc1 L_ygo_33
s_sleep 1
s_cmp_lt_u32 s67, 2097152
s_cbranch_scc1 L_lf_39
L_ygo_33:
ds_read_b64_tr_b16 v[24:25], v20 offset:0
ds_read_b64_tr_b16 v[26:27], v20 offset:2048
ds_read_b64_tr_b16 v[28:29], v20 offset:4096
ds_read_b64_tr_b16 v[30:31], v20 offset:6144
ds_read_b64_tr_b16 v[32:33], v20 offset:8192
s_waitcnt lgkmcnt(0)
v_lshlrev_b32 v20, 16, v24
v_and_b32 v21, 0xffff0000, v24
v_fmac_f32 v40, v60, v20
v_fmac_f32 v41, v61, v21
v_lshlrev_b32 v20, 16, v25
v_and_b32 v21, 0xffff0000, v25
v_fmac_f32 v42, v62, v20
v_fmac_f32 v43, v63, v21
v_lshlrev_b32 v20, 16, v26
v_and_b32 v21, 0xffff0000, v26
v_fmac_f32 v44, v64, v20
v_fmac_f32 v45, v65, v21
v_lshlrev_b32 v20, 16, v27
v_and_b32 v21, 0xffff0000, v27
v_fmac_f32 v46, v66, v20
v_fmac_f32 v47, v67, v21
v_lshlrev_b32 v20, 16, v28
v_and_b32 v21, 0xffff0000, v28
v_fmac_f32 v48, v68, v20
v_fmac_f32 v49, v69, v21
v_lshlrev_b32 v20, 16, v29
v_and_b32 v21, 0xffff0000, v29
v_fmac_f32 v50, v70, v20
v_fmac_f32 v51, v71, v21
v_lshlrev_b32 v20, 16, v30
v_and_b32 v21, 0xffff0000, v30
v_fmac_f32 v52, v72, v20
v_fmac_f32 v53, v73, v21
v_lshlrev_b32 v20, 16, v31
v_and_b32 v21, 0xffff0000, v31
v_fmac_f32 v54, v74, v20
v_fmac_f32 v55, v75, v21
v_lshlrev_b32 v20, 16, v32
v_and_b32 v21, 0xffff0000, v32
v_fmac_f32 v56, v76, v20
v_fmac_f32 v57, v77, v21
v_lshlrev_b32 v20, 16, v33
v_and_b32 v21, 0xffff0000, v33
v_fmac_f32 v58, v78, v20
v_fmac_f32 v59, v79, v21
s_barrier
ds_read_b128 v[80:83], v3 offset:0
ds_read_b128 v[84:87], v3 offset:10240
ds_read_b128 v[88:91], v3 offset:20480
ds_read_b128 v[92:95], v3 offset:30720
ds_read_b128 v[96:99], v3 offset:1024
ds_read_b128 v[100:103], v3 offset:11264
ds_read_b128 v[104:107], v3 offset:21504
ds_read_b128 v[108:111], v3 offset:31744
ds_read_b128 v[112:115], v3 offset:2048
ds_read_b128 v[116:119], v3 offset:12288
ds_read_b128 v[120:123], v3 offset:22528
ds_read_b128 v[124:127], v3 offset:32768
ds_read_b128 v[128:131], v3 offset:3072
ds_read_b128 v[132:135], v3 offset:13312
ds_read_b128 v[136:139], v3 offset:23552
ds_read_b128 v[140:143], v3 offset:33792
ds_read_b128 v[144:147], v3 offset:4096
ds_read_b128 v[148:151], v3 offset:14336
ds_read_b128 v[152:155], v3 offset:24576
ds_read_b128 v[156:159], v3 offset:34816
s_waitcnt lgkmcnt(15)
v_pk_add_f32 v[80:81], v[80:81], v[84:85]
v_pk_add_f32 v[82:83], v[82:83], v[86:87]
v_pk_add_f32 v[88:89], v[88:89], v[92:93]
v_pk_add_f32 v[90:91], v[90:91], v[94:95]
v_pk_add_f32 v[80:81], v[80:81], v[40:41]
v_pk_add_f32 v[82:83], v[82:83], v[42:43]
v_pk_add_f32 v[80:81], v[80:81], v[88:89]
v_pk_add_f32 v[82:83], v[82:83], v[90:91]
v_cvt_pk_bf16_f32 v80, v80, v81
v_cvt_pk_bf16_f32 v81, v82, v83
ds_write_b64 v1, v[80:81] offset:0
s_waitcnt lgkmcnt(13)
v_pk_add_f32 v[96:97], v[96:97], v[100:101]
v_pk_add_f32 v[98:99], v[98:99], v[102:103]
v_pk_add_f32 v[104:105], v[104:105], v[108:109]
v_pk_add_f32 v[106:107], v[106:107], v[110:111]
v_pk_add_f32 v[96:97], v[96:97], v[44:45]
v_pk_add_f32 v[98:99], v[98:99], v[46:47]
v_pk_add_f32 v[96:97], v[96:97], v[104:105]
v_pk_add_f32 v[98:99], v[98:99], v[106:107]
v_cvt_pk_bf16_f32 v96, v96, v97
v_cvt_pk_bf16_f32 v97, v98, v99
ds_write_b64 v1, v[96:97] offset:32
s_waitcnt lgkmcnt(10)
v_pk_add_f32 v[112:113], v[112:113], v[116:117]
v_pk_add_f32 v[114:115], v[114:115], v[118:119]
v_pk_add_f32 v[120:121], v[120:121], v[124:125]
v_pk_add_f32 v[122:123], v[122:123], v[126:127]
v_pk_add_f32 v[112:113], v[112:113], v[48:49]
v_pk_add_f32 v[114:115], v[114:115], v[50:51]
v_pk_add_f32 v[112:113], v[112:113], v[120:121]
v_pk_add_f32 v[114:115], v[114:115], v[122:123]
v_cvt_pk_bf16_f32 v112, v112, v113
v_cvt_pk_bf16_f32 v113, v114, v115
ds_write_b64 v1, v[112:113] offset:64
s_waitcnt lgkmcnt(7)
v_pk_add_f32 v[128:129], v[128:129], v[132:133]
v_pk_add_f32 v[130:131], v[130:131], v[134:135]
v_pk_add_f32 v[136:137], v[136:137], v[140:141]
v_pk_add_f32 v[138:139], v[138:139], v[142:143]
v_pk_add_f32 v[128:129], v[128:129], v[52:53]
v_pk_add_f32 v[130:131], v[130:131], v[54:55]
v_pk_add_f32 v[128:129], v[128:129], v[136:137]
v_pk_add_f32 v[130:131], v[130:131], v[138:139]
v_cvt_pk_bf16_f32 v128, v128, v129
v_cvt_pk_bf16_f32 v129, v130, v131
ds_write_b64 v1, v[128:129] offset:96
s_waitcnt lgkmcnt(4)
v_pk_add_f32 v[144:145], v[144:145], v[148:149]
v_pk_add_f32 v[146:147], v[146:147], v[150:151]
v_pk_add_f32 v[152:153], v[152:153], v[156:157]
v_pk_add_f32 v[154:155], v[154:155], v[158:159]
v_pk_add_f32 v[144:145], v[144:145], v[56:57]
v_pk_add_f32 v[146:147], v[146:147], v[58:59]
v_pk_add_f32 v[144:145], v[144:145], v[152:153]
v_pk_add_f32 v[146:147], v[146:147], v[154:155]
v_cvt_pk_bf16_f32 v144, v144, v145
v_cvt_pk_bf16_f32 v145, v146, v147
ds_write_b64 v1, v[144:145] offset:128
ds_read_b128 v[24:27], v2 offset:0
ds_read_b128 v[28:31], v2 offset:1024
ds_read_b128 v[32:35], v2 offset:2048
s_waitcnt lgkmcnt(2)
buffer_store_dwordx4 v[24:27], v13, s[40:43], 0 offen nt
s_waitcnt lgkmcnt(1)
buffer_store_dwordx4 v[28:31], v14, s[40:43], 0 offen nt
s_waitcnt lgkmcnt(0)
s_mov_b32 exec_hi, 0
buffer_store_dwordx4 v[32:35], v15, s[40:43], 0 offen nt
s_endpgm
L_roleA_a:
s_and_b32 s63, s54, 1
s_lshr_b32 s64, s54, 1
s_lshl2_add_u32 s66, s63, s64
s_lshl_b32 s61, s66, 5
s_add_u32 s61, s61, s55
s_bfe_u32 s64, s54, 0x10001
s_lshl1_add_u32 s63, s63, s64
s_and_b32 s64, s55, 7
s_lshl3_add_u32 s59, s63, s64
s_lshr_b32 s63, s54, 2
s_lshr_b32 s64, s55, 3
s_lshl2_add_u32 s60, s63, s64
s_mov_b32 s6, 2621440
s_mov_b32 s7, 0x20000
s_mov_b32 s18, 20971520
s_mov_b32 s19, 0x20000
s_mov_b32 s46, 256
s_mov_b32 s47, 0x20000
s_waitcnt lgkmcnt(0)
s_setprio 2
v_lshrrev_b32 v156, 5, v0
s_lshl2_add_u32 s63, s61, s53
s_lshl_b32 s63, s63, 1
v_add_u32 v156, s63, v156
v_lshlrev_b32 v19, 3, v156
v_mul_u32_u24 v156, 1280, v156
v_and_b32 v157, 31, v0
v_lshl_add_u32 v156, v157, 3, v156
buffer_load_dwordx2 v[24:25], v156, s[4:7], 0 offen offset:0
buffer_load_dwordx2 v[26:27], v156, s[4:7], 0 offen offset:256
buffer_load_dwordx2 v[28:29], v156, s[4:7], 0 offen offset:512
buffer_load_dwordx2 v[30:31], v156, s[4:7], 0 offen offset:768
buffer_load_dwordx2 v[32:33], v156, s[4:7], 0 offen offset:1024
s_and_b32 s86, s53, 1
s_lshr_b32 s87, s53, 1
v_and_b32 v112, 15, v0
v_lshrrev_b32 v113, 4, v0
v_bfe_u32 v114, v0, 1, 3
v_xor_b32 v114, v114, v113
s_mul_i32 s63, s86, 12288
v_lshl_add_u32 v116, v112, 7, s63
v_lshl_add_u32 v1, v114, 4, v116
v_xor_b32 v2, 64, v1
v_lshlrev_b32 v112, 4, v112
v_lshrrev_b32 v114, 5, v0
v_lshl_add_u32 v112, v114, 8, v112
v_and_b32 v113, 1, v113
v_lshl_add_u32 v6, v113, 9, v112
v_lshl_add_u32 v7, v113, 10, v112
v_lshrrev_b32 v113, 5, v0
v_mul_u32_u24 v115, 4096, v113
v_bfe_u32 v112, v0, 4, 1
v_mul_u32_u24 v113, 1024, v112
v_add_u32 v115, v115, v113
v_bfe_u32 v113, v0, 2, 2
v_lshl_add_u32 v115, v113, 6, v115
v_and_b32 v113, 3, v0
v_lshl_add_u32 v115, v113, 3, v115
v_lshlrev_b32 v112, 5, v112
s_lshl1_add_u32 s64, s87, 0
s_lshr_b32 s65, s64, 1
s_and_b32 s64, s64, 1
s_lshl_b32 s64, s64, 5
v_xor_b32 v116, s64, v112
s_lshl_b32 s65, s65, 8
s_add_u32 s65, s65, 24576
v_add3_u32 v3, v115, v116, s65
s_lshl1_add_u32 s64, s87, 1
s_lshr_b32 s65, s64, 1
s_and_b32 s64, s64, 1
s_lshl_b32 s64, s64, 5
v_xor_b32 v116, s64, v112
s_lshl_b32 s65, s65, 8
s_add_u32 s65, s65, 24576
v_add3_u32 v4, v115, v116, s65
s_mul_i32 s63, s86, 3
s_add_u32 s63, s63, 0
s_lshr_b32 s64, s63, 1
s_add_u32 s64, s64, s56
s_mul_i32 s64, s64, 49
s_lshr_b32 s65, s57, 1
s_add_u32 s64, s64, s65
s_add_u32 s64, s64, s87
s_and_b32 s63, s63, 1
s_lshl1_add_u32 s64, s64, s63
s_lshl_b32 s64, s64, 11
s_add_u32 s88, s64, 8585216
s_mul_i32 s63, s86, 3
s_add_u32 s63, s63, 1
s_lshr_b32 s64, s63, 1
s_add_u32 s64, s64, s56
s_mul_i32 s64, s64, 49
s_lshr_b32 s65, s57, 1
s_add_u32 s64, s64, s65
s_add_u32 s64, s64, s87
s_and_b32 s63, s63, 1
s_lshl1_add_u32 s64, s64, s63
s_lshl_b32 s64, s64, 11
s_add_u32 s89, s64, 8585216
s_mul_i32 s63, s86, 3
s_add_u32 s63, s63, 2
s_lshr_b32 s64, s63, 1
s_add_u32 s64, s64, s56
s_mul_i32 s64, s64, 49
s_lshr_b32 s65, s57, 1
s_add_u32 s64, s64, s65
s_add_u32 s64, s64, s87
s_and_b32 s63, s63, 1
s_lshl1_add_u32 s64, s64, s63
s_lshl_b32 s64, s64, 11
s_add_u32 s90, s64, 8585216
s_waitcnt vmcnt(0)
v_lshlrev_b32 v34, 16, v24
v_and_b32 v35, 0xffff0000, v24
v_lshlrev_b32 v36, 16, v25
v_and_b32 v37, 0xffff0000, v25
v_lshlrev_b32 v38, 16, v26
v_and_b32 v39, 0xffff0000, v26
v_lshlrev_b32 v40, 16, v27
v_and_b32 v41, 0xffff0000, v27
v_lshlrev_b32 v42, 16, v28
v_and_b32 v43, 0xffff0000, v28
v_lshlrev_b32 v44, 16, v29
v_and_b32 v45, 0xffff0000, v29
v_lshlrev_b32 v46, 16, v30
v_and_b32 v47, 0xffff0000, v30
v_lshlrev_b32 v48, 16, v31
v_and_b32 v49, 0xffff0000, v31
v_lshlrev_b32 v50, 16, v32
v_and_b32 v51, 0xffff0000, v32
v_lshlrev_b32 v52, 16, v33
v_and_b32 v53, 0xffff0000, v33
v_add_f32 v20, v34, v35
v_add_f32 v21, v36, v37
v_add_f32 v20, v20, v38
v_add_f32 v21, v21, v39
v_add_f32 v20, v20, v40
v_add_f32 v21, v21, v41
v_add_f32 v20, v20, v42
v_add_f32 v21, v21, v43
v_add_f32 v20, v20, v44
v_add_f32 v21, v21, v45
v_add_f32 v20, v20, v46
v_add_f32 v21, v21, v47
v_add_f32 v20, v20, v48
v_add_f32 v21, v21, v49
v_add_f32 v20, v20, v50
v_add_f32 v21, v21, v51
v_add_f32 v20, v20, v52
v_add_f32 v21, v21, v53
v_add_f32 v20, v20, v21
s_nop 1
v_add_f32_dpp v20, v20, v20 row_ror:8 row_mask:0xf bank_mask:0xf
s_nop 1
v_add_f32_dpp v20, v20, v20 row_ror:4 row_mask:0xf bank_mask:0xf
s_nop 1
v_add_f32_dpp v20, v20, v20 row_ror:2 row_mask:0xf bank_mask:0xf
s_nop 1
v_add_f32_dpp v20, v20, v20 row_ror:1 row_mask:0xf bank_mask:0xf
v_mov_b32 v21, v20
s_nop 1
v_permlane16_swap_b32 v20, v21
v_add_f32 v20, v20, v21
v_mul_f32 v20, 0x3acccccd, v20
v_sub_f32 v34, v34, v20
v_sub_f32 v35, v35, v20
v_sub_f32 v36, v36, v20
v_sub_f32 v37, v37, v20
v_sub_f32 v38, v38, v20
v_sub_f32 v39, v39, v20
v_sub_f32 v40, v40, v20
v_sub_f32 v41, v41, v20
v_sub_f32 v42, v42, v20
v_sub_f32 v43, v43, v20
v_sub_f32 v44, v44, v20
v_sub_f32 v45, v45, v20
v_sub_f32 v46, v46, v20
v_sub_f32 v47, v47, v20
v_sub_f32 v48, v48, v20
v_sub_f32 v49, v49, v20
v_sub_f32 v50, v50, v20
v_sub_f32 v51, v51, v20
v_sub_f32 v52, v52, v20
v_sub_f32 v53, v53, v20
v_mul_f32 v21, v34, v34
v_mul_f32 v22, v35, v35
v_fmac_f32 v21, v36, v36
v_fmac_f32 v22, v37, v37
v_fmac_f32 v21, v38, v38
v_fmac_f32 v22, v39, v39
v_fmac_f32 v21, v40, v40
v_fmac_f32 v22, v41, v41
v_fmac_f32 v21, v42, v42
v_fmac_f32 v22, v43, v43
v_fmac_f32 v21, v44, v44
v_fmac_f32 v22, v45, v45
v_fmac_f32 v21, v46, v46
v_fmac_f32 v22, v47, v47
v_fmac_f32 v21, v48, v48
v_fmac_f32 v22, v49, v49
v_fmac_f32 v21, v50, v50
v_fmac_f32 v22, v51, v51
v_fmac_f32 v21, v52, v52
v_fmac_f32 v22, v53, v53
v_add_f32 v21, v21, v22
s_nop 1
v_add_f32_dpp v21, v21, v21 row_ror:8 row_mask:0xf bank_mask:0xf
s_nop 1
v_add_f32_dpp v21, v21, v21 row_ror:4 row_mask:0xf bank_mask:0xf
s_nop 1
v_add_f32_dpp v21, v21, v21 row_ror:2 row_mask:0xf bank_mask:0xf
s_nop 1
v_add_f32_dpp v21, v21, v21 row_ror:1 row_mask:0xf bank_mask:0xf
v_mov_b32 v22, v21
s_nop 1
v_permlane16_swap_b32 v21, v22
v_add_f32 v21, v21, v22
v_mul_f32 v21, 0x3acccccd, v21
v_cvt_pk_bf16_f32 v22, v20, v21
v_lshlrev_b32 v20, 16, v22
v_and_b32 v21, 0xffff0000, v22
v_add_f32 v21, 0x3727c5ac, v21
v_cvt_pk_bf16_f32 v21, v21, v21
v_and_b32 v21, 0xffff0000, v21
v_sqrt_f32 v21, v21
s_nop 0
v_cvt_pk_bf16_f32 v21, v21, v21
v_and_b32 v21, 0xffff0000, v21
s_mov_b32 s63, 40960
s_mov_b32 exec_lo, 1
s_mov_b32 exec_hi, 1
buffer_store_dwordx2 v[20:21], v19, s[16:19], s63 offen sc1
s_mov_b64 exec, -1
s_setprio 0
s_barrier
ds_read_b64_tr_b16 v[104:105], v3 offset:0
ds_read_b64_tr_b16 v[106:107], v3 offset:512
ds_read_b128 v[80:83], v1 offset:0
ds_read_b128 v[84:87], v1 offset:2048
ds_read_b128 v[88:91], v1 offset:4096
ds_read_b128 v[92:95], v1 offset:6144
ds_read_b128 v[96:99], v1 offset:8192
ds_read_b128 v[100:103], v1 offset:10240
ds_read_b64_tr_b16 v[108:109], v3 offset:2048
ds_read_b64_tr_b16 v[110:111], v3 offset:2560
ds_read_b64_tr_b16 v[112:113], v4 offset:0
ds_read_b64_tr_b16 v[114:115], v4 offset:512
ds_read_b64_tr_b16 v[116:117], v4 offset:2048
ds_read_b64_tr_b16 v[118:119], v4 offset:2560
s_waitcnt lgkmcnt(0)
v_mfma_f32_16x16x32_bf16 v[160:163], v[104:107], v[80:83], 0
ds_read_b64_tr_b16 v[144:145], v3 offset:8192
v_mfma_f32_16x16x32_bf16 v[176:179], v[104:107], v[84:87], 0
ds_read_b64_tr_b16 v[146:147], v3 offset:8704
v_mfma_f32_16x16x32_bf16 v[192:195], v[104:107], v[88:91], 0
ds_read_b128 v[120:123], v2 offset:0
v_mfma_f32_16x16x32_bf16 v[208:211], v[104:107], v[92:95], 0
ds_read_b128 v[124:127], v2 offset:2048
v_mfma_f32_16x16x32_bf16 v[224:227], v[104:107], v[96:99], 0
ds_read_b128 v[128:131], v2 offset:4096
v_mfma_f32_16x16x32_bf16 v[240:243], v[104:107], v[100:103], 0
ds_read_b128 v[132:135], v2 offset:6144
v_mfma_f32_16x16x32_bf16 v[244:247], v[108:111], v[100:103], 0
ds_read_b128 v[136:139], v2 offset:8192
v_mfma_f32_16x16x32_bf16 v[228:231], v[108:111], v[96:99], 0
ds_read_b128 v[140:143], v2 offset:10240
v_mfma_f32_16x16x32_bf16 v[212:215], v[108:111], v[92:95], 0
ds_read_b64_tr_b16 v[148:149], v3 offset:10240
v_mfma_f32_16x16x32_bf16 v[196:199], v[108:111], v[88:91], 0
ds_read_b64_tr_b16 v[150:151], v3 offset:10752
v_mfma_f32_16x16x32_bf16 v[180:183], v[108:111], v[84:87], 0
ds_read_b64_tr_b16 v[152:153], v4 offset:8192
v_mfma_f32_16x16x32_bf16 v[164:167], v[108:111], v[80:83], 0
ds_read_b64_tr_b16 v[154:155], v4 offset:8704
v_mfma_f32_16x16x32_bf16 v[168:171], v[112:115], v[80:83], 0
ds_read_b64_tr_b16 v[156:157], v4 offset:10240
v_mfma_f32_16x16x32_bf16 v[184:187], v[112:115], v[84:87], 0
ds_read_b64_tr_b16 v[158:159], v4 offset:10752
v_mfma_f32_16x16x32_bf16 v[200:203], v[112:115], v[88:91], 0
v_add_u32 v1, 40960, v1
v_mfma_f32_16x16x32_bf16 v[216:219], v[112:115], v[92:95], 0
v_add_u32 v2, 40960, v2
v_mfma_f32_16x16x32_bf16 v[232:235], v[112:115], v[96:99], 0
v_add_u32 v3, 40960, v3
v_mfma_f32_16x16x32_bf16 v[248:251], v[112:115], v[100:103], 0
v_add_u32 v4, 40960, v4
v_mfma_f32_16x16x32_bf16 v[252:255], v[116:119], v[100:103], 0
v_mfma_f32_16x16x32_bf16 v[236:239], v[116:119], v[96:99], 0
v_mfma_f32_16x16x32_bf16 v[220:223], v[116:119], v[92:95], 0
v_mfma_f32_16x16x32_bf16 v[204:207], v[116:119], v[88:91], 0
v_mfma_f32_16x16x32_bf16 v[188:191], v[116:119], v[84:87], 0
v_mfma_f32_16x16x32_bf16 v[172:175], v[116:119], v[80:83], 0
s_waitcnt lgkmcnt(0)
s_waitcnt vmcnt(0)
s_barrier
v_mfma_f32_16x16x32_bf16 v[160:163], v[144:147], v[120:123], v[160:163]
ds_read_b64_tr_b16 v[104:105], v3 offset:0
v_mfma_f32_16x16x32_bf16 v[176:179], v[144:147], v[124:127], v[176:179]
ds_read_b64_tr_b16 v[106:107], v3 offset:512
v_mfma_f32_16x16x32_bf16 v[192:195], v[144:147], v[128:131], v[192:195]
ds_read_b128 v[80:83], v1 offset:0
v_mfma_f32_16x16x32_bf16 v[208:211], v[144:147], v[132:135], v[208:211]
ds_read_b128 v[84:87], v1 offset:2048
v_mfma_f32_16x16x32_bf16 v[224:227], v[144:147], v[136:139], v[224:227]
ds_read_b128 v[88:91], v1 offset:4096
v_mfma_f32_16x16x32_bf16 v[240:243], v[144:147], v[140:143], v[240:243]
ds_read_b128 v[92:95], v1 offset:6144
v_mfma_f32_16x16x32_bf16 v[244:247], v[148:151], v[140:143], v[244:247]
ds_read_b128 v[96:99], v1 offset:8192
v_mfma_f32_16x16x32_bf16 v[228:231], v[148:151], v[136:139], v[228:231]
ds_read_b128 v[100:103], v1 offset:10240
v_mfma_f32_16x16x32_bf16 v[212:215], v[148:151], v[132:135], v[212:215]
ds_read_b64_tr_b16 v[108:109], v3 offset:2048
v_mfma_f32_16x16x32_bf16 v[196:199], v[148:151], v[128:131], v[196:199]
ds_read_b64_tr_b16 v[110:111], v3 offset:2560
v_mfma_f32_16x16x32_bf16 v[180:183], v[148:151], v[124:127], v[180:183]
ds_read_b64_tr_b16 v[112:113], v4 offset:0
v_mfma_f32_16x16x32_bf16 v[164:167], v[148:151], v[120:123], v[164:167]
ds_read_b64_tr_b16 v[114:115], v4 offset:512
v_mfma_f32_16x16x32_bf16 v[168:171], v[152:155], v[120:123], v[168:171]
ds_read_b64_tr_b16 v[116:117], v4 offset:2048
v_mfma_f32_16x16x32_bf16 v[184:187], v[152:155], v[124:127], v[184:187]
ds_read_b64_tr_b16 v[118:119], v4 offset:2560
v_mfma_f32_16x16x32_bf16 v[200:203], v[152:155], v[128:131], v[200:203]
v_mfma_f32_16x16x32_bf16 v[216:219], v[152:155], v[132:135], v[216:219]
v_mfma_f32_16x16x32_bf16 v[232:235], v[152:155], v[136:139], v[232:235]
v_mfma_f32_16x16x32_bf16 v[248:251], v[152:155], v[140:143], v[248:251]
v_mfma_f32_16x16x32_bf16 v[252:255], v[156:159], v[140:143], v[252:255]
v_mfma_f32_16x16x32_bf16 v[236:239], v[156:159], v[136:139], v[236:239]
v_mfma_f32_16x16x32_bf16 v[220:223], v[156:159], v[132:135], v[220:223]
v_mfma_f32_16x16x32_bf16 v[204:207], v[156:159], v[128:131], v[204:207]
v_mfma_f32_16x16x32_bf16 v[188:191], v[156:159], v[124:127], v[188:191]
v_mfma_f32_16x16x32_bf16 v[172:175], v[156:159], v[120:123], v[172:175]
s_waitcnt lgkmcnt(0)
v_mfma_f32_16x16x32_bf16 v[160:163], v[104:107], v[80:83], v[160:163]
ds_read_b64_tr_b16 v[144:145], v3 offset:8192
v_mfma_f32_16x16x32_bf16 v[176:179], v[104:107], v[84:87], v[176:179]
ds_read_b64_tr_b16 v[146:147], v3 offset:8704
v_mfma_f32_16x16x32_bf16 v[192:195], v[104:107], v[88:91], v[192:195]
ds_read_b128 v[120:123], v2 offset:0
v_mfma_f32_16x16x32_bf16 v[208:211], v[104:107], v[92:95], v[208:211]
ds_read_b128 v[124:127], v2 offset:2048
v_mfma_f32_16x16x32_bf16 v[224:227], v[104:107], v[96:99], v[224:227]
ds_read_b128 v[128:131], v2 offset:4096
v_mfma_f32_16x16x32_bf16 v[240:243], v[104:107], v[100:103], v[240:243]
ds_read_b128 v[132:135], v2 offset:6144
v_mfma_f32_16x16x32_bf16 v[244:247], v[108:111], v[100:103], v[244:247]
ds_read_b128 v[136:139], v2 offset:8192
v_mfma_f32_16x16x32_bf16 v[228:231], v[108:111], v[96:99], v[228:231]
ds_read_b128 v[140:143], v2 offset:10240
v_mfma_f32_16x16x32_bf16 v[212:215], v[108:111], v[92:95], v[212:215]
ds_read_b64_tr_b16 v[148:149], v3 offset:10240
v_mfma_f32_16x16x32_bf16 v[196:199], v[108:111], v[88:91], v[196:199]
ds_read_b64_tr_b16 v[150:151], v3 offset:10752
v_mfma_f32_16x16x32_bf16 v[180:183], v[108:111], v[84:87], v[180:183]
ds_read_b64_tr_b16 v[152:153], v4 offset:8192
v_mfma_f32_16x16x32_bf16 v[164:167], v[108:111], v[80:83], v[164:167]
ds_read_b64_tr_b16 v[154:155], v4 offset:8704
v_mfma_f32_16x16x32_bf16 v[168:171], v[112:115], v[80:83], v[168:171]
ds_read_b64_tr_b16 v[156:157], v4 offset:10240
v_mfma_f32_16x16x32_bf16 v[184:187], v[112:115], v[84:87], v[184:187]
ds_read_b64_tr_b16 v[158:159], v4 offset:10752
v_mfma_f32_16x16x32_bf16 v[200:203], v[112:115], v[88:91], v[200:203]
v_add_u32 v1, 40960, v1
v_mfma_f32_16x16x32_bf16 v[216:219], v[112:115], v[92:95], v[216:219]
v_add_u32 v2, 40960, v2
v_mfma_f32_16x16x32_bf16 v[232:235], v[112:115], v[96:99], v[232:235]
v_add_u32 v3, 40960, v3
v_mfma_f32_16x16x32_bf16 v[248:251], v[112:115], v[100:103], v[248:251]
v_add_u32 v4, 40960, v4
v_mfma_f32_16x16x32_bf16 v[252:255], v[116:119], v[100:103], v[252:255]
v_mfma_f32_16x16x32_bf16 v[236:239], v[116:119], v[96:99], v[236:239]
v_mfma_f32_16x16x32_bf16 v[220:223], v[116:119], v[92:95], v[220:223]
v_mfma_f32_16x16x32_bf16 v[204:207], v[116:119], v[88:91], v[204:207]
v_mfma_f32_16x16x32_bf16 v[188:191], v[116:119], v[84:87], v[188:191]
v_mfma_f32_16x16x32_bf16 v[172:175], v[116:119], v[80:83], v[172:175]
s_waitcnt lgkmcnt(0)
s_barrier
v_mfma_f32_16x16x32_bf16 v[160:163], v[144:147], v[120:123], v[160:163]
ds_read_b64_tr_b16 v[104:105], v3 offset:0
v_mfma_f32_16x16x32_bf16 v[176:179], v[144:147], v[124:127], v[176:179]
ds_read_b64_tr_b16 v[106:107], v3 offset:512
v_mfma_f32_16x16x32_bf16 v[192:195], v[144:147], v[128:131], v[192:195]
ds_read_b128 v[80:83], v1 offset:0
v_mfma_f32_16x16x32_bf16 v[208:211], v[144:147], v[132:135], v[208:211]
ds_read_b128 v[84:87], v1 offset:2048
v_mfma_f32_16x16x32_bf16 v[224:227], v[144:147], v[136:139], v[224:227]
ds_read_b128 v[88:91], v1 offset:4096
v_mfma_f32_16x16x32_bf16 v[240:243], v[144:147], v[140:143], v[240:243]
ds_read_b128 v[92:95], v1 offset:6144
v_mfma_f32_16x16x32_bf16 v[244:247], v[148:151], v[140:143], v[244:247]
ds_read_b128 v[96:99], v1 offset:8192
v_mfma_f32_16x16x32_bf16 v[228:231], v[148:151], v[136:139], v[228:231]
ds_read_b128 v[100:103], v1 offset:10240
v_mfma_f32_16x16x32_bf16 v[212:215], v[148:151], v[132:135], v[212:215]
ds_read_b64_tr_b16 v[108:109], v3 offset:2048
v_mfma_f32_16x16x32_bf16 v[196:199], v[148:151], v[128:131], v[196:199]
ds_read_b64_tr_b16 v[110:111], v3 offset:2560
v_mfma_f32_16x16x32_bf16 v[180:183], v[148:151], v[124:127], v[180:183]
ds_read_b64_tr_b16 v[112:113], v4 offset:0
v_mfma_f32_16x16x32_bf16 v[164:167], v[148:151], v[120:123], v[164:167]
ds_read_b64_tr_b16 v[114:115], v4 offset:512
v_mfma_f32_16x16x32_bf16 v[168:171], v[152:155], v[120:123], v[168:171]
ds_read_b64_tr_b16 v[116:117], v4 offset:2048
v_mfma_f32_16x16x32_bf16 v[184:187], v[152:155], v[124:127], v[184:187]
ds_read_b64_tr_b16 v[118:119], v4 offset:2560
v_mfma_f32_16x16x32_bf16 v[200:203], v[152:155], v[128:131], v[200:203]
v_mfma_f32_16x16x32_bf16 v[216:219], v[152:155], v[132:135], v[216:219]
v_mfma_f32_16x16x32_bf16 v[232:235], v[152:155], v[136:139], v[232:235]
v_mfma_f32_16x16x32_bf16 v[248:251], v[152:155], v[140:143], v[248:251]
v_mfma_f32_16x16x32_bf16 v[252:255], v[156:159], v[140:143], v[252:255]
v_mfma_f32_16x16x32_bf16 v[236:239], v[156:159], v[136:139], v[236:239]
v_mfma_f32_16x16x32_bf16 v[220:223], v[156:159], v[132:135], v[220:223]
v_mfma_f32_16x16x32_bf16 v[204:207], v[156:159], v[128:131], v[204:207]
v_mfma_f32_16x16x32_bf16 v[188:191], v[156:159], v[124:127], v[188:191]
v_mfma_f32_16x16x32_bf16 v[172:175], v[156:159], v[120:123], v[172:175]
s_waitcnt lgkmcnt(0)
v_mfma_f32_16x16x32_bf16 v[160:163], v[104:107], v[80:83], v[160:163]
ds_read_b64_tr_b16 v[144:145], v3 offset:8192
v_mfma_f32_16x16x32_bf16 v[176:179], v[104:107], v[84:87], v[176:179]
ds_read_b64_tr_b16 v[146:147], v3 offset:8704
v_mfma_f32_16x16x32_bf16 v[192:195], v[104:107], v[88:91], v[192:195]
ds_read_b128 v[120:123], v2 offset:0
v_mfma_f32_16x16x32_bf16 v[208:211], v[104:107], v[92:95], v[208:211]
ds_read_b128 v[124:127], v2 offset:2048
v_mfma_f32_16x16x32_bf16 v[224:227], v[104:107], v[96:99], v[224:227]
ds_read_b128 v[128:131], v2 offset:4096
v_mfma_f32_16x16x32_bf16 v[240:243], v[104:107], v[100:103], v[240:243]
ds_read_b128 v[132:135], v2 offset:6144
v_mfma_f32_16x16x32_bf16 v[244:247], v[108:111], v[100:103], v[244:247]
ds_read_b128 v[136:139], v2 offset:8192
v_mfma_f32_16x16x32_bf16 v[228:231], v[108:111], v[96:99], v[228:231]
ds_read_b128 v[140:143], v2 offset:10240
v_mfma_f32_16x16x32_bf16 v[212:215], v[108:111], v[92:95], v[212:215]
ds_read_b64_tr_b16 v[148:149], v3 offset:10240
v_mfma_f32_16x16x32_bf16 v[196:199], v[108:111], v[88:91], v[196:199]
ds_read_b64_tr_b16 v[150:151], v3 offset:10752
v_mfma_f32_16x16x32_bf16 v[180:183], v[108:111], v[84:87], v[180:183]
ds_read_b64_tr_b16 v[152:153], v4 offset:8192
v_mfma_f32_16x16x32_bf16 v[164:167], v[108:111], v[80:83], v[164:167]
ds_read_b64_tr_b16 v[154:155], v4 offset:8704
v_mfma_f32_16x16x32_bf16 v[168:171], v[112:115], v[80:83], v[168:171]
ds_read_b64_tr_b16 v[156:157], v4 offset:10240
v_mfma_f32_16x16x32_bf16 v[184:187], v[112:115], v[84:87], v[184:187]
ds_read_b64_tr_b16 v[158:159], v4 offset:10752
v_mfma_f32_16x16x32_bf16 v[200:203], v[112:115], v[88:91], v[200:203]
v_subrev_u32 v1, 81920, v1
v_mfma_f32_16x16x32_bf16 v[216:219], v[112:115], v[92:95], v[216:219]
v_subrev_u32 v2, 81920, v2
v_mfma_f32_16x16x32_bf16 v[232:235], v[112:115], v[96:99], v[232:235]
v_subrev_u32 v3, 81920, v3
v_mfma_f32_16x16x32_bf16 v[248:251], v[112:115], v[100:103], v[248:251]
v_subrev_u32 v4, 81920, v4
v_mfma_f32_16x16x32_bf16 v[252:255], v[116:119], v[100:103], v[252:255]
v_mfma_f32_16x16x32_bf16 v[236:239], v[116:119], v[96:99], v[236:239]
v_mfma_f32_16x16x32_bf16 v[220:223], v[116:119], v[92:95], v[220:223]
v_mfma_f32_16x16x32_bf16 v[204:207], v[116:119], v[88:91], v[204:207]
v_mfma_f32_16x16x32_bf16 v[188:191], v[116:119], v[84:87], v[188:191]
v_mfma_f32_16x16x32_bf16 v[172:175], v[116:119], v[80:83], v[172:175]
s_waitcnt lgkmcnt(0)
s_barrier
v_mfma_f32_16x16x32_bf16 v[160:163], v[144:147], v[120:123], v[160:163]
ds_read_b64_tr_b16 v[104:105], v3 offset:0
v_mfma_f32_16x16x32_bf16 v[176:179], v[144:147], v[124:127], v[176:179]
ds_read_b64_tr_b16 v[106:107], v3 offset:512
v_mfma_f32_16x16x32_bf16 v[192:195], v[144:147], v[128:131], v[192:195]
ds_read_b128 v[80:83], v1 offset:0
v_mfma_f32_16x16x32_bf16 v[208:211], v[144:147], v[132:135], v[208:211]
ds_read_b128 v[84:87], v1 offset:2048
v_mfma_f32_16x16x32_bf16 v[224:227], v[144:147], v[136:139], v[224:227]
ds_read_b128 v[88:91], v1 offset:4096
v_mfma_f32_16x16x32_bf16 v[240:243], v[144:147], v[140:143], v[240:243]
ds_read_b128 v[92:95], v1 offset:6144
v_mfma_f32_16x16x32_bf16 v[244:247], v[148:151], v[140:143], v[244:247]
ds_read_b128 v[96:99], v1 offset:8192
v_mfma_f32_16x16x32_bf16 v[228:231], v[148:151], v[136:139], v[228:231]
ds_read_b128 v[100:103], v1 offset:10240
v_mfma_f32_16x16x32_bf16 v[212:215], v[148:151], v[132:135], v[212:215]
ds_read_b64_tr_b16 v[108:109], v3 offset:2048
v_mfma_f32_16x16x32_bf16 v[196:199], v[148:151], v[128:131], v[196:199]
ds_read_b64_tr_b16 v[110:111], v3 offset:2560
v_mfma_f32_16x16x32_bf16 v[180:183], v[148:151], v[124:127], v[180:183]
ds_read_b64_tr_b16 v[112:113], v4 offset:0
v_mfma_f32_16x16x32_bf16 v[164:167], v[148:151], v[120:123], v[164:167]
ds_read_b64_tr_b16 v[114:115], v4 offset:512
v_mfma_f32_16x16x32_bf16 v[168:171], v[152:155], v[120:123], v[168:171]
ds_read_b64_tr_b16 v[116:117], v4 offset:2048
v_mfma_f32_16x16x32_bf16 v[184:187], v[152:155], v[124:127], v[184:187]
ds_read_b64_tr_b16 v[118:119], v4 offset:2560
v_mfma_f32_16x16x32_bf16 v[200:203], v[152:155], v[128:131], v[200:203]
v_mfma_f32_16x16x32_bf16 v[216:219], v[152:155], v[132:135], v[216:219]
v_mfma_f32_16x16x32_bf16 v[232:235], v[152:155], v[136:139], v[232:235]
v_mfma_f32_16x16x32_bf16 v[248:251], v[152:155], v[140:143], v[248:251]
v_mfma_f32_16x16x32_bf16 v[252:255], v[156:159], v[140:143], v[252:255]
v_mfma_f32_16x16x32_bf16 v[236:239], v[156:159], v[136:139], v[236:239]
v_mfma_f32_16x16x32_bf16 v[220:223], v[156:159], v[132:135], v[220:223]
v_mfma_f32_16x16x32_bf16 v[204:207], v[156:159], v[128:131], v[204:207]
v_mfma_f32_16x16x32_bf16 v[188:191], v[156:159], v[124:127], v[188:191]
v_mfma_f32_16x16x32_bf16 v[172:175], v[156:159], v[120:123], v[172:175]
s_waitcnt lgkmcnt(0)
v_mfma_f32_16x16x32_bf16 v[160:163], v[104:107], v[80:83], v[160:163]
ds_read_b64_tr_b16 v[144:145], v3 offset:8192
v_mfma_f32_16x16x32_bf16 v[176:179], v[104:107], v[84:87], v[176:179]
ds_read_b64_tr_b16 v[146:147], v3 offset:8704
v_mfma_f32_16x16x32_bf16 v[192:195], v[104:107], v[88:91], v[192:195]
ds_read_b128 v[120:123], v2 offset:0
v_mfma_f32_16x16x32_bf16 v[208:211], v[104:107], v[92:95], v[208:211]
ds_read_b128 v[124:127], v2 offset:2048
v_mfma_f32_16x16x32_bf16 v[224:227], v[104:107], v[96:99], v[224:227]
ds_read_b128 v[128:131], v2 offset:4096
v_mfma_f32_16x16x32_bf16 v[240:243], v[104:107], v[100:103], v[240:243]
ds_read_b128 v[132:135], v2 offset:6144
v_mfma_f32_16x16x32_bf16 v[244:247], v[108:111], v[100:103], v[244:247]
ds_read_b128 v[136:139], v2 offset:8192
v_mfma_f32_16x16x32_bf16 v[228:231], v[108:111], v[96:99], v[228:231]
ds_read_b128 v[140:143], v2 offset:10240
v_mfma_f32_16x16x32_bf16 v[212:215], v[108:111], v[92:95], v[212:215]
ds_read_b64_tr_b16 v[148:149], v3 offset:10240
v_mfma_f32_16x16x32_bf16 v[196:199], v[108:111], v[88:91], v[196:199]
ds_read_b64_tr_b16 v[150:151], v3 offset:10752
v_mfma_f32_16x16x32_bf16 v[180:183], v[108:111], v[84:87], v[180:183]
ds_read_b64_tr_b16 v[152:153], v4 offset:8192
v_mfma_f32_16x16x32_bf16 v[164:167], v[108:111], v[80:83], v[164:167]
ds_read_b64_tr_b16 v[154:155], v4 offset:8704
v_mfma_f32_16x16x32_bf16 v[168:171], v[112:115], v[80:83], v[168:171]
ds_read_b64_tr_b16 v[156:157], v4 offset:10240
v_mfma_f32_16x16x32_bf16 v[184:187], v[112:115], v[84:87], v[184:187]
ds_read_b64_tr_b16 v[158:159], v4 offset:10752
v_mfma_f32_16x16x32_bf16 v[200:203], v[112:115], v[88:91], v[200:203]
v_add_u32 v1, 40960, v1
v_mfma_f32_16x16x32_bf16 v[216:219], v[112:115], v[92:95], v[216:219]
v_add_u32 v2, 40960, v2
v_mfma_f32_16x16x32_bf16 v[232:235], v[112:115], v[96:99], v[232:235]
v_add_u32 v3, 40960, v3
v_mfma_f32_16x16x32_bf16 v[248:251], v[112:115], v[100:103], v[248:251]
v_add_u32 v4, 40960, v4
v_mfma_f32_16x16x32_bf16 v[252:255], v[116:119], v[100:103], v[252:255]
v_mfma_f32_16x16x32_bf16 v[236:239], v[116:119], v[96:99], v[236:239]
v_mfma_f32_16x16x32_bf16 v[220:223], v[116:119], v[92:95], v[220:223]
v_mfma_f32_16x16x32_bf16 v[204:207], v[116:119], v[88:91], v[204:207]
v_mfma_f32_16x16x32_bf16 v[188:191], v[116:119], v[84:87], v[188:191]
v_mfma_f32_16x16x32_bf16 v[172:175], v[116:119], v[80:83], v[172:175]
s_waitcnt lgkmcnt(0)
s_barrier
v_mfma_f32_16x16x32_bf16 v[160:163], v[144:147], v[120:123], v[160:163]
ds_read_b64_tr_b16 v[104:105], v3 offset:0
v_mfma_f32_16x16x32_bf16 v[176:179], v[144:147], v[124:127], v[176:179]
ds_read_b64_tr_b16 v[106:107], v3 offset:512
v_mfma_f32_16x16x32_bf16 v[192:195], v[144:147], v[128:131], v[192:195]
ds_read_b128 v[80:83], v1 offset:0
v_mfma_f32_16x16x32_bf16 v[208:211], v[144:147], v[132:135], v[208:211]
ds_read_b128 v[84:87], v1 offset:2048
v_mfma_f32_16x16x32_bf16 v[224:227], v[144:147], v[136:139], v[224:227]
ds_read_b128 v[88:91], v1 offset:4096
v_mfma_f32_16x16x32_bf16 v[240:243], v[144:147], v[140:143], v[240:243]
ds_read_b128 v[92:95], v1 offset:6144
v_mfma_f32_16x16x32_bf16 v[244:247], v[148:151], v[140:143], v[244:247]
ds_read_b128 v[96:99], v1 offset:8192
v_mfma_f32_16x16x32_bf16 v[228:231], v[148:151], v[136:139], v[228:231]
ds_read_b128 v[100:103], v1 offset:10240
v_mfma_f32_16x16x32_bf16 v[212:215], v[148:151], v[132:135], v[212:215]
ds_read_b64_tr_b16 v[108:109], v3 offset:2048
v_mfma_f32_16x16x32_bf16 v[196:199], v[148:151], v[128:131], v[196:199]
ds_read_b64_tr_b16 v[110:111], v3 offset:2560
v_mfma_f32_16x16x32_bf16 v[180:183], v[148:151], v[124:127], v[180:183]
ds_read_b64_tr_b16 v[112:113], v4 offset:0
v_mfma_f32_16x16x32_bf16 v[164:167], v[148:151], v[120:123], v[164:167]
ds_read_b64_tr_b16 v[114:115], v4 offset:512
v_mfma_f32_16x16x32_bf16 v[168:171], v[152:155], v[120:123], v[168:171]
ds_read_b64_tr_b16 v[116:117], v4 offset:2048
v_mfma_f32_16x16x32_bf16 v[184:187], v[152:155], v[124:127], v[184:187]
ds_read_b64_tr_b16 v[118:119], v4 offset:2560
v_mfma_f32_16x16x32_bf16 v[200:203], v[152:155], v[128:131], v[200:203]
v_mfma_f32_16x16x32_bf16 v[216:219], v[152:155], v[132:135], v[216:219]
v_mfma_f32_16x16x32_bf16 v[232:235], v[152:155], v[136:139], v[232:235]
v_mfma_f32_16x16x32_bf16 v[248:251], v[152:155], v[140:143], v[248:251]
v_mfma_f32_16x16x32_bf16 v[252:255], v[156:159], v[140:143], v[252:255]
v_mfma_f32_16x16x32_bf16 v[236:239], v[156:159], v[136:139], v[236:239]
v_mfma_f32_16x16x32_bf16 v[220:223], v[156:159], v[132:135], v[220:223]
v_mfma_f32_16x16x32_bf16 v[204:207], v[156:159], v[128:131], v[204:207]
v_mfma_f32_16x16x32_bf16 v[188:191], v[156:159], v[124:127], v[188:191]
v_mfma_f32_16x16x32_bf16 v[172:175], v[156:159], v[120:123], v[172:175]
s_waitcnt lgkmcnt(0)
v_mfma_f32_16x16x32_bf16 v[160:163], v[104:107], v[80:83], v[160:163]
ds_read_b64_tr_b16 v[144:145], v3 offset:8192
v_mfma_f32_16x16x32_bf16 v[176:179], v[104:107], v[84:87], v[176:179]
ds_read_b64_tr_b16 v[146:147], v3 offset:8704
v_mfma_f32_16x16x32_bf16 v[192:195], v[104:107], v[88:91], v[192:195]
ds_read_b128 v[120:123], v2 offset:0
v_mfma_f32_16x16x32_bf16 v[208:211], v[104:107], v[92:95], v[208:211]
ds_read_b128 v[124:127], v2 offset:2048
v_mfma_f32_16x16x32_bf16 v[224:227], v[104:107], v[96:99], v[224:227]
ds_read_b128 v[128:131], v2 offset:4096
v_mfma_f32_16x16x32_bf16 v[240:243], v[104:107], v[100:103], v[240:243]
ds_read_b128 v[132:135], v2 offset:6144
v_mfma_f32_16x16x32_bf16 v[244:247], v[108:111], v[100:103], v[244:247]
ds_read_b128 v[136:139], v2 offset:8192
v_mfma_f32_16x16x32_bf16 v[228:231], v[108:111], v[96:99], v[228:231]
ds_read_b128 v[140:143], v2 offset:10240
v_mfma_f32_16x16x32_bf16 v[212:215], v[108:111], v[92:95], v[212:215]
ds_read_b64_tr_b16 v[148:149], v3 offset:10240
v_mfma_f32_16x16x32_bf16 v[196:199], v[108:111], v[88:91], v[196:199]
ds_read_b64_tr_b16 v[150:151], v3 offset:10752
v_mfma_f32_16x16x32_bf16 v[180:183], v[108:111], v[84:87], v[180:183]
ds_read_b64_tr_b16 v[152:153], v4 offset:8192
v_mfma_f32_16x16x32_bf16 v[164:167], v[108:111], v[80:83], v[164:167]
ds_read_b64_tr_b16 v[154:155], v4 offset:8704
v_mfma_f32_16x16x32_bf16 v[168:171], v[112:115], v[80:83], v[168:171]
ds_read_b64_tr_b16 v[156:157], v4 offset:10240
v_mfma_f32_16x16x32_bf16 v[184:187], v[112:115], v[84:87], v[184:187]
ds_read_b64_tr_b16 v[158:159], v4 offset:10752
v_mfma_f32_16x16x32_bf16 v[200:203], v[112:115], v[88:91], v[200:203]
v_add_u32 v1, 40960, v1
v_mfma_f32_16x16x32_bf16 v[216:219], v[112:115], v[92:95], v[216:219]
v_add_u32 v2, 40960, v2
v_mfma_f32_16x16x32_bf16 v[232:235], v[112:115], v[96:99], v[232:235]
v_add_u32 v3, 40960, v3
v_mfma_f32_16x16x32_bf16 v[248:251], v[112:115], v[100:103], v[248:251]
v_add_u32 v4, 40960, v4
v_mfma_f32_16x16x32_bf16 v[252:255], v[116:119], v[100:103], v[252:255]
v_mfma_f32_16x16x32_bf16 v[236:239], v[116:119], v[96:99], v[236:239]
v_mfma_f32_16x16x32_bf16 v[220:223], v[116:119], v[92:95], v[220:223]
v_mfma_f32_16x16x32_bf16 v[204:207], v[116:119], v[88:91], v[204:207]
v_mfma_f32_16x16x32_bf16 v[188:191], v[116:119], v[84:87], v[188:191]
v_mfma_f32_16x16x32_bf16 v[172:175], v[116:119], v[80:83], v[172:175]
s_waitcnt lgkmcnt(0)
s_barrier
v_mfma_f32_16x16x32_bf16 v[160:163], v[144:147], v[120:123], v[160:163]
ds_read_b64_tr_b16 v[104:105], v3 offset:0
v_mfma_f32_16x16x32_bf16 v[176:179], v[144:147], v[124:127], v[176:179]
ds_read_b64_tr_b16 v[106:107], v3 offset:512
v_mfma_f32_16x16x32_bf16 v[192:195], v[144:147], v[128:131], v[192:195]
ds_read_b128 v[80:83], v1 offset:0
v_mfma_f32_16x16x32_bf16 v[208:211], v[144:147], v[132:135], v[208:211]
ds_read_b128 v[84:87], v1 offset:2048
v_mfma_f32_16x16x32_bf16 v[224:227], v[144:147], v[136:139], v[224:227]
ds_read_b128 v[88:91], v1 offset:4096
v_mfma_f32_16x16x32_bf16 v[240:243], v[144:147], v[140:143], v[240:243]
ds_read_b128 v[92:95], v1 offset:6144
v_mfma_f32_16x16x32_bf16 v[244:247], v[148:151], v[140:143], v[244:247]
ds_read_b128 v[96:99], v1 offset:8192
v_mfma_f32_16x16x32_bf16 v[228:231], v[148:151], v[136:139], v[228:231]
ds_read_b128 v[100:103], v1 offset:10240
v_mfma_f32_16x16x32_bf16 v[212:215], v[148:151], v[132:135], v[212:215]
ds_read_b64_tr_b16 v[108:109], v3 offset:2048
v_mfma_f32_16x16x32_bf16 v[196:199], v[148:151], v[128:131], v[196:199]
ds_read_b64_tr_b16 v[110:111], v3 offset:2560
v_mfma_f32_16x16x32_bf16 v[180:183], v[148:151], v[124:127], v[180:183]
ds_read_b64_tr_b16 v[112:113], v4 offset:0
v_mfma_f32_16x16x32_bf16 v[164:167], v[148:151], v[120:123], v[164:167]
ds_read_b64_tr_b16 v[114:115], v4 offset:512
v_mfma_f32_16x16x32_bf16 v[168:171], v[152:155], v[120:123], v[168:171]
ds_read_b64_tr_b16 v[116:117], v4 offset:2048
v_mfma_f32_16x16x32_bf16 v[184:187], v[152:155], v[124:127], v[184:187]
ds_read_b64_tr_b16 v[118:119], v4 offset:2560
v_mfma_f32_16x16x32_bf16 v[200:203], v[152:155], v[128:131], v[200:203]
v_mfma_f32_16x16x32_bf16 v[216:219], v[152:155], v[132:135], v[216:219]
v_mfma_f32_16x16x32_bf16 v[232:235], v[152:155], v[136:139], v[232:235]
v_mfma_f32_16x16x32_bf16 v[248:251], v[152:155], v[140:143], v[248:251]
v_mfma_f32_16x16x32_bf16 v[252:255], v[156:159], v[140:143], v[252:255]
v_mfma_f32_16x16x32_bf16 v[236:239], v[156:159], v[136:139], v[236:239]
v_mfma_f32_16x16x32_bf16 v[220:223], v[156:159], v[132:135], v[220:223]
v_mfma_f32_16x16x32_bf16 v[204:207], v[156:159], v[128:131], v[204:207]
v_mfma_f32_16x16x32_bf16 v[188:191], v[156:159], v[124:127], v[188:191]
v_mfma_f32_16x16x32_bf16 v[172:175], v[156:159], v[120:123], v[172:175]
s_waitcnt lgkmcnt(0)
v_mfma_f32_16x16x32_bf16 v[160:163], v[104:107], v[80:83], v[160:163]
ds_read_b64_tr_b16 v[144:145], v3 offset:8192
v_mfma_f32_16x16x32_bf16 v[176:179], v[104:107], v[84:87], v[176:179]
ds_read_b64_tr_b16 v[146:147], v3 offset:8704
v_mfma_f32_16x16x32_bf16 v[192:195], v[104:107], v[88:91], v[192:195]
ds_read_b128 v[120:123], v2 offset:0
v_mfma_f32_16x16x32_bf16 v[208:211], v[104:107], v[92:95], v[208:211]
ds_read_b128 v[124:127], v2 offset:2048
v_mfma_f32_16x16x32_bf16 v[224:227], v[104:107], v[96:99], v[224:227]
ds_read_b128 v[128:131], v2 offset:4096
v_mfma_f32_16x16x32_bf16 v[240:243], v[104:107], v[100:103], v[240:243]
ds_read_b128 v[132:135], v2 offset:6144
v_mfma_f32_16x16x32_bf16 v[244:247], v[108:111], v[100:103], v[244:247]
ds_read_b128 v[136:139], v2 offset:8192
v_mfma_f32_16x16x32_bf16 v[228:231], v[108:111], v[96:99], v[228:231]
ds_read_b128 v[140:143], v2 offset:10240
v_mfma_f32_16x16x32_bf16 v[212:215], v[108:111], v[92:95], v[212:215]
ds_read_b64_tr_b16 v[148:149], v3 offset:10240
v_mfma_f32_16x16x32_bf16 v[196:199], v[108:111], v[88:91], v[196:199]
ds_read_b64_tr_b16 v[150:151], v3 offset:10752
v_mfma_f32_16x16x32_bf16 v[180:183], v[108:111], v[84:87], v[180:183]
ds_read_b64_tr_b16 v[152:153], v4 offset:8192
v_mfma_f32_16x16x32_bf16 v[164:167], v[108:111], v[80:83], v[164:167]
ds_read_b64_tr_b16 v[154:155], v4 offset:8704
v_mfma_f32_16x16x32_bf16 v[168:171], v[112:115], v[80:83], v[168:171]
ds_read_b64_tr_b16 v[156:157], v4 offset:10240
v_mfma_f32_16x16x32_bf16 v[184:187], v[112:115], v[84:87], v[184:187]
ds_read_b64_tr_b16 v[158:159], v4 offset:10752
v_mfma_f32_16x16x32_bf16 v[200:203], v[112:115], v[88:91], v[200:203]
v_subrev_u32 v1, 81920, v1
v_mfma_f32_16x16x32_bf16 v[216:219], v[112:115], v[92:95], v[216:219]
v_subrev_u32 v2, 81920, v2
v_mfma_f32_16x16x32_bf16 v[232:235], v[112:115], v[96:99], v[232:235]
v_subrev_u32 v3, 81920, v3
v_mfma_f32_16x16x32_bf16 v[248:251], v[112:115], v[100:103], v[248:251]
v_subrev_u32 v4, 81920, v4
v_mfma_f32_16x16x32_bf16 v[252:255], v[116:119], v[100:103], v[252:255]
v_mfma_f32_16x16x32_bf16 v[236:239], v[116:119], v[96:99], v[236:239]
v_mfma_f32_16x16x32_bf16 v[220:223], v[116:119], v[92:95], v[220:223]
v_mfma_f32_16x16x32_bf16 v[204:207], v[116:119], v[88:91], v[204:207]
v_mfma_f32_16x16x32_bf16 v[188:191], v[116:119], v[84:87], v[188:191]
v_mfma_f32_16x16x32_bf16 v[172:175], v[116:119], v[80:83], v[172:175]
s_waitcnt lgkmcnt(0)
s_barrier
v_mfma_f32_16x16x32_bf16 v[160:163], v[144:147], v[120:123], v[160:163]
ds_read_b64_tr_b16 v[104:105], v3 offset:0
v_mfma_f32_16x16x32_bf16 v[176:179], v[144:147], v[124:127], v[176:179]
ds_read_b64_tr_b16 v[106:107], v3 offset:512
v_mfma_f32_16x16x32_bf16 v[192:195], v[144:147], v[128:131], v[192:195]
ds_read_b128 v[80:83], v1 offset:0
v_mfma_f32_16x16x32_bf16 v[208:211], v[144:147], v[132:135], v[208:211]
ds_read_b128 v[84:87], v1 offset:2048
v_mfma_f32_16x16x32_bf16 v[224:227], v[144:147], v[136:139], v[224:227]
ds_read_b128 v[88:91], v1 offset:4096
v_mfma_f32_16x16x32_bf16 v[240:243], v[144:147], v[140:143], v[240:243]
ds_read_b128 v[92:95], v1 offset:6144
v_mfma_f32_16x16x32_bf16 v[244:247], v[148:151], v[140:143], v[244:247]
ds_read_b128 v[96:99], v1 offset:8192
v_mfma_f32_16x16x32_bf16 v[228:231], v[148:151], v[136:139], v[228:231]
ds_read_b128 v[100:103], v1 offset:10240
v_mfma_f32_16x16x32_bf16 v[212:215], v[148:151], v[132:135], v[212:215]
ds_read_b64_tr_b16 v[108:109], v3 offset:2048
v_mfma_f32_16x16x32_bf16 v[196:199], v[148:151], v[128:131], v[196:199]
ds_read_b64_tr_b16 v[110:111], v3 offset:2560
v_mfma_f32_16x16x32_bf16 v[180:183], v[148:151], v[124:127], v[180:183]
ds_read_b64_tr_b16 v[112:113], v4 offset:0
v_mfma_f32_16x16x32_bf16 v[164:167], v[148:151], v[120:123], v[164:167]
ds_read_b64_tr_b16 v[114:115], v4 offset:512
v_mfma_f32_16x16x32_bf16 v[168:171], v[152:155], v[120:123], v[168:171]
ds_read_b64_tr_b16 v[116:117], v4 offset:2048
v_mfma_f32_16x16x32_bf16 v[184:187], v[152:155], v[124:127], v[184:187]
ds_read_b64_tr_b16 v[118:119], v4 offset:2560
v_mfma_f32_16x16x32_bf16 v[200:203], v[152:155], v[128:131], v[200:203]
v_mfma_f32_16x16x32_bf16 v[216:219], v[152:155], v[132:135], v[216:219]
v_mfma_f32_16x16x32_bf16 v[232:235], v[152:155], v[136:139], v[232:235]
v_mfma_f32_16x16x32_bf16 v[248:251], v[152:155], v[140:143], v[248:251]
v_mfma_f32_16x16x32_bf16 v[252:255], v[156:159], v[140:143], v[252:255]
v_mfma_f32_16x16x32_bf16 v[236:239], v[156:159], v[136:139], v[236:239]
v_mfma_f32_16x16x32_bf16 v[220:223], v[156:159], v[132:135], v[220:223]
v_mfma_f32_16x16x32_bf16 v[204:207], v[156:159], v[128:131], v[204:207]
v_mfma_f32_16x16x32_bf16 v[188:191], v[156:159], v[124:127], v[188:191]
v_mfma_f32_16x16x32_bf16 v[172:175], v[156:159], v[120:123], v[172:175]
s_waitcnt lgkmcnt(0)
v_mfma_f32_16x16x32_bf16 v[160:163], v[104:107], v[80:83], v[160:163]
ds_read_b64_tr_b16 v[144:145], v3 offset:8192
v_mfma_f32_16x16x32_bf16 v[176:179], v[104:107], v[84:87], v[176:179]
ds_read_b64_tr_b16 v[146:147], v3 offset:8704
v_mfma_f32_16x16x32_bf16 v[192:195], v[104:107], v[88:91], v[192:195]
ds_read_b128 v[120:123], v2 offset:0
v_mfma_f32_16x16x32_bf16 v[208:211], v[104:107], v[92:95], v[208:211]
ds_read_b128 v[124:127], v2 offset:2048
v_mfma_f32_16x16x32_bf16 v[224:227], v[104:107], v[96:99], v[224:227]
ds_read_b128 v[128:131], v2 offset:4096
v_mfma_f32_16x16x32_bf16 v[240:243], v[104:107], v[100:103], v[240:243]
ds_read_b128 v[132:135], v2 offset:6144
v_mfma_f32_16x16x32_bf16 v[244:247], v[108:111], v[100:103], v[244:247]
ds_read_b128 v[136:139], v2 offset:8192
v_mfma_f32_16x16x32_bf16 v[228:231], v[108:111], v[96:99], v[228:231]
ds_read_b128 v[140:143], v2 offset:10240
v_mfma_f32_16x16x32_bf16 v[212:215], v[108:111], v[92:95], v[212:215]
ds_read_b64_tr_b16 v[148:149], v3 offset:10240
v_mfma_f32_16x16x32_bf16 v[196:199], v[108:111], v[88:91], v[196:199]
ds_read_b64_tr_b16 v[150:151], v3 offset:10752
v_mfma_f32_16x16x32_bf16 v[180:183], v[108:111], v[84:87], v[180:183]
ds_read_b64_tr_b16 v[152:153], v4 offset:8192
v_mfma_f32_16x16x32_bf16 v[164:167], v[108:111], v[80:83], v[164:167]
ds_read_b64_tr_b16 v[154:155], v4 offset:8704
v_mfma_f32_16x16x32_bf16 v[168:171], v[112:115], v[80:83], v[168:171]
ds_read_b64_tr_b16 v[156:157], v4 offset:10240
v_mfma_f32_16x16x32_bf16 v[184:187], v[112:115], v[84:87], v[184:187]
ds_read_b64_tr_b16 v[158:159], v4 offset:10752
v_mfma_f32_16x16x32_bf16 v[200:203], v[112:115], v[88:91], v[200:203]
v_add_u32 v1, 40960, v1
v_mfma_f32_16x16x32_bf16 v[216:219], v[112:115], v[92:95], v[216:219]
v_add_u32 v2, 40960, v2
v_mfma_f32_16x16x32_bf16 v[232:235], v[112:115], v[96:99], v[232:235]
v_add_u32 v3, 40960, v3
v_mfma_f32_16x16x32_bf16 v[248:251], v[112:115], v[100:103], v[248:251]
v_add_u32 v4, 40960, v4
v_mfma_f32_16x16x32_bf16 v[252:255], v[116:119], v[100:103], v[252:255]
v_mfma_f32_16x16x32_bf16 v[236:239], v[116:119], v[96:99], v[236:239]
v_mfma_f32_16x16x32_bf16 v[220:223], v[116:119], v[92:95], v[220:223]
v_mfma_f32_16x16x32_bf16 v[204:207], v[116:119], v[88:91], v[204:207]
v_mfma_f32_16x16x32_bf16 v[188:191], v[116:119], v[84:87], v[188:191]
v_mfma_f32_16x16x32_bf16 v[172:175], v[116:119], v[80:83], v[172:175]
s_waitcnt lgkmcnt(0)
s_barrier
v_mfma_f32_16x16x32_bf16 v[160:163], v[144:147], v[120:123], v[160:163]
ds_read_b64_tr_b16 v[104:105], v3 offset:0
v_mfma_f32_16x16x32_bf16 v[176:179], v[144:147], v[124:127], v[176:179]
ds_read_b64_tr_b16 v[106:107], v3 offset:512
v_mfma_f32_16x16x32_bf16 v[192:195], v[144:147], v[128:131], v[192:195]
ds_read_b128 v[80:83], v1 offset:0
v_mfma_f32_16x16x32_bf16 v[208:211], v[144:147], v[132:135], v[208:211]
ds_read_b128 v[84:87], v1 offset:2048
v_mfma_f32_16x16x32_bf16 v[224:227], v[144:147], v[136:139], v[224:227]
ds_read_b128 v[88:91], v1 offset:4096
v_mfma_f32_16x16x32_bf16 v[240:243], v[144:147], v[140:143], v[240:243]
ds_read_b128 v[92:95], v1 offset:6144
v_mfma_f32_16x16x32_bf16 v[244:247], v[148:151], v[140:143], v[244:247]
ds_read_b128 v[96:99], v1 offset:8192
v_mfma_f32_16x16x32_bf16 v[228:231], v[148:151], v[136:139], v[228:231]
ds_read_b128 v[100:103], v1 offset:10240
v_mfma_f32_16x16x32_bf16 v[212:215], v[148:151], v[132:135], v[212:215]
ds_read_b64_tr_b16 v[108:109], v3 offset:2048
v_mfma_f32_16x16x32_bf16 v[196:199], v[148:151], v[128:131], v[196:199]
ds_read_b64_tr_b16 v[110:111], v3 offset:2560
v_mfma_f32_16x16x32_bf16 v[180:183], v[148:151], v[124:127], v[180:183]
ds_read_b64_tr_b16 v[112:113], v4 offset:0
v_mfma_f32_16x16x32_bf16 v[164:167], v[148:151], v[120:123], v[164:167]
ds_read_b64_tr_b16 v[114:115], v4 offset:512
v_mfma_f32_16x16x32_bf16 v[168:171], v[152:155], v[120:123], v[168:171]
ds_read_b64_tr_b16 v[116:117], v4 offset:2048
v_mfma_f32_16x16x32_bf16 v[184:187], v[152:155], v[124:127], v[184:187]
ds_read_b64_tr_b16 v[118:119], v4 offset:2560
v_mfma_f32_16x16x32_bf16 v[200:203], v[152:155], v[128:131], v[200:203]
v_mfma_f32_16x16x32_bf16 v[216:219], v[152:155], v[132:135], v[216:219]
v_mfma_f32_16x16x32_bf16 v[232:235], v[152:155], v[136:139], v[232:235]
v_mfma_f32_16x16x32_bf16 v[248:251], v[152:155], v[140:143], v[248:251]
v_mfma_f32_16x16x32_bf16 v[252:255], v[156:159], v[140:143], v[252:255]
v_mfma_f32_16x16x32_bf16 v[236:239], v[156:159], v[136:139], v[236:239]
v_mfma_f32_16x16x32_bf16 v[220:223], v[156:159], v[132:135], v[220:223]
v_mfma_f32_16x16x32_bf16 v[204:207], v[156:159], v[128:131], v[204:207]
v_mfma_f32_16x16x32_bf16 v[188:191], v[156:159], v[124:127], v[188:191]
v_mfma_f32_16x16x32_bf16 v[172:175], v[156:159], v[120:123], v[172:175]
s_waitcnt lgkmcnt(0)
v_mfma_f32_16x16x32_bf16 v[160:163], v[104:107], v[80:83], v[160:163]
ds_read_b64_tr_b16 v[144:145], v3 offset:8192
v_mfma_f32_16x16x32_bf16 v[176:179], v[104:107], v[84:87], v[176:179]
ds_read_b64_tr_b16 v[146:147], v3 offset:8704
v_mfma_f32_16x16x32_bf16 v[192:195], v[104:107], v[88:91], v[192:195]
ds_read_b128 v[120:123], v2 offset:0
v_mfma_f32_16x16x32_bf16 v[208:211], v[104:107], v[92:95], v[208:211]
ds_read_b128 v[124:127], v2 offset:2048
v_mfma_f32_16x16x32_bf16 v[224:227], v[104:107], v[96:99], v[224:227]
ds_read_b128 v[128:131], v2 offset:4096
v_mfma_f32_16x16x32_bf16 v[240:243], v[104:107], v[100:103], v[240:243]
ds_read_b128 v[132:135], v2 offset:6144
v_mfma_f32_16x16x32_bf16 v[244:247], v[108:111], v[100:103], v[244:247]
ds_read_b128 v[136:139], v2 offset:8192
v_mfma_f32_16x16x32_bf16 v[228:231], v[108:111], v[96:99], v[228:231]
ds_read_b128 v[140:143], v2 offset:10240
v_mfma_f32_16x16x32_bf16 v[212:215], v[108:111], v[92:95], v[212:215]
ds_read_b64_tr_b16 v[148:149], v3 offset:10240
v_mfma_f32_16x16x32_bf16 v[196:199], v[108:111], v[88:91], v[196:199]
ds_read_b64_tr_b16 v[150:151], v3 offset:10752
v_mfma_f32_16x16x32_bf16 v[180:183], v[108:111], v[84:87], v[180:183]
ds_read_b64_tr_b16 v[152:153], v4 offset:8192
v_mfma_f32_16x16x32_bf16 v[164:167], v[108:111], v[80:83], v[164:167]
ds_read_b64_tr_b16 v[154:155], v4 offset:8704
v_mfma_f32_16x16x32_bf16 v[168:171], v[112:115], v[80:83], v[168:171]
ds_read_b64_tr_b16 v[156:157], v4 offset:10240
v_mfma_f32_16x16x32_bf16 v[184:187], v[112:115], v[84:87], v[184:187]
ds_read_b64_tr_b16 v[158:159], v4 offset:10752
v_mfma_f32_16x16x32_bf16 v[200:203], v[112:115], v[88:91], v[200:203]
v_add_u32 v1, 40960, v1
v_mfma_f32_16x16x32_bf16 v[216:219], v[112:115], v[92:95], v[216:219]
v_add_u32 v2, 40960, v2
v_mfma_f32_16x16x32_bf16 v[232:235], v[112:115], v[96:99], v[232:235]
v_add_u32 v3, 40960, v3
v_mfma_f32_16x16x32_bf16 v[248:251], v[112:115], v[100:103], v[248:251]
v_add_u32 v4, 40960, v4
v_mfma_f32_16x16x32_bf16 v[252:255], v[116:119], v[100:103], v[252:255]
v_mfma_f32_16x16x32_bf16 v[236:239], v[116:119], v[96:99], v[236:239]
v_mfma_f32_16x16x32_bf16 v[220:223], v[116:119], v[92:95], v[220:223]
v_mfma_f32_16x16x32_bf16 v[204:207], v[116:119], v[88:91], v[204:207]
v_mfma_f32_16x16x32_bf16 v[188:191], v[116:119], v[84:87], v[188:191]
v_mfma_f32_16x16x32_bf16 v[172:175], v[116:119], v[80:83], v[172:175]
s_waitcnt lgkmcnt(0)
s_barrier
v_mfma_f32_16x16x32_bf16 v[160:163], v[144:147], v[120:123], v[160:163]
ds_read_b64_tr_b16 v[104:105], v3 offset:0
ds_read_b64_tr_b16 v[106:107], v3 offset:512
v_mfma_f32_16x16x32_bf16 v[176:179], v[144:147], v[124:127], v[176:179]
ds_read_b128 v[80:83], v1 offset:0
ds_read_b128 v[84:87], v1 offset:2048
v_mfma_f32_16x16x32_bf16 v[192:195], v[144:147], v[128:131], v[192:195]
ds_read_b128 v[88:91], v1 offset:4096
ds_read_b128 v[92:95], v1 offset:6144
v_mfma_f32_16x16x32_bf16 v[208:211], v[144:147], v[132:135], v[208:211]
ds_read_b128 v[96:99], v1 offset:8192
ds_read_b128 v[100:103], v1 offset:10240
v_mfma_f32_16x16x32_bf16 v[224:227], v[144:147], v[136:139], v[224:227]
ds_read_b64_tr_b16 v[108:109], v3 offset:2048
ds_read_b64_tr_b16 v[110:111], v3 offset:2560
v_mfma_f32_16x16x32_bf16 v[240:243], v[144:147], v[140:143], v[240:243]
ds_read_b64_tr_b16 v[112:113], v4 offset:0
ds_read_b64_tr_b16 v[114:115], v4 offset:512
v_mfma_f32_16x16x32_bf16 v[244:247], v[148:151], v[140:143], v[244:247]
ds_read_b64_tr_b16 v[116:117], v4 offset:2048
ds_read_b64_tr_b16 v[118:119], v4 offset:2560
v_mfma_f32_16x16x32_bf16 v[228:231], v[148:151], v[136:139], v[228:231]
v_and_b32 v56, 15, v0
s_mul_i32 s63, s86, 768
v_mfma_f32_16x16x32_bf16 v[212:215], v[148:151], v[132:135], v[212:215]
s_add_u32 s63, s63, 159232
v_lshl_add_u32 v57, v56, 3, s63
v_mfma_f32_16x16x32_bf16 v[196:199], v[148:151], v[128:131], v[196:199]
s_lshl_b32 s63, s87, 9
s_add_u32 s63, s63, 160768
v_mfma_f32_16x16x32_bf16 v[180:183], v[148:151], v[124:127], v[180:183]
v_lshl_add_u32 v59, v56, 3, s63
s_lshl_b32 s63, s87, 8
v_mfma_f32_16x16x32_bf16 v[164:167], v[148:151], v[120:123], v[164:167]
s_add_u32 s63, s63, 161280
v_lshl_add_u32 v60, v56, 3, s63
v_mfma_f32_16x16x32_bf16 v[168:171], v[152:155], v[120:123], v[168:171]
v_mov_b32 v58, 162320
s_mul_i32 s91, s54, 3
v_mfma_f32_16x16x32_bf16 v[184:187], v[152:155], v[124:127], v[184:187]
s_lshr_b32 s91, s91, 1
s_mul_i32 s63, s53, 12
v_mfma_f32_16x16x32_bf16 v[200:203], v[152:155], v[128:131], v[200:203]
s_mul_i32 s64, s60, 49
s_add_u32 s64, s64, s63
v_mfma_f32_16x16x32_bf16 v[216:219], v[152:155], v[132:135], v[216:219]
s_mul_i32 s92, s64, 5120
s_add_u32 s92, s92, 6553600
v_mfma_f32_16x16x32_bf16 v[232:235], v[152:155], v[136:139], v[232:235]
v_mfma_f32_16x16x32_bf16 v[248:251], v[152:155], v[140:143], v[248:251]
v_mfma_f32_16x16x32_bf16 v[252:255], v[156:159], v[140:143], v[252:255]
v_mfma_f32_16x16x32_bf16 v[236:239], v[156:159], v[136:139], v[236:239]
v_mfma_f32_16x16x32_bf16 v[220:223], v[156:159], v[132:135], v[220:223]
v_mfma_f32_16x16x32_bf16 v[204:207], v[156:159], v[128:131], v[204:207]
v_mfma_f32_16x16x32_bf16 v[188:191], v[156:159], v[124:127], v[188:191]
v_mfma_f32_16x16x32_bf16 v[172:175], v[156:159], v[120:123], v[172:175]
s_waitcnt lgkmcnt(0)
v_mfma_f32_16x16x32_bf16 v[160:163], v[104:107], v[80:83], v[160:163]
ds_read_b64_tr_b16 v[144:145], v3 offset:8192
ds_read_b64_tr_b16 v[146:147], v3 offset:8704
v_mfma_f32_16x16x32_bf16 v[176:179], v[104:107], v[84:87], v[176:179]
ds_read_b128 v[120:123], v2 offset:0
ds_read_b128 v[124:127], v2 offset:2048
v_mfma_f32_16x16x32_bf16 v[192:195], v[104:107], v[88:91], v[192:195]
ds_read_b128 v[128:131], v2 offset:4096
ds_read_b128 v[132:135], v2 offset:6144
v_mfma_f32_16x16x32_bf16 v[208:211], v[104:107], v[92:95], v[208:211]
ds_read_b128 v[136:139], v2 offset:8192
ds_read_b128 v[140:143], v2 offset:10240
v_mfma_f32_16x16x32_bf16 v[224:227], v[104:107], v[96:99], v[224:227]
ds_read_b64_tr_b16 v[148:149], v3 offset:10240
ds_read_b64_tr_b16 v[150:151], v3 offset:10752
v_mfma_f32_16x16x32_bf16 v[240:243], v[104:107], v[100:103], v[240:243]
ds_read_b64_tr_b16 v[152:153], v4 offset:8192
ds_read_b64_tr_b16 v[154:155], v4 offset:8704
v_mfma_f32_16x16x32_bf16 v[244:247], v[108:111], v[100:103], v[244:247]
ds_read_b64_tr_b16 v[156:157], v4 offset:10240
ds_read_b64_tr_b16 v[158:159], v4 offset:10752
v_mfma_f32_16x16x32_bf16 v[228:231], v[108:111], v[96:99], v[228:231]
v_subrev_u32 v1, 81920, v1
v_subrev_u32 v2, 81920, v2
v_mfma_f32_16x16x32_bf16 v[212:215], v[108:111], v[92:95], v[212:215]
v_subrev_u32 v3, 81920, v3
v_subrev_u32 v4, 81920, v4
v_mfma_f32_16x16x32_bf16 v[196:199], v[108:111], v[88:91], v[196:199]
s_mul_i32 s63, s53, 12
s_mul_i32 s64, s59, 49
v_mfma_f32_16x16x32_bf16 v[180:183], v[108:111], v[84:87], v[180:183]
s_add_u32 s64, s64, s63
s_lshl_b32 s93, s64, 12
v_mfma_f32_16x16x32_bf16 v[164:167], v[108:111], v[80:83], v[164:167]
s_add_u32 s93, s93, 8585216
s_add_u32 s63, s56, s86
v_mfma_f32_16x16x32_bf16 v[168:171], v[112:115], v[80:83], v[168:171]
s_mul_i32 s64, s57, 43
s_lshr_b32 s64, s64, 10
v_mfma_f32_16x16x32_bf16 v[184:187], v[112:115], v[84:87], v[184:187]
s_lshl2_add_u32 s63, s63, s64
s_add_u32 s96, s63, 0
v_mfma_f32_16x16x32_bf16 v[200:203], v[112:115], v[88:91], v[200:203]
s_lshl_b32 s96, s96, 7
s_add_u32 s98, s96, 512
v_mfma_f32_16x16x32_bf16 v[216:219], v[112:115], v[92:95], v[216:219]
s_lshl2_add_u32 s63, s59, s53
s_add_u32 s63, s63, 0
v_mfma_f32_16x16x32_bf16 v[232:235], v[112:115], v[96:99], v[232:235]
s_lshl_b32 s99, s63, 7
s_mul_i32 s63, s59, 43
v_mfma_f32_16x16x32_bf16 v[248:251], v[112:115], v[100:103], v[248:251]
s_lshr_b32 s63, s63, 7
s_mul_i32 s63, s63, 3
v_mfma_f32_16x16x32_bf16 v[252:255], v[116:119], v[100:103], v[252:255]
s_sub_u32 s63, s59, s63
s_cmp_eq_u32 s63, 1
s_cselect_b32 s100, 24, 12
s_cmp_ge_u32 s59, 30
s_cselect_b32 s100, 8, s100
v_mfma_f32_16x16x32_bf16 v[236:239], v[116:119], v[96:99], v[236:239]
v_mfma_f32_16x16x32_bf16 v[220:223], v[116:119], v[92:95], v[220:223]
v_mfma_f32_16x16x32_bf16 v[204:207], v[116:119], v[88:91], v[204:207]
v_mfma_f32_16x16x32_bf16 v[188:191], v[116:119], v[84:87], v[188:191]
v_mfma_f32_16x16x32_bf16 v[172:175], v[116:119], v[80:83], v[172:175]
s_waitcnt lgkmcnt(0)
s_barrier
v_mfma_f32_16x16x32_bf16 v[160:163], v[144:147], v[120:123], v[160:163]
ds_read_b64_tr_b16 v[104:105], v3 offset:0
v_mfma_f32_16x16x32_bf16 v[176:179], v[144:147], v[124:127], v[176:179]
ds_read_b64_tr_b16 v[106:107], v3 offset:512
v_mfma_f32_16x16x32_bf16 v[192:195], v[144:147], v[128:131], v[192:195]
ds_read_b128 v[80:83], v1 offset:0
v_mfma_f32_16x16x32_bf16 v[208:211], v[144:147], v[132:135], v[208:211]
ds_read_b128 v[84:87], v1 offset:2048
v_mfma_f32_16x16x32_bf16 v[224:227], v[144:147], v[136:139], v[224:227]
ds_read_b128 v[88:91], v1 offset:4096
v_mfma_f32_16x16x32_bf16 v[240:243], v[144:147], v[140:143], v[240:243]
ds_read_b128 v[92:95], v1 offset:6144
v_mfma_f32_16x16x32_bf16 v[244:247], v[148:151], v[140:143], v[244:247]
ds_read_b128 v[96:99], v1 offset:8192
v_mfma_f32_16x16x32_bf16 v[228:231], v[148:151], v[136:139], v[228:231]
ds_read_b128 v[100:103], v1 offset:10240
v_mfma_f32_16x16x32_bf16 v[212:215], v[148:151], v[132:135], v[212:215]
ds_read_b64_tr_b16 v[108:109], v3 offset:2048
v_mfma_f32_16x16x32_bf16 v[196:199], v[148:151], v[128:131], v[196:199]
ds_read_b64_tr_b16 v[110:111], v3 offset:2560
v_mfma_f32_16x16x32_bf16 v[180:183], v[148:151], v[124:127], v[180:183]
ds_read_b64_tr_b16 v[112:113], v4 offset:0
v_mfma_f32_16x16x32_bf16 v[164:167], v[148:151], v[120:123], v[164:167]
ds_read_b64_tr_b16 v[114:115], v4 offset:512
v_mfma_f32_16x16x32_bf16 v[168:171], v[152:155], v[120:123], v[168:171]
ds_read_b64_tr_b16 v[116:117], v4 offset:2048
v_mfma_f32_16x16x32_bf16 v[184:187], v[152:155], v[124:127], v[184:187]
ds_read_b64_tr_b16 v[118:119], v4 offset:2560
v_mfma_f32_16x16x32_bf16 v[200:203], v[152:155], v[128:131], v[200:203]
v_mfma_f32_16x16x32_bf16 v[216:219], v[152:155], v[132:135], v[216:219]
v_mfma_f32_16x16x32_bf16 v[232:235], v[152:155], v[136:139], v[232:235]
v_mfma_f32_16x16x32_bf16 v[248:251], v[152:155], v[140:143], v[248:251]
v_mfma_f32_16x16x32_bf16 v[252:255], v[156:159], v[140:143], v[252:255]
v_mfma_f32_16x16x32_bf16 v[236:239], v[156:159], v[136:139], v[236:239]
v_mfma_f32_16x16x32_bf16 v[220:223], v[156:159], v[132:135], v[220:223]
v_mfma_f32_16x16x32_bf16 v[204:207], v[156:159], v[128:131], v[204:207]
v_mfma_f32_16x16x32_bf16 v[188:191], v[156:159], v[124:127], v[188:191]
v_mfma_f32_16x16x32_bf16 v[172:175], v[156:159], v[120:123], v[172:175]
s_waitcnt lgkmcnt(0)
s_setprio 2
v_mfma_f32_16x16x32_bf16 v[160:163], v[104:107], v[80:83], v[160:163]
ds_read_b64_tr_b16 v[144:145], v3 offset:8192
ds_read_b64_tr_b16 v[146:147], v3 offset:8704
v_mfma_f32_16x16x32_bf16 v[176:179], v[104:107], v[84:87], v[176:179]
ds_read_b128 v[120:123], v2 offset:0
ds_read_b128 v[124:127], v2 offset:2048
v_mfma_f32_16x16x32_bf16 v[192:195], v[104:107], v[88:91], v[192:195]
ds_read_b128 v[128:131], v2 offset:4096
ds_read_b128 v[132:135], v2 offset:6144
v_mfma_f32_16x16x32_bf16 v[208:211], v[104:107], v[92:95], v[208:211]
ds_read_b128 v[136:139], v2 offset:8192
ds_read_b128 v[140:143], v2 offset:10240
v_mfma_f32_16x16x32_bf16 v[224:227], v[104:107], v[96:99], v[224:227]
ds_read_b64_tr_b16 v[148:149], v3 offset:10240
ds_read_b64_tr_b16 v[150:151], v3 offset:10752
v_mfma_f32_16x16x32_bf16 v[240:243], v[104:107], v[100:103], v[240:243]
ds_read_b64_tr_b16 v[152:153], v4 offset:8192
ds_read_b64_tr_b16 v[154:155], v4 offset:8704
v_mfma_f32_16x16x32_bf16 v[244:247], v[108:111], v[100:103], v[244:247]
ds_read_b64_tr_b16 v[156:157], v4 offset:10240
ds_read_b64_tr_b16 v[158:159], v4 offset:10752
v_mfma_f32_16x16x32_bf16 v[228:231], v[108:111], v[96:99], v[228:231]
ds_read_b32 v8, v58
v_mfma_f32_16x16x32_bf16 v[212:215], v[108:111], v[92:95], v[212:215]
v_mfma_f32_16x16x32_bf16 v[196:199], v[108:111], v[88:91], v[196:199]
s_waitcnt lgkmcnt(0)
v_readfirstlane_b32 s63, v8
s_nop 0
s_cmp_eq_u32 s63, 4
s_cbranch_scc1 L_ggo_40
s_mov_b32 s67, 0
L_lf_41:
ds_read_b32 v8, v58
s_add_u32 s67, s67, 1
s_waitcnt lgkmcnt(0)
v_readfirstlane_b32 s63, v8
s_nop 0
s_cmp_eq_u32 s63, 4
s_cbranch_scc1 L_ggo_40
s_sleep 1
s_cmp_lt_u32 s67, 2097152
s_cbranch_scc1 L_lf_41
L_ggo_40:
v_mfma_f32_16x16x32_bf16 v[180:183], v[108:111], v[84:87], v[180:183]
ds_read_b64 v[12:13], v59 offset:0
ds_read_b64 v[14:15], v59 offset:128
v_mfma_f32_16x16x32_bf16 v[164:167], v[108:111], v[80:83], v[164:167]
ds_read_b64 v[16:17], v59 offset:256
ds_read_b64 v[18:19], v59 offset:384
v_mfma_f32_16x16x32_bf16 v[168:171], v[112:115], v[80:83], v[168:171]
ds_read_b64 v[20:21], v57 offset:0
ds_read_b64 v[22:23], v57 offset:128
v_mfma_f32_16x16x32_bf16 v[184:187], v[112:115], v[84:87], v[184:187]
ds_read_b64 v[24:25], v57 offset:256
ds_read_b64 v[26:27], v57 offset:384
v_mfma_f32_16x16x32_bf16 v[200:203], v[112:115], v[88:91], v[200:203]
ds_read_b64 v[28:29], v57 offset:512
ds_read_b64 v[30:31], v57 offset:640
v_mfma_f32_16x16x32_bf16 v[216:219], v[112:115], v[92:95], v[216:219]
v_mfma_f32_16x16x32_bf16 v[232:235], v[112:115], v[96:99], v[232:235]
s_waitcnt lgkmcnt(0)
s_mov_b32 exec_lo, 0xffff0000
v_mov_b32 v12, 0
v_mov_b32 v13, 0
s_mov_b32 exec_lo, -1
v_mfma_f32_16x16x32_bf16 v[248:251], v[112:115], v[100:103], v[248:251]
s_mov_b32 exec_lo, 0xffff0000
v_mov_b32 v14, 0
v_mov_b32 v15, 0
s_mov_b32 exec_lo, -1
s_mov_b32 exec_lo, 0xffff0000
v_mov_b32 v16, 0
v_mov_b32 v17, 0
s_mov_b32 exec_lo, -1
v_mfma_f32_16x16x32_bf16 v[252:255], v[116:119], v[100:103], v[252:255]
s_mov_b32 exec_lo, 0xffff0000
v_mov_b32 v18, 0
v_mov_b32 v19, 0
s_mov_b32 exec_lo, -1
v_cvt_pk_bf16_f32 v32, -v20, -v20
v_mfma_f32_16x16x32_bf16 v[236:239], v[116:119], v[96:99], v[236:239]
v_cvt_pk_bf16_f32 v33, -v20, -v20
v_cvt_pk_bf16_f32 v34, -v22, -v22
v_mfma_f32_16x16x32_bf16 v[220:223], v[116:119], v[92:95], v[220:223]
v_cvt_pk_bf16_f32 v35, -v22, -v22
v_cvt_pk_bf16_f32 v36, -v24, -v24
v_mfma_f32_16x16x32_bf16 v[204:207], v[116:119], v[88:91], v[204:207]
v_cvt_pk_bf16_f32 v37, -v24, -v24
v_cvt_pk_bf16_f32 v38, -v26, -v26
v_mfma_f32_16x16x32_bf16 v[188:191], v[116:119], v[84:87], v[188:191]
v_cvt_pk_bf16_f32 v39, -v26, -v26
v_cvt_pk_bf16_f32 v40, -v28, -v28
v_mfma_f32_16x16x32_bf16 v[172:175], v[116:119], v[80:83], v[172:175]
v_cvt_pk_bf16_f32 v41, -v28, -v28
v_cvt_pk_bf16_f32 v42, -v30, -v30
v_cvt_pk_bf16_f32 v43, -v30, -v30
v_mov_b32 v56, 162312
v_mov_b32 v57, 1
s_waitcnt lgkmcnt(0)
s_mov_b64 exec, 1
ds_add_u32 v56, v57
s_mov_b64 exec, -1
v_mfma_f32_16x16x32_bf16 v[160:163], v[144:147], v[120:123], v[160:163]
v_rcp_f32 v44, v21
v_mul_f32 v50, v21, v21
v_mfma_f32_16x16x32_bf16 v[164:167], v[148:151], v[120:123], v[164:167]
v_mul_f32 v44, 0xbfb8aa3b, v44
v_rcp_f32 v45, v23
v_mfma_f32_16x16x32_bf16 v[168:171], v[152:155], v[120:123], v[168:171]
v_mul_f32 v51, v23, v23
v_mul_f32 v45, 0xbfb8aa3b, v45
v_mfma_f32_16x16x32_bf16 v[172:175], v[156:159], v[120:123], v[172:175]
v_rcp_f32 v46, v25
v_mul_f32 v52, v25, v25
v_mfma_f32_16x16x16_bf16 v[160:163], v[12:13], v[32:33], v[160:163]
v_mul_f32 v46, 0xbfb8aa3b, v46
v_rcp_f32 v47, v27
v_mfma_f32_16x16x16_bf16 v[164:167], v[14:15], v[32:33], v[164:167]
v_mul_f32 v53, v27, v27
v_mul_f32 v47, 0xbfb8aa3b, v47
v_mfma_f32_16x16x16_bf16 v[168:171], v[16:17], v[32:33], v[168:171]
v_rcp_f32 v48, v29
v_mul_f32 v54, v29, v29
v_mfma_f32_16x16x16_bf16 v[172:175], v[18:19], v[32:33], v[172:175]
v_mul_f32 v48, 0xbfb8aa3b, v48
v_rcp_f32 v49, v31
v_mfma_f32_16x16x32_bf16 v[176:179], v[144:147], v[124:127], v[176:179]
v_mul_f32 v55, v31, v31
v_mul_f32 v49, 0xbfb8aa3b, v49
v_mfma_f32_16x16x32_bf16 v[180:183], v[148:151], v[124:127], v[180:183]
v_mfma_f32_16x16x32_bf16 v[184:187], v[152:155], v[124:127], v[184:187]
v_mfma_f32_16x16x32_bf16 v[188:191], v[156:159], v[124:127], v[188:191]
v_mfma_f32_16x16x16_bf16 v[176:179], v[12:13], v[34:35], v[176:179]
v_mul_f32 v108, v160, v44
v_mul_f32 v109, v161, v44
v_mfma_f32_16x16x16_bf16 v[180:183], v[14:15], v[34:35], v[180:183]
v_mul_f32 v110, v162, v44
v_mul_f32 v111, v163, v44
v_mfma_f32_16x16x16_bf16 v[184:187], v[16:17], v[34:35], v[184:187]
v_mul_f32 v112, v168, v44
v_mul_f32 v113, v169, v44
v_mfma_f32_16x16x16_bf16 v[188:191], v[18:19], v[34:35], v[188:191]
v_mul_f32 v114, v170, v44
v_mul_f32 v115, v171, v44
v_mfma_f32_16x16x32_bf16 v[192:195], v[144:147], v[128:131], v[192:195]
v_exp_f32 v108, v108
v_mul_f32 v160, v160, v164
v_mfma_f32_16x16x32_bf16 v[196:199], v[148:151], v[128:131], v[196:199]
v_exp_f32 v109, v109
v_mul_f32 v161, v161, v165
v_mfma_f32_16x16x32_bf16 v[200:203], v[152:155], v[128:131], v[200:203]
v_exp_f32 v110, v110
v_mul_f32 v162, v162, v166
v_mfma_f32_16x16x32_bf16 v[204:207], v[156:159], v[128:131], v[204:207]
v_exp_f32 v111, v111
v_mul_f32 v163, v163, v167
v_mfma_f32_16x16x16_bf16 v[192:195], v[12:13], v[36:37], v[192:195]
v_exp_f32 v112, v112
v_mul_f32 v168, v168, v172
v_mfma_f32_16x16x16_bf16 v[196:199], v[14:15], v[36:37], v[196:199]
v_exp_f32 v113, v113
v_mul_f32 v169, v169, v173
v_mfma_f32_16x16x16_bf16 v[200:203], v[16:17], v[36:37], v[200:203]
v_exp_f32 v114, v114
v_mul_f32 v170, v170, v174
v_mfma_f32_16x16x16_bf16 v[204:207], v[18:19], v[36:37], v[204:207]
v_exp_f32 v115, v115
v_mul_f32 v171, v171, v175
v_mfma_f32_16x16x32_bf16 v[208:211], v[144:147], v[132:135], v[208:211]
v_fma_f32 v108, v108, v50, v50
v_fma_f32 v109, v109, v50, v50
v_mfma_f32_16x16x32_bf16 v[212:215], v[148:151], v[132:135], v[212:215]
v_fma_f32 v110, v110, v50, v50
v_fma_f32 v111, v111, v50, v50
v_mfma_f32_16x16x32_bf16 v[216:219], v[152:155], v[132:135], v[216:219]
v_fma_f32 v112, v112, v50, v50
v_fma_f32 v113, v113, v50, v50
v_mfma_f32_16x16x32_bf16 v[220:223], v[156:159], v[132:135], v[220:223]
v_fma_f32 v114, v114, v50, v50
v_fma_f32 v115, v115, v50, v50
v_mfma_f32_16x16x16_bf16 v[208:211], v[12:13], v[38:39], v[208:211]
v_rcp_f32 v108, v108
v_rcp_f32 v109, v109
v_mfma_f32_16x16x16_bf16 v[212:215], v[14:15], v[38:39], v[212:215]
v_rcp_f32 v110, v110
v_rcp_f32 v111, v111
v_mfma_f32_16x16x16_bf16 v[216:219], v[16:17], v[38:39], v[216:219]
v_rcp_f32 v112, v112
v_rcp_f32 v113, v113
v_mfma_f32_16x16x16_bf16 v[220:223], v[18:19], v[38:39], v[220:223]
v_rcp_f32 v114, v114
v_rcp_f32 v115, v115
v_mfma_f32_16x16x32_bf16 v[224:227], v[144:147], v[136:139], v[224:227]
v_mul_f32 v160, v160, v108
v_mul_f32 v161, v161, v109
v_mfma_f32_16x16x32_bf16 v[228:231], v[148:151], v[136:139], v[228:231]
v_mul_f32 v162, v162, v110
v_mul_f32 v163, v163, v111
v_mfma_f32_16x16x32_bf16 v[232:235], v[152:155], v[136:139], v[232:235]
v_mul_f32 v168, v168, v112
v_mul_f32 v169, v169, v113
v_mfma_f32_16x16x32_bf16 v[236:239], v[156:159], v[136:139], v[236:239]
v_mul_f32 v170, v170, v114
v_mul_f32 v171, v171, v115
v_mfma_f32_16x16x16_bf16 v[224:227], v[12:13], v[40:41], v[224:227]
v_cvt_pk_bf16_f32 v84, v160, v161
v_cvt_pk_bf16_f32 v86, v168, v169
v_mfma_f32_16x16x16_bf16 v[228:231], v[14:15], v[40:41], v[228:231]
v_cvt_pk_bf16_f32 v85, v162, v163
v_cvt_pk_bf16_f32 v87, v170, v171
v_mfma_f32_16x16x16_bf16 v[232:235], v[16:17], v[40:41], v[232:235]
v_permlane16_swap_b32 v84, v86
v_permlane16_swap_b32 v85, v87
v_mfma_f32_16x16x16_bf16 v[236:239], v[18:19], v[40:41], v[236:239]
buffer_store_dwordx4 v[84:87], v6, s[16:19], s88 offen offset:0 sc1
v_mul_f32 v108, v176, v45
v_mfma_f32_16x16x32_bf16 v[240:243], v[144:147], v[140:143], v[240:243]
v_mul_f32 v109, v177, v45
v_mul_f32 v110, v178, v45
v_mfma_f32_16x16x32_bf16 v[244:247], v[148:151], v[140:143], v[244:247]
v_mul_f32 v111, v179, v45
v_mul_f32 v112, v184, v45
v_mfma_f32_16x16x32_bf16 v[248:251], v[152:155], v[140:143], v[248:251]
v_mul_f32 v113, v185, v45
v_mul_f32 v114, v186, v45
v_mfma_f32_16x16x32_bf16 v[252:255], v[156:159], v[140:143], v[252:255]
v_mul_f32 v115, v187, v45
v_exp_f32 v108, v108
v_mfma_f32_16x16x16_bf16 v[240:243], v[12:13], v[42:43], v[240:243]
v_mul_f32 v176, v176, v180
v_exp_f32 v109, v109
v_mfma_f32_16x16x16_bf16 v[244:247], v[14:15], v[42:43], v[244:247]
v_mul_f32 v177, v177, v181
v_exp_f32 v110, v110
v_mfma_f32_16x16x16_bf16 v[248:251], v[16:17], v[42:43], v[248:251]
v_mul_f32 v178, v178, v182
v_exp_f32 v111, v111
v_mfma_f32_16x16x16_bf16 v[252:255], v[18:19], v[42:43], v[252:255]
v_mul_f32 v179, v179, v183
v_exp_f32 v112, v112
v_mul_f32 v184, v184, v188
v_exp_f32 v113, v113
v_mul_f32 v185, v185, v189
v_exp_f32 v114, v114
v_mul_f32 v186, v186, v190
v_exp_f32 v115, v115
v_mul_f32 v187, v187, v191
v_fma_f32 v108, v108, v51, v51
v_fma_f32 v109, v109, v51, v51
v_fma_f32 v110, v110, v51, v51
v_fma_f32 v111, v111, v51, v51
v_fma_f32 v112, v112, v51, v51
v_fma_f32 v113, v113, v51, v51
v_fma_f32 v114, v114, v51, v51
v_fma_f32 v115, v115, v51, v51
v_rcp_f32 v108, v108
v_rcp_f32 v109, v109
v_rcp_f32 v110, v110
v_rcp_f32 v111, v111
v_rcp_f32 v112, v112
v_rcp_f32 v113, v113
v_rcp_f32 v114, v114
v_rcp_f32 v115, v115
v_mul_f32 v176, v176, v108
v_mul_f32 v177, v177, v109
v_mul_f32 v178, v178, v110
v_mul_f32 v179, v179, v111
v_mul_f32 v184, v184, v112
v_mul_f32 v185, v185, v113
v_mul_f32 v186, v186, v114
v_mul_f32 v187, v187, v115
v_cvt_pk_bf16_f32 v88, v176, v177
v_cvt_pk_bf16_f32 v90, v184, v185
v_cvt_pk_bf16_f32 v89, v178, v179
v_cvt_pk_bf16_f32 v91, v186, v187
v_permlane16_swap_b32 v88, v90
s_nop 0
v_permlane16_swap_b32 v89, v91
buffer_store_dwordx4 v[88:91], v6, s[16:19], s88 offen offset:1024 sc1
v_mul_f32 v108, v192, v46
v_mul_f32 v109, v193, v46
v_mul_f32 v110, v194, v46
v_mul_f32 v111, v195, v46
v_mul_f32 v112, v200, v46
v_mul_f32 v113, v201, v46
v_mul_f32 v114, v202, v46
v_mul_f32 v115, v203, v46
v_exp_f32 v108, v108
v_mul_f32 v192, v192, v196
v_exp_f32 v109, v109
v_mul_f32 v193, v193, v197
v_exp_f32 v110, v110
v_mul_f32 v194, v194, v198
v_exp_f32 v111, v111
v_mul_f32 v195, v195, v199
v_exp_f32 v112, v112
v_mul_f32 v200, v200, v204
v_exp_f32 v113, v113
v_mul_f32 v201, v201, v205
v_exp_f32 v114, v114
v_mul_f32 v202, v202, v206
v_exp_f32 v115, v115
v_mul_f32 v203, v203, v207
v_fma_f32 v108, v108, v52, v52
v_fma_f32 v109, v109, v52, v52
v_fma_f32 v110, v110, v52, v52
v_fma_f32 v111, v111, v52, v52
v_fma_f32 v112, v112, v52, v52
v_fma_f32 v113, v113, v52, v52
v_fma_f32 v114, v114, v52, v52
v_fma_f32 v115, v115, v52, v52
v_rcp_f32 v108, v108
v_rcp_f32 v109, v109
v_rcp_f32 v110, v110
v_rcp_f32 v111, v111
v_rcp_f32 v112, v112
v_rcp_f32 v113, v113
v_rcp_f32 v114, v114
v_rcp_f32 v115, v115
v_mul_f32 v192, v192, v108
v_mul_f32 v193, v193, v109
v_mul_f32 v194, v194, v110
v_mul_f32 v195, v195, v111
v_mul_f32 v200, v200, v112
v_mul_f32 v201, v201, v113
v_mul_f32 v202, v202, v114
v_mul_f32 v203, v203, v115
v_cvt_pk_bf16_f32 v92, v192, v193
v_cvt_pk_bf16_f32 v94, v200, v201
v_cvt_pk_bf16_f32 v93, v194, v195
v_cvt_pk_bf16_f32 v95, v202, v203
v_permlane16_swap_b32 v92, v94
s_nop 0
v_permlane16_swap_b32 v93, v95
buffer_store_dwordx4 v[92:95], v6, s[16:19], s89 offen offset:0 sc1
v_mul_f32 v108, v208, v47
v_mul_f32 v109, v209, v47
v_mul_f32 v110, v210, v47
v_mul_f32 v111, v211, v47
v_mul_f32 v112, v216, v47
v_mul_f32 v113, v217, v47
v_mul_f32 v114, v218, v47
v_mul_f32 v115, v219, v47
v_exp_f32 v108, v108
v_mul_f32 v208, v208, v212
v_exp_f32 v109, v109
v_mul_f32 v209, v209, v213
v_exp_f32 v110, v110
v_mul_f32 v210, v210, v214
v_exp_f32 v111, v111
v_mul_f32 v211, v211, v215
v_exp_f32 v112, v112
v_mul_f32 v216, v216, v220
v_exp_f32 v113, v113
v_mul_f32 v217, v217, v221
v_exp_f32 v114, v114
v_mul_f32 v218, v218, v222
v_exp_f32 v115, v115
v_mul_f32 v219, v219, v223
v_fma_f32 v108, v108, v53, v53
v_fma_f32 v109, v109, v53, v53
v_fma_f32 v110, v110, v53, v53
v_fma_f32 v111, v111, v53, v53
v_fma_f32 v112, v112, v53, v53
v_fma_f32 v113, v113, v53, v53
v_fma_f32 v114, v114, v53, v53
v_fma_f32 v115, v115, v53, v53
v_rcp_f32 v108, v108
v_rcp_f32 v109, v109
v_rcp_f32 v110, v110
v_rcp_f32 v111, v111
v_rcp_f32 v112, v112
v_rcp_f32 v113, v113
v_rcp_f32 v114, v114
v_rcp_f32 v115, v115
v_mul_f32 v208, v208, v108
v_mul_f32 v209, v209, v109
v_mul_f32 v210, v210, v110
v_mul_f32 v211, v211, v111
v_mul_f32 v216, v216, v112
v_mul_f32 v217, v217, v113
v_mul_f32 v218, v218, v114
v_mul_f32 v219, v219, v115
v_cvt_pk_bf16_f32 v96, v208, v209
v_cvt_pk_bf16_f32 v98, v216, v217
v_cvt_pk_bf16_f32 v97, v210, v211
v_cvt_pk_bf16_f32 v99, v218, v219
v_permlane16_swap_b32 v96, v98
s_nop 0
v_permlane16_swap_b32 v97, v99
buffer_store_dwordx4 v[96:99], v6, s[16:19], s89 offen offset:1024 sc1
v_mul_f32 v108, v224, v48
v_mul_f32 v109, v225, v48
v_mul_f32 v110, v226, v48
v_mul_f32 v111, v227, v48
v_mul_f32 v112, v232, v48
v_mul_f32 v113, v233, v48
v_mul_f32 v114, v234, v48
v_mul_f32 v115, v235, v48
v_exp_f32 v108, v108
v_mul_f32 v224, v224, v228
v_exp_f32 v109, v109
v_mul_f32 v225, v225, v229
v_exp_f32 v110, v110
v_mul_f32 v226, v226, v230
v_exp_f32 v111, v111
v_mul_f32 v227, v227, v231
v_exp_f32 v112, v112
v_mul_f32 v232, v232, v236
v_exp_f32 v113, v113
v_mul_f32 v233, v233, v237
v_exp_f32 v114, v114
v_mul_f32 v234, v234, v238
v_exp_f32 v115, v115
v_mul_f32 v235, v235, v239
v_fma_f32 v108, v108, v54, v54
v_fma_f32 v109, v109, v54, v54
v_fma_f32 v110, v110, v54, v54
v_fma_f32 v111, v111, v54, v54
v_fma_f32 v112, v112, v54, v54
v_fma_f32 v113, v113, v54, v54
v_fma_f32 v114, v114, v54, v54
v_fma_f32 v115, v115, v54, v54
v_rcp_f32 v108, v108
v_rcp_f32 v109, v109
v_rcp_f32 v110, v110
v_rcp_f32 v111, v111
v_rcp_f32 v112, v112
v_rcp_f32 v113, v113
v_rcp_f32 v114, v114
v_rcp_f32 v115, v115
v_mul_f32 v224, v224, v108
v_mul_f32 v225, v225, v109
v_mul_f32 v226, v226, v110
v_mul_f32 v227, v227, v111
v_mul_f32 v232, v232, v112
v_mul_f32 v233, v233, v113
v_mul_f32 v234, v234, v114
v_mul_f32 v235, v235, v115
v_cvt_pk_bf16_f32 v100, v224, v225
v_cvt_pk_bf16_f32 v102, v232, v233
v_cvt_pk_bf16_f32 v101, v226, v227
v_cvt_pk_bf16_f32 v103, v234, v235
v_permlane16_swap_b32 v100, v102
s_nop 0
v_permlane16_swap_b32 v101, v103
buffer_store_dwordx4 v[100:103], v6, s[16:19], s90 offen offset:0 sc1
v_mul_f32 v108, v240, v49
v_mul_f32 v109, v241, v49
v_mul_f32 v110, v242, v49
v_mul_f32 v111, v243, v49
v_mul_f32 v112, v248, v49
v_mul_f32 v113, v249, v49
v_mul_f32 v114, v250, v49
v_mul_f32 v115, v251, v49
v_exp_f32 v108, v108
v_mul_f32 v240, v240, v244
v_exp_f32 v109, v109
v_mul_f32 v241, v241, v245
v_exp_f32 v110, v110
v_mul_f32 v242, v242, v246
v_exp_f32 v111, v111
v_mul_f32 v243, v243, v247
v_exp_f32 v112, v112
v_mul_f32 v248, v248, v252
v_exp_f32 v113, v113
v_mul_f32 v249, v249, v253
v_exp_f32 v114, v114
v_mul_f32 v250, v250, v254
v_exp_f32 v115, v115
v_mul_f32 v251, v251, v255
v_fma_f32 v108, v108, v55, v55
v_fma_f32 v109, v109, v55, v55
v_fma_f32 v110, v110, v55, v55
v_fma_f32 v111, v111, v55, v55
v_fma_f32 v112, v112, v55, v55
v_fma_f32 v113, v113, v55, v55
v_fma_f32 v114, v114, v55, v55
v_fma_f32 v115, v115, v55, v55
v_rcp_f32 v108, v108
v_rcp_f32 v109, v109
v_rcp_f32 v110, v110
v_rcp_f32 v111, v111
v_rcp_f32 v112, v112
v_rcp_f32 v113, v113
v_rcp_f32 v114, v114
v_rcp_f32 v115, v115
v_mul_f32 v240, v240, v108
v_mul_f32 v241, v241, v109
v_mul_f32 v242, v242, v110
v_mul_f32 v243, v243, v111
v_mul_f32 v248, v248, v112
v_mul_f32 v249, v249, v113
v_mul_f32 v250, v250, v114
v_mul_f32 v251, v251, v115
v_cvt_pk_bf16_f32 v104, v240, v241
v_cvt_pk_bf16_f32 v106, v248, v249
v_cvt_pk_bf16_f32 v105, v242, v243
v_cvt_pk_bf16_f32 v107, v250, v251
v_permlane16_swap_b32 v104, v106
s_nop 0
v_permlane16_swap_b32 v105, v107
buffer_store_dwordx4 v[104:107], v6, s[16:19], s90 offen offset:1024 sc1
L_down:
v_lshlrev_b32 v1, 4, v0
v_add_u32 v2, 1024, v1
s_mul_i32 s63, s53, 10240
v_add_u32 v3, s63, v1
v_add_u32 v4, 81920, v3
v_mov_b32 v5, 162316
s_add_u32 s94, s91, 5
s_sub_u32 s66, s94, 12
s_cmp_ge_u32 s94, 12
s_cselect_b32 s94, s66, s94
s_mul_i32 s94, s94, 5120
s_add_u32 s94, s94, s92
buffer_load_dwordx4 v[108:111], v1, s[16:19], s94 offen offset:0 sc1
buffer_load_dwordx4 v[112:115], v2, s[16:19], s94 offen offset:0 sc1
buffer_load_dwordx4 v[116:119], v2, s[16:19], s94 offen offset:1024 sc1
buffer_load_dwordx4 v[120:123], v2, s[16:19], s94 offen offset:2048 sc1
buffer_load_dwordx4 v[124:127], v2, s[16:19], s94 offen offset:3072 sc1
s_waitcnt vmcnt(5)
s_mov_b32 s97, 1
s_atomic_add s97, s[16:17], s96 offset:0
s_atomic_add s97, s[16:17], s98 offset:0
s_setprio 0
s_add_u32 s94, s91, 0
s_sub_u32 s66, s94, 12
s_cmp_ge_u32 s94, 12
s_cselect_b32 s94, s66, s94
s_mul_i32 s94, s94, 5120
s_add_u32 s94, s94, s92
buffer_load_dwordx4 v[8:11], v1, s[16:19], s94 offen offset:0 sc1
buffer_load_dwordx4 v[12:15], v2, s[16:19], s94 offen offset:0 sc1
buffer_load_dwordx4 v[16:19], v2, s[16:19], s94 offen offset:1024 sc1
buffer_load_dwordx4 v[20:23], v2, s[16:19], s94 offen offset:2048 sc1
buffer_load_dwordx4 v[24:27], v2, s[16:19], s94 offen offset:3072 sc1
s_add_u32 s94, s91, 1
s_sub_u32 s66, s94, 12
s_cmp_ge_u32 s94, 12
s_cselect_b32 s94, s66, s94
s_mul_i32 s94, s94, 5120
s_add_u32 s94, s94, s92
buffer_load_dwordx4 v[28:31], v1, s[16:19], s94 offen offset:0 sc1
buffer_load_dwordx4 v[32:35], v2, s[16:19], s94 offen offset:0 sc1
buffer_load_dwordx4 v[36:39], v2, s[16:19], s94 offen offset:1024 sc1
buffer_load_dwordx4 v[40:43], v2, s[16:19], s94 offen offset:2048 sc1
buffer_load_dwordx4 v[44:47], v2, s[16:19], s94 offen offset:3072 sc1
s_add_u32 s94, s91, 2
s_sub_u32 s66, s94, 12
s_cmp_ge_u32 s94, 12
s_cselect_b32 s94, s66, s94
s_mul_i32 s94, s94, 5120
s_add_u32 s94, s94, s92
buffer_load_dwordx4 v[48:51], v1, s[16:19], s94 offen offset:0 sc1
buffer_load_dwordx4 v[52:55], v2, s[16:19], s94 offen offset:0 sc1
buffer_load_dwordx4 v[56:59], v2, s[16:19], s94 offen offset:1024 sc1
buffer_load_dwordx4 v[60:63], v2, s[16:19], s94 offen offset:2048 sc1
buffer_load_dwordx4 v[64:67], v2, s[16:19], s94 offen offset:3072 sc1
s_mov_b32 s86, 0
s_atomic_add s86, s[16:17], s99 offset:0 glc
s_add_u32 s94, s91, 3
s_sub_u32 s66, s94, 12
s_cmp_ge_u32 s94, 12
s_cselect_b32 s94, s66, s94
s_mul_i32 s94, s94, 5120
s_add_u32 s94, s94, s92
buffer_load_dwordx4 v[68:71], v1, s[16:19], s94 offen offset:0 sc1
buffer_load_dwordx4 v[72:75], v2, s[16:19], s94 offen offset:0 sc1
buffer_load_dwordx4 v[76:79], v2, s[16:19], s94 offen offset:1024 sc1
buffer_load_dwordx4 v[80:83], v2, s[16:19], s94 offen offset:2048 sc1
buffer_load_dwordx4 v[84:87], v2, s[16:19], s94 offen offset:3072 sc1
s_add_u32 s94, s91, 4
s_sub_u32 s66, s94, 12
s_cmp_ge_u32 s94, 12
s_cselect_b32 s94, s66, s94
s_mul_i32 s94, s94, 5120
s_add_u32 s94, s94, s92
buffer_load_dwordx4 v[88:91], v1, s[16:19], s94 offen offset:0 sc1
buffer_load_dwordx4 v[92:95], v2, s[16:19], s94 offen offset:0 sc1
buffer_load_dwordx4 v[96:99], v2, s[16:19], s94 offen offset:1024 sc1
buffer_load_dwordx4 v[100:103], v2, s[16:19], s94 offen offset:2048 sc1
buffer_load_dwordx4 v[104:107], v2, s[16:19], s94 offen offset:3072 sc1
s_waitcnt lgkmcnt(0)
s_mov_b32 s67, 0
L_poll_42:
s_cmp_ge_u32 s86, s100
s_cbranch_scc1 L_pollok_44
L_again_43:
s_mov_b32 s86, 0
s_atomic_add s86, s[16:17], s99 offset:0 glc
s_add_u32 s67, s67, 1
s_cmp_lt_u32 s67, 131072
s_waitcnt lgkmcnt(0)
s_cbranch_scc1 L_poll_42
L_pollok_44:
s_add_u32 s95, s91, 0
s_sub_u32 s66, s95, 12
s_cmp_ge_u32 s95, 12
s_cselect_b32 s95, s66, s95
s_mul_i32 s95, s95, 4096
s_add_u32 s95, s95, s93
s_add_u32 s96, s93, 49152
buffer_load_dwordx4 v[128:131], v1, s[16:19], s95 offen offset:0 sc1
buffer_load_dwordx4 v[132:135], v1, s[16:19], s95 offen offset:1024 sc1
buffer_load_dwordx4 v[136:139], v1, s[16:19], s95 offen offset:2048 sc1
buffer_load_dwordx4 v[140:143], v1, s[16:19], s95 offen offset:3072 sc1
s_add_u32 s95, s95, 4096
s_cmp_eq_u32 s95, s96
s_cselect_b32 s95, s93, s95
buffer_load_dwordx4 v[144:147], v1, s[16:19], s95 offen offset:0 sc1
buffer_load_dwordx4 v[148:151], v1, s[16:19], s95 offen offset:1024 sc1
buffer_load_dwordx4 v[152:155], v1, s[16:19], s95 offen offset:2048 sc1
buffer_load_dwordx4 v[156:159], v1, s[16:19], s95 offen offset:3072 sc1
s_add_u32 s95, s95, 4096
s_cmp_eq_u32 s95, s96
s_cselect_b32 s95, s93, s95
s_waitcnt vmcnt(7)
v_mfma_f32_16x16x32_bf16 v[176:179], v[8:11], v[128:131], 0
buffer_load_dwordx4 v[160:163], v1, s[16:19], s95 offen offset:0 sc1
v_mfma_f32_16x16x32_bf16 v[180:183], v[12:15], v[128:131], 0
buffer_load_dwordx4 v[164:167], v1, s[16:19], s95 offen offset:1024 sc1
v_mfma_f32_16x16x32_bf16 v[184:187], v[16:19], v[128:131], 0
buffer_load_dwordx4 v[168:171], v1, s[16:19], s95 offen offset:2048 sc1
v_mfma_f32_16x16x32_bf16 v[188:191], v[20:23], v[128:131], 0
buffer_load_dwordx4 v[172:175], v1, s[16:19], s95 offen offset:3072 sc1
v_mfma_f32_16x16x32_bf16 v[192:195], v[24:27], v[128:131], 0
s_add_u32 s95, s95, 4096
s_waitcnt vmcnt(10)
v_mfma_f32_16x16x32_bf16 v[196:199], v[8:11], v[132:135], 0
s_cmp_eq_u32 s95, s96
s_cselect_b32 s95, s93, s95
v_mfma_f32_16x16x32_bf16 v[200:203], v[12:15], v[132:135], 0
buffer_load_dwordx4 v[128:131], v1, s[16:19], s95 offen offset:0 sc1
v_mfma_f32_16x16x32_bf16 v[204:207], v[16:19], v[132:135], 0
v_mfma_f32_16x16x32_bf16 v[208:211], v[20:23], v[132:135], 0
v_mfma_f32_16x16x32_bf16 v[212:215], v[24:27], v[132:135], 0
s_waitcnt vmcnt(10)
v_mfma_f32_16x16x32_bf16 v[216:219], v[8:11], v[136:139], 0
buffer_load_dwordx4 v[132:135], v1, s[16:19], s95 offen offset:1024 sc1
v_mfma_f32_16x16x32_bf16 v[220:223], v[12:15], v[136:139], 0
v_mfma_f32_16x16x32_bf16 v[224:227], v[16:19], v[136:139], 0
v_mfma_f32_16x16x32_bf16 v[228:231], v[20:23], v[136:139], 0
v_mfma_f32_16x16x32_bf16 v[232:235], v[24:27], v[136:139], 0
s_waitcnt vmcnt(10)
v_mfma_f32_16x16x32_bf16 v[236:239], v[8:11], v[140:143], 0
buffer_load_dwordx4 v[136:139], v1, s[16:19], s95 offen offset:2048 sc1
v_mfma_f32_16x16x32_bf16 v[240:243], v[12:15], v[140:143], 0
v_mfma_f32_16x16x32_bf16 v[244:247], v[16:19], v[140:143], 0
v_mfma_f32_16x16x32_bf16 v[248:251], v[20:23], v[140:143], 0
v_mfma_f32_16x16x32_bf16 v[252:255], v[24:27], v[140:143], 0
s_waitcnt vmcnt(10)
v_mfma_f32_16x16x32_bf16 v[176:179], v[28:31], v[144:147], v[176:179]
buffer_load_dwordx4 v[140:143], v1, s[16:19], s95 offen offset:3072 sc1
v_mfma_f32_16x16x32_bf16 v[180:183], v[32:35], v[144:147], v[180:183]
s_add_u32 s95, s95, 4096
v_mfma_f32_16x16x32_bf16 v[184:187], v[36:39], v[144:147], v[184:187]
s_cmp_eq_u32 s95, s96
s_cselect_b32 s95, s93, s95
v_mfma_f32_16x16x32_bf16 v[188:191], v[40:43], v[144:147], v[188:191]
v_mfma_f32_16x16x32_bf16 v[192:195], v[44:47], v[144:147], v[192:195]
s_waitcnt vmcnt(10)
v_mfma_f32_16x16x32_bf16 v[196:199], v[28:31], v[148:151], v[196:199]
buffer_load_dwordx4 v[144:147], v1, s[16:19], s95 offen offset:0 sc1
v_mfma_f32_16x16x32_bf16 v[200:203], v[32:35], v[148:151], v[200:203]
v_mfma_f32_16x16x32_bf16 v[204:207], v[36:39], v[148:151], v[204:207]
v_mfma_f32_16x16x32_bf16 v[208:211], v[40:43], v[148:151], v[208:211]
v_mfma_f32_16x16x32_bf16 v[212:215], v[44:47], v[148:151], v[212:215]
s_waitcnt vmcnt(10)
v_mfma_f32_16x16x32_bf16 v[216:219], v[28:31], v[152:155], v[216:219]
buffer_load_dwordx4 v[148:151], v1, s[16:19], s95 offen offset:1024 sc1
v_mfma_f32_16x16x32_bf16 v[220:223], v[32:35], v[152:155], v[220:223]
v_mfma_f32_16x16x32_bf16 v[224:227], v[36:39], v[152:155], v[224:227]
v_mfma_f32_16x16x32_bf16 v[228:231], v[40:43], v[152:155], v[228:231]
v_mfma_f32_16x16x32_bf16 v[232:235], v[44:47], v[152:155], v[232:235]
s_waitcnt vmcnt(10)
v_mfma_f32_16x16x32_bf16 v[236:239], v[28:31], v[156:159], v[236:239]
buffer_load_dwordx4 v[152:155], v1, s[16:19], s95 offen offset:2048 sc1
v_mfma_f32_16x16x32_bf16 v[240:243], v[32:35], v[156:159], v[240:243]
v_mfma_f32_16x16x32_bf16 v[244:247], v[36:39], v[156:159], v[244:247]
v_mfma_f32_16x16x32_bf16 v[248:251], v[40:43], v[156:159], v[248:251]
v_mfma_f32_16x16x32_bf16 v[252:255], v[44:47], v[156:159], v[252:255]
s_waitcnt vmcnt(10)
v_mfma_f32_16x16x32_bf16 v[176:179], v[48:51], v[160:163], v[176:179]
buffer_load_dwordx4 v[156:159], v1, s[16:19], s95 offen offset:3072 sc1
v_mfma_f32_16x16x32_bf16 v[180:183], v[52:55], v[160:163], v[180:183]
s_add_u32 s95, s95, 4096
v_mfma_f32_16x16x32_bf16 v[184:187], v[56:59], v[160:163], v[184:187]
s_cmp_eq_u32 s95, s96
s_cselect_b32 s95, s93, s95
v_mfma_f32_16x16x32_bf16 v[188:191], v[60:63], v[160:163], v[188:191]
v_mfma_f32_16x16x32_bf16 v[192:195], v[64:67], v[160:163], v[192:195]
s_waitcnt vmcnt(10)
v_mfma_f32_16x16x32_bf16 v[196:199], v[48:51], v[164:167], v[196:199]
buffer_load_dwordx4 v[160:163], v1, s[16:19], s95 offen offset:0 sc1
v_mfma_f32_16x16x32_bf16 v[200:203], v[52:55], v[164:167], v[200:203]
v_mfma_f32_16x16x32_bf16 v[204:207], v[56:59], v[164:167], v[204:207]
v_mfma_f32_16x16x32_bf16 v[208:211], v[60:63], v[164:167], v[208:211]
v_mfma_f32_16x16x32_bf16 v[212:215], v[64:67], v[164:167], v[212:215]
s_waitcnt vmcnt(10)
v_mfma_f32_16x16x32_bf16 v[216:219], v[48:51], v[168:171], v[216:219]
buffer_load_dwordx4 v[164:167], v1, s[16:19], s95 offen offset:1024 sc1
v_mfma_f32_16x16x32_bf16 v[220:223], v[52:55], v[168:171], v[220:223]
v_mfma_f32_16x16x32_bf16 v[224:227], v[56:59], v[168:171], v[224:227]
v_mfma_f32_16x16x32_bf16 v[228:231], v[60:63], v[168:171], v[228:231]
v_mfma_f32_16x16x32_bf16 v[232:235], v[64:67], v[168:171], v[232:235]
s_waitcnt vmcnt(10)
v_mfma_f32_16x16x32_bf16 v[236:239], v[48:51], v[172:175], v[236:239]
buffer_load_dwordx4 v[168:171], v1, s[16:19], s95 offen offset:2048 sc1
v_mfma_f32_16x16x32_bf16 v[240:243], v[52:55], v[172:175], v[240:243]
v_mfma_f32_16x16x32_bf16 v[244:247], v[56:59], v[172:175], v[244:247]
v_mfma_f32_16x16x32_bf16 v[248:251], v[60:63], v[172:175], v[248:251]
v_mfma_f32_16x16x32_bf16 v[252:255], v[64:67], v[172:175], v[252:255]
ds_read_b32 v6, v5
s_waitcnt vmcnt(10)
v_mfma_f32_16x16x32_bf16 v[176:179], v[68:71], v[128:131], v[176:179]
buffer_load_dwordx4 v[172:175], v1, s[16:19], s95 offen offset:3072 sc1
v_mfma_f32_16x16x32_bf16 v[180:183], v[72:75], v[128:131], v[180:183]
s_add_u32 s95, s95, 4096
v_mfma_f32_16x16x32_bf16 v[184:187], v[76:79], v[128:131], v[184:187]
s_cmp_eq_u32 s95, s96
s_cselect_b32 s95, s93, s95
v_mfma_f32_16x16x32_bf16 v[188:191], v[80:83], v[128:131], v[188:191]
v_mfma_f32_16x16x32_bf16 v[192:195], v[84:87], v[128:131], v[192:195]
s_waitcnt vmcnt(10)
v_mfma_f32_16x16x32_bf16 v[196:199], v[68:71], v[132:135], v[196:199]
buffer_load_dwordx4 v[128:131], v1, s[16:19], s95 offen offset:0 sc1
v_mfma_f32_16x16x32_bf16 v[200:203], v[72:75], v[132:135], v[200:203]
v_mfma_f32_16x16x32_bf16 v[204:207], v[76:79], v[132:135], v[204:207]
v_mfma_f32_16x16x32_bf16 v[208:211], v[80:83], v[132:135], v[208:211]
v_mfma_f32_16x16x32_bf16 v[212:215], v[84:87], v[132:135], v[212:215]
s_waitcnt lgkmcnt(0)
v_readfirstlane_b32 s63, v6
s_nop 0
s_cmp_eq_u32 s63, 1
s_cbranch_scc1 L_wgo_45
s_mov_b32 s67, 0
L_lf_46:
ds_read_b32 v6, v5
s_add_u32 s67, s67, 1
s_waitcnt lgkmcnt(0)
v_readfirstlane_b32 s63, v6
s_nop 0
s_cmp_eq_u32 s63, 1
s_cbranch_scc1 L_wgo_45
s_sleep 1
s_cmp_lt_u32 s67, 2097152
s_cbranch_scc1 L_lf_46
L_wgo_45:
s_waitcnt vmcnt(10)
v_mfma_f32_16x16x32_bf16 v[216:219], v[68:71], v[136:139], v[216:219]
buffer_load_dwordx4 v[132:135], v1, s[16:19], s95 offen offset:1024 sc1
v_mfma_f32_16x16x32_bf16 v[220:223], v[72:75], v[136:139], v[220:223]
ds_read_b128 v[8:11], v3 offset:40960
v_mfma_f32_16x16x32_bf16 v[224:227], v[76:79], v[136:139], v[224:227]
ds_read_b128 v[12:15], v3 offset:41984
v_mfma_f32_16x16x32_bf16 v[228:231], v[80:83], v[136:139], v[228:231]
ds_read_b128 v[16:19], v3 offset:43008
v_mfma_f32_16x16x32_bf16 v[232:235], v[84:87], v[136:139], v[232:235]
ds_read_b128 v[20:23], v3 offset:44032
s_waitcnt vmcnt(10)
v_mfma_f32_16x16x32_bf16 v[236:239], v[68:71], v[140:143], v[236:239]
buffer_load_dwordx4 v[136:139], v1, s[16:19], s95 offen offset:2048 sc1
v_mfma_f32_16x16x32_bf16 v[240:243], v[72:75], v[140:143], v[240:243]
ds_read_b128 v[24:27], v3 offset:45056
v_mfma_f32_16x16x32_bf16 v[244:247], v[76:79], v[140:143], v[244:247]
v_mfma_f32_16x16x32_bf16 v[248:251], v[80:83], v[140:143], v[248:251]
v_mfma_f32_16x16x32_bf16 v[252:255], v[84:87], v[140:143], v[252:255]
s_waitcnt vmcnt(10)
v_mfma_f32_16x16x32_bf16 v[176:179], v[88:91], v[144:147], v[176:179]
buffer_load_dwordx4 v[140:143], v1, s[16:19], s95 offen offset:3072 sc1
v_mfma_f32_16x16x32_bf16 v[180:183], v[92:95], v[144:147], v[180:183]
s_add_u32 s95, s95, 4096
v_mfma_f32_16x16x32_bf16 v[184:187], v[96:99], v[144:147], v[184:187]
s_cmp_eq_u32 s95, s96
s_cselect_b32 s95, s93, s95
v_mfma_f32_16x16x32_bf16 v[188:191], v[100:103], v[144:147], v[188:191]
ds_read_b128 v[28:31], v3 offset:46080
v_mfma_f32_16x16x32_bf16 v[192:195], v[104:107], v[144:147], v[192:195]
ds_read_b128 v[32:35], v3 offset:47104
s_waitcnt vmcnt(10)
v_mfma_f32_16x16x32_bf16 v[196:199], v[88:91], v[148:151], v[196:199]
buffer_load_dwordx4 v[144:147], v1, s[16:19], s95 offen offset:0 sc1
v_mfma_f32_16x16x32_bf16 v[200:203], v[92:95], v[148:151], v[200:203]
ds_read_b128 v[36:39], v3 offset:48128
v_mfma_f32_16x16x32_bf16 v[204:207], v[96:99], v[148:151], v[204:207]
ds_read_b128 v[40:43], v3 offset:49152
v_mfma_f32_16x16x32_bf16 v[208:211], v[100:103], v[148:151], v[208:211]
ds_read_b128 v[44:47], v3 offset:50176
v_mfma_f32_16x16x32_bf16 v[212:215], v[104:107], v[148:151], v[212:215]
s_waitcnt vmcnt(10)
v_mfma_f32_16x16x32_bf16 v[216:219], v[88:91], v[152:155], v[216:219]
buffer_load_dwordx4 v[148:151], v1, s[16:19], s95 offen offset:1024 sc1
v_mfma_f32_16x16x32_bf16 v[220:223], v[92:95], v[152:155], v[220:223]
v_mfma_f32_16x16x32_bf16 v[224:227], v[96:99], v[152:155], v[224:227]
v_mfma_f32_16x16x32_bf16 v[228:231], v[100:103], v[152:155], v[228:231]
v_mfma_f32_16x16x32_bf16 v[232:235], v[104:107], v[152:155], v[232:235]
s_waitcnt vmcnt(10)
v_mfma_f32_16x16x32_bf16 v[236:239], v[88:91], v[156:159], v[236:239]
buffer_load_dwordx4 v[152:155], v1, s[16:19], s95 offen offset:2048 sc1
v_mfma_f32_16x16x32_bf16 v[240:243], v[92:95], v[156:159], v[240:243]
v_mfma_f32_16x16x32_bf16 v[244:247], v[96:99], v[156:159], v[244:247]
v_mfma_f32_16x16x32_bf16 v[248:251], v[100:103], v[156:159], v[248:251]
v_mfma_f32_16x16x32_bf16 v[252:255], v[104:107], v[156:159], v[252:255]
s_waitcnt vmcnt(10)
v_mfma_f32_16x16x32_bf16 v[176:179], v[108:111], v[160:163], v[176:179]
buffer_load_dwordx4 v[156:159], v1, s[16:19], s95 offen offset:3072 sc1
v_mfma_f32_16x16x32_bf16 v[180:183], v[112:115], v[160:163], v[180:183]
s_add_u32 s95, s95, 4096
v_mfma_f32_16x16x32_bf16 v[184:187], v[116:119], v[160:163], v[184:187]
s_cmp_eq_u32 s95, s96
s_cselect_b32 s95, s93, s95
v_mfma_f32_16x16x32_bf16 v[188:191], v[120:123], v[160:163], v[188:191]
ds_read_b128 v[48:51], v4 offset:0
v_mfma_f32_16x16x32_bf16 v[192:195], v[124:127], v[160:163], v[192:195]
ds_read_b128 v[52:55], v4 offset:1024
s_waitcnt vmcnt(10)
v_mfma_f32_16x16x32_bf16 v[196:199], v[108:111], v[164:167], v[196:199]
buffer_load_dwordx4 v[160:163], v1, s[16:19], s95 offen offset:0 sc1
v_mfma_f32_16x16x32_bf16 v[200:203], v[112:115], v[164:167], v[200:203]
ds_read_b128 v[56:59], v4 offset:2048
v_mfma_f32_16x16x32_bf16 v[204:207], v[116:119], v[164:167], v[204:207]
ds_read_b128 v[60:63], v4 offset:3072
v_mfma_f32_16x16x32_bf16 v[208:211], v[120:123], v[164:167], v[208:211]
ds_read_b128 v[64:67], v4 offset:4096
v_mfma_f32_16x16x32_bf16 v[212:215], v[124:127], v[164:167], v[212:215]
s_waitcnt vmcnt(10)
v_mfma_f32_16x16x32_bf16 v[216:219], v[108:111], v[168:171], v[216:219]
buffer_load_dwordx4 v[164:167], v1, s[16:19], s95 offen offset:1024 sc1
v_mfma_f32_16x16x32_bf16 v[220:223], v[112:115], v[168:171], v[220:223]
v_mfma_f32_16x16x32_bf16 v[224:227], v[116:119], v[168:171], v[224:227]
v_mfma_f32_16x16x32_bf16 v[228:231], v[120:123], v[168:171], v[228:231]
v_mfma_f32_16x16x32_bf16 v[232:235], v[124:127], v[168:171], v[232:235]
s_waitcnt vmcnt(10)
v_mfma_f32_16x16x32_bf16 v[236:239], v[108:111], v[172:175], v[236:239]
buffer_load_dwordx4 v[168:171], v1, s[16:19], s95 offen offset:2048 sc1
v_mfma_f32_16x16x32_bf16 v[240:243], v[112:115], v[172:175], v[240:243]
v_mfma_f32_16x16x32_bf16 v[244:247], v[116:119], v[172:175], v[244:247]
v_mfma_f32_16x16x32_bf16 v[248:251], v[120:123], v[172:175], v[248:251]
v_mfma_f32_16x16x32_bf16 v[252:255], v[124:127], v[172:175], v[252:255]
s_waitcnt lgkmcnt(10)
s_waitcnt vmcnt(10)
v_mfma_f32_16x16x32_bf16 v[176:179], v[8:11], v[128:131], v[176:179]
buffer_load_dwordx4 v[172:175], v1, s[16:19], s95 offen offset:3072 sc1
v_mfma_f32_16x16x32_bf16 v[180:183], v[12:15], v[128:131], v[180:183]
s_add_u32 s95, s95, 4096
v_mfma_f32_16x16x32_bf16 v[184:187], v[16:19], v[128:131], v[184:187]
s_cmp_eq_u32 s95, s96
s_cselect_b32 s95, s93, s95
v_mfma_f32_16x16x32_bf16 v[188:191], v[20:23], v[128:131], v[188:191]
ds_read_b128 v[68:71], v4 offset:5120
v_mfma_f32_16x16x32_bf16 v[192:195], v[24:27], v[128:131], v[192:195]
ds_read_b128 v[72:75], v4 offset:6144
s_waitcnt vmcnt(10)
v_mfma_f32_16x16x32_bf16 v[196:199], v[8:11], v[132:135], v[196:199]
buffer_load_dwordx4 v[128:131], v1, s[16:19], s95 offen offset:0 sc1
v_mfma_f32_16x16x32_bf16 v[200:203], v[12:15], v[132:135], v[200:203]
ds_read_b128 v[76:79], v4 offset:7168
v_mfma_f32_16x16x32_bf16 v[204:207], v[16:19], v[132:135], v[204:207]
ds_read_b128 v[80:83], v4 offset:8192
v_mfma_f32_16x16x32_bf16 v[208:211], v[20:23], v[132:135], v[208:211]
ds_read_b128 v[84:87], v4 offset:9216
v_mfma_f32_16x16x32_bf16 v[212:215], v[24:27], v[132:135], v[212:215]
s_waitcnt vmcnt(10)
v_mfma_f32_16x16x32_bf16 v[216:219], v[8:11], v[136:139], v[216:219]
buffer_load_dwordx4 v[132:135], v1, s[16:19], s95 offen offset:1024 sc1
v_mfma_f32_16x16x32_bf16 v[220:223], v[12:15], v[136:139], v[220:223]
v_mfma_f32_16x16x32_bf16 v[224:227], v[16:19], v[136:139], v[224:227]
v_mfma_f32_16x16x32_bf16 v[228:231], v[20:23], v[136:139], v[228:231]
v_mfma_f32_16x16x32_bf16 v[232:235], v[24:27], v[136:139], v[232:235]
s_waitcnt vmcnt(10)
v_mfma_f32_16x16x32_bf16 v[236:239], v[8:11], v[140:143], v[236:239]
buffer_load_dwordx4 v[136:139], v1, s[16:19], s95 offen offset:2048 sc1
v_mfma_f32_16x16x32_bf16 v[240:243], v[12:15], v[140:143], v[240:243]
v_mfma_f32_16x16x32_bf16 v[244:247], v[16:19], v[140:143], v[244:247]
v_mfma_f32_16x16x32_bf16 v[248:251], v[20:23], v[140:143], v[248:251]
v_mfma_f32_16x16x32_bf16 v[252:255], v[24:27], v[140:143], v[252:255]
s_waitcnt lgkmcnt(10)
s_waitcnt vmcnt(10)
v_mfma_f32_16x16x32_bf16 v[176:179], v[28:31], v[144:147], v[176:179]
buffer_load_dwordx4 v[140:143], v1, s[16:19], s95 offen offset:3072 sc1
v_mfma_f32_16x16x32_bf16 v[180:183], v[32:35], v[144:147], v[180:183]
s_add_u32 s95, s95, 4096
v_mfma_f32_16x16x32_bf16 v[184:187], v[36:39], v[144:147], v[184:187]
s_cmp_eq_u32 s95, s96
s_cselect_b32 s95, s93, s95
v_mfma_f32_16x16x32_bf16 v[188:191], v[40:43], v[144:147], v[188:191]
ds_read_b128 v[88:91], v3 offset:0
v_mfma_f32_16x16x32_bf16 v[192:195], v[44:47], v[144:147], v[192:195]
ds_read_b128 v[92:95], v3 offset:1024
s_waitcnt vmcnt(10)
v_mfma_f32_16x16x32_bf16 v[196:199], v[28:31], v[148:151], v[196:199]
buffer_load_dwordx4 v[144:147], v1, s[16:19], s95 offen offset:0 sc1
v_mfma_f32_16x16x32_bf16 v[200:203], v[32:35], v[148:151], v[200:203]
ds_read_b128 v[96:99], v3 offset:2048
v_mfma_f32_16x16x32_bf16 v[204:207], v[36:39], v[148:151], v[204:207]
ds_read_b128 v[100:103], v3 offset:3072
v_mfma_f32_16x16x32_bf16 v[208:211], v[40:43], v[148:151], v[208:211]
ds_read_b128 v[104:107], v3 offset:4096
v_mfma_f32_16x16x32_bf16 v[212:215], v[44:47], v[148:151], v[212:215]
s_waitcnt vmcnt(10)
v_mfma_f32_16x16x32_bf16 v[216:219], v[28:31], v[152:155], v[216:219]
buffer_load_dwordx4 v[148:151], v1, s[16:19], s95 offen offset:1024 sc1
v_mfma_f32_16x16x32_bf16 v[220:223], v[32:35], v[152:155], v[220:223]
v_mfma_f32_16x16x32_bf16 v[224:227], v[36:39], v[152:155], v[224:227]
v_mfma_f32_16x16x32_bf16 v[228:231], v[40:43], v[152:155], v[228:231]
v_mfma_f32_16x16x32_bf16 v[232:235], v[44:47], v[152:155], v[232:235]
s_waitcnt vmcnt(10)
v_mfma_f32_16x16x32_bf16 v[236:239], v[28:31], v[156:159], v[236:239]
buffer_load_dwordx4 v[152:155], v1, s[16:19], s95 offen offset:2048 sc1
v_mfma_f32_16x16x32_bf16 v[240:243], v[32:35], v[156:159], v[240:243]
v_mfma_f32_16x16x32_bf16 v[244:247], v[36:39], v[156:159], v[244:247]
v_mfma_f32_16x16x32_bf16 v[248:251], v[40:43], v[156:159], v[248:251]
v_mfma_f32_16x16x32_bf16 v[252:255], v[44:47], v[156:159], v[252:255]
s_waitcnt lgkmcnt(10)
s_waitcnt vmcnt(10)
v_mfma_f32_16x16x32_bf16 v[176:179], v[48:51], v[160:163], v[176:179]
buffer_load_dwordx4 v[156:159], v1, s[16:19], s95 offen offset:3072 sc1
v_mfma_f32_16x16x32_bf16 v[180:183], v[52:55], v[160:163], v[180:183]
s_add_u32 s95, s95, 4096
v_mfma_f32_16x16x32_bf16 v[184:187], v[56:59], v[160:163], v[184:187]
s_cmp_eq_u32 s95, s96
s_cselect_b32 s95, s93, s95
v_mfma_f32_16x16x32_bf16 v[188:191], v[60:63], v[160:163], v[188:191]
ds_read_b128 v[108:111], v3 offset:5120
v_mfma_f32_16x16x32_bf16 v[192:195], v[64:67], v[160:163], v[192:195]
ds_read_b128 v[112:115], v3 offset:6144
s_waitcnt vmcnt(10)
v_mfma_f32_16x16x32_bf16 v[196:199], v[48:51], v[164:167], v[196:199]
buffer_load_dwordx4 v[160:163], v1, s[16:19], s95 offen offset:0 sc1
v_mfma_f32_16x16x32_bf16 v[200:203], v[52:55], v[164:167], v[200:203]
ds_read_b128 v[116:119], v3 offset:7168
v_mfma_f32_16x16x32_bf16 v[204:207], v[56:59], v[164:167], v[204:207]
ds_read_b128 v[120:123], v3 offset:8192
v_mfma_f32_16x16x32_bf16 v[208:211], v[60:63], v[164:167], v[208:211]
ds_read_b128 v[124:127], v3 offset:9216
v_mfma_f32_16x16x32_bf16 v[212:215], v[64:67], v[164:167], v[212:215]
s_waitcnt vmcnt(10)
v_mfma_f32_16x16x32_bf16 v[216:219], v[48:51], v[168:171], v[216:219]
buffer_load_dwordx4 v[164:167], v1, s[16:19], s95 offen offset:1024 sc1
v_mfma_f32_16x16x32_bf16 v[220:223], v[52:55], v[168:171], v[220:223]
v_mfma_f32_16x16x32_bf16 v[224:227], v[56:59], v[168:171], v[224:227]
v_mfma_f32_16x16x32_bf16 v[228:231], v[60:63], v[168:171], v[228:231]
v_mfma_f32_16x16x32_bf16 v[232:235], v[64:67], v[168:171], v[232:235]
s_waitcnt vmcnt(10)
v_mfma_f32_16x16x32_bf16 v[236:239], v[48:51], v[172:175], v[236:239]
buffer_load_dwordx4 v[168:171], v1, s[16:19], s95 offen offset:2048 sc1
v_mfma_f32_16x16x32_bf16 v[240:243], v[52:55], v[172:175], v[240:243]
v_mfma_f32_16x16x32_bf16 v[244:247], v[56:59], v[172:175], v[244:247]
v_mfma_f32_16x16x32_bf16 v[248:251], v[60:63], v[172:175], v[248:251]
v_mfma_f32_16x16x32_bf16 v[252:255], v[64:67], v[172:175], v[252:255]
s_waitcnt lgkmcnt(10)
s_waitcnt vmcnt(10)
v_mfma_f32_16x16x32_bf16 v[176:179], v[68:71], v[128:131], v[176:179]
buffer_load_dwordx4 v[172:175], v1, s[16:19], s95 offen offset:3072 sc1
v_mfma_f32_16x16x32_bf16 v[180:183], v[72:75], v[128:131], v[180:183]
s_add_u32 s95, s95, 4096
v_mfma_f32_16x16x32_bf16 v[184:187], v[76:79], v[128:131], v[184:187]
s_cmp_eq_u32 s95, s96
s_cselect_b32 s95, s93, s95
v_mfma_f32_16x16x32_bf16 v[188:191], v[80:83], v[128:131], v[188:191]
v_mfma_f32_16x16x32_bf16 v[192:195], v[84:87], v[128:131], v[192:195]
s_waitcnt lgkmcnt(5)
s_waitcnt vmcnt(7)
v_mfma_f32_16x16x32_bf16 v[176:179], v[88:91], v[144:147], v[176:179]
v_mfma_f32_16x16x32_bf16 v[180:183], v[92:95], v[144:147], v[180:183]
v_mfma_f32_16x16x32_bf16 v[184:187], v[96:99], v[144:147], v[184:187]
v_mfma_f32_16x16x32_bf16 v[188:191], v[100:103], v[144:147], v[188:191]
v_mfma_f32_16x16x32_bf16 v[192:195], v[104:107], v[144:147], v[192:195]
s_waitcnt lgkmcnt(0)
s_waitcnt vmcnt(3)
v_mfma_f32_16x16x32_bf16 v[176:179], v[108:111], v[160:163], v[176:179]
v_mfma_f32_16x16x32_bf16 v[180:183], v[112:115], v[160:163], v[180:183]
v_mfma_f32_16x16x32_bf16 v[184:187], v[116:119], v[160:163], v[184:187]
v_mfma_f32_16x16x32_bf16 v[188:191], v[120:123], v[160:163], v[188:191]
v_mfma_f32_16x16x32_bf16 v[192:195], v[124:127], v[160:163], v[192:195]
v_mfma_f32_16x16x32_bf16 v[196:199], v[68:71], v[132:135], v[196:199]
v_mfma_f32_16x16x32_bf16 v[200:203], v[72:75], v[132:135], v[200:203]
v_mfma_f32_16x16x32_bf16 v[204:207], v[76:79], v[132:135], v[204:207]
s_nop 0
ds_write_b128 v3, v[176:179] offset:40960
v_mfma_f32_16x16x32_bf16 v[208:211], v[80:83], v[132:135], v[208:211]
v_mfma_f32_16x16x32_bf16 v[212:215], v[84:87], v[132:135], v[212:215]
ds_write_b128 v3, v[180:183] offset:41984
v_mfma_f32_16x16x32_bf16 v[196:199], v[88:91], v[148:151], v[196:199]
v_mfma_f32_16x16x32_bf16 v[200:203], v[92:95], v[148:151], v[200:203]
ds_write_b128 v3, v[184:187] offset:43008
v_mfma_f32_16x16x32_bf16 v[204:207], v[96:99], v[148:151], v[204:207]
v_mfma_f32_16x16x32_bf16 v[208:211], v[100:103], v[148:151], v[208:211]
ds_write_b128 v3, v[188:191] offset:44032
v_mfma_f32_16x16x32_bf16 v[212:215], v[104:107], v[148:151], v[212:215]
s_waitcnt vmcnt(2)
v_mfma_f32_16x16x32_bf16 v[196:199], v[108:111], v[164:167], v[196:199]
ds_write_b128 v3, v[192:195] offset:45056
v_mfma_f32_16x16x32_bf16 v[200:203], v[112:115], v[164:167], v[200:203]
v_mfma_f32_16x16x32_bf16 v[204:207], v[116:119], v[164:167], v[204:207]
v_mfma_f32_16x16x32_bf16 v[208:211], v[120:123], v[164:167], v[208:211]
v_mfma_f32_16x16x32_bf16 v[212:215], v[124:127], v[164:167], v[212:215]
v_mfma_f32_16x16x32_bf16 v[216:219], v[68:71], v[136:139], v[216:219]
v_mfma_f32_16x16x32_bf16 v[220:223], v[72:75], v[136:139], v[220:223]
v_mfma_f32_16x16x32_bf16 v[224:227], v[76:79], v[136:139], v[224:227]
ds_write_b128 v3, v[196:199] offset:46080
v_mfma_f32_16x16x32_bf16 v[228:231], v[80:83], v[136:139], v[228:231]
v_mfma_f32_16x16x32_bf16 v[232:235], v[84:87], v[136:139], v[232:235]
ds_write_b128 v3, v[200:203] offset:47104
v_mfma_f32_16x16x32_bf16 v[216:219], v[88:91], v[152:155], v[216:219]
v_mfma_f32_16x16x32_bf16 v[220:223], v[92:95], v[152:155], v[220:223]
ds_write_b128 v3, v[204:207] offset:48128
v_mfma_f32_16x16x32_bf16 v[224:227], v[96:99], v[152:155], v[224:227]
v_mfma_f32_16x16x32_bf16 v[228:231], v[100:103], v[152:155], v[228:231]
ds_write_b128 v3, v[208:211] offset:49152
v_mfma_f32_16x16x32_bf16 v[232:235], v[104:107], v[152:155], v[232:235]
s_waitcnt vmcnt(1)
v_mfma_f32_16x16x32_bf16 v[216:219], v[108:111], v[168:171], v[216:219]
ds_write_b128 v3, v[212:215] offset:50176
v_mfma_f32_16x16x32_bf16 v[220:223], v[112:115], v[168:171], v[220:223]
v_mfma_f32_16x16x32_bf16 v[224:227], v[116:119], v[168:171], v[224:227]
v_mfma_f32_16x16x32_bf16 v[228:231], v[120:123], v[168:171], v[228:231]
v_mfma_f32_16x16x32_bf16 v[232:235], v[124:127], v[168:171], v[232:235]
v_mfma_f32_16x16x32_bf16 v[236:239], v[68:71], v[140:143], v[236:239]
v_mfma_f32_16x16x32_bf16 v[240:243], v[72:75], v[140:143], v[240:243]
v_mfma_f32_16x16x32_bf16 v[244:247], v[76:79], v[140:143], v[244:247]
ds_write_b128 v4, v[216:219] offset:0
v_mfma_f32_16x16x32_bf16 v[248:251], v[80:83], v[140:143], v[248:251]
v_mfma_f32_16x16x32_bf16 v[252:255], v[84:87], v[140:143], v[252:255]
ds_write_b128 v4, v[220:223] offset:1024
v_mfma_f32_16x16x32_bf16 v[236:239], v[88:91], v[156:159], v[236:239]
v_mfma_f32_16x16x32_bf16 v[240:243], v[92:95], v[156:159], v[240:243]
ds_write_b128 v4, v[224:227] offset:2048
v_mfma_f32_16x16x32_bf16 v[244:247], v[96:99], v[156:159], v[244:247]
v_mfma_f32_16x16x32_bf16 v[248:251], v[100:103], v[156:159], v[248:251]
ds_write_b128 v4, v[228:231] offset:3072
v_mfma_f32_16x16x32_bf16 v[252:255], v[104:107], v[156:159], v[252:255]
s_waitcnt vmcnt(0)
v_mfma_f32_16x16x32_bf16 v[236:239], v[108:111], v[172:175], v[236:239]
ds_write_b128 v4, v[232:235] offset:4096
v_mfma_f32_16x16x32_bf16 v[240:243], v[112:115], v[172:175], v[240:243]
v_mfma_f32_16x16x32_bf16 v[244:247], v[116:119], v[172:175], v[244:247]
v_mfma_f32_16x16x32_bf16 v[248:251], v[120:123], v[172:175], v[248:251]
v_mfma_f32_16x16x32_bf16 v[252:255], v[124:127], v[172:175], v[252:255]
s_nop 2
ds_write_b128 v4, v[236:239] offset:5120
s_nop 0
ds_write_b128 v4, v[240:243] offset:6144
ds_write_b128 v4, v[244:247] offset:7168
ds_write_b128 v4, v[248:251] offset:8192
ds_write_b128 v4, v[252:255] offset:9216
s_waitcnt lgkmcnt(0)
s_barrier
s_endpgm
L_geo_b:
s_lshl1_add_u32 s63, s64, s63
s_lshl1_add_u32 s63, s63, s55
s_sub_u32 s63, s63, 30
s_mov_b32 s56, 30
s_mul_i32 s57, s63, 6
s_mul_i32 s64, s63, 205
s_lshr_b32 s64, s64, 11
s_mul_i32 s64, s64, 10
s_sub_u32 s58, s63, s64
s_cmp_lt_u32 s52, 4
s_cbranch_scc1 L_roleA_b
s_setprio 1
v_lshrrev_b32 v20, 3, v0
v_mul_u32_u24 v20, 1280, v20
s_mul_i32 s63, s56, 81920
s_mul_i32 s64, s53, 40960
s_add_u32 s63, s63, s64
v_add_u32 v20, s63, v20
v_and_b32 v21, 7, v0
v_lshrrev_b32 v22, 4, v0
v_xor_b32 v21, v21, v22
v_lshl_add_u32 v1, v21, 4, v20
v_xor_b32 v2, 64, v1
v_add_u32 v2, 10240, v2
s_mul_i32 s86, s53, 4096
s_mul_i32 s87, s53, 6144
s_add_u32 s87, s87, 16384
v_bfe_u32 v20, v0, 2, 2
v_mul_u32_u24 v20, 3072, v20
v_and_b32 v21, 3, v0
v_lshl_add_u32 v20, v21, 4, v20
s_mul_i32 s63, s53, 49152
s_lshl_b32 s64, s57, 5
s_add_u32 s63, s63, s64
v_add_u32 v20, s63, v20
s_mov_b32 s6, 2621440
s_mov_b32 s7, 0x20000
s_mov_b32 s10, 1966080
s_mov_b32 s11, 0x20000
s_mov_b32 s14, 1966080
s_mov_b32 s15, 0x20000
s_waitcnt lgkmcnt(0)
s_lshl_b32 s88, s58, 7
s_mul_i32 s89, s58, 196608
s_add_u32 s58, s58, 1
s_cmp_eq_u32 s58, 10
s_cselect_b32 s58, 0, s58
s_add_u32 m0, s86, 0
s_nop 0
buffer_load_dwordx4 v1, s[4:7], s88 offen lds
s_add_u32 m0, s86, 1024
s_nop 0
buffer_load_dwordx4 v2, s[4:7], s88 offen lds
s_add_u32 m0, s86, 2048
s_add_u32 s88, s88, 20480
buffer_load_dwordx4 v1, s[4:7], s88 offen lds
s_add_u32 m0, s86, 3072
s_nop 0
buffer_load_dwordx4 v2, s[4:7], s88 offen lds
s_load_dwordx2 s[20:21], s[0:1], 8
s_load_dwordx2 s[24:25], s[0:1], 16
s_load_dwordx2 s[28:29], s[0:1], 24
s_load_dwordx2 s[32:33], s[0:1], 32
s_load_dwordx2 s[36:37], s[0:1], 40
s_load_dwordx2 s[40:41], s[0:1], 80
s_load_dwordx2 s[48:49], s[0:1], 72
v_add_u32 v21, 0, v22
v_mul_u32_u24 v23, 11, v21
v_lshrrev_b32 v23, 5, v23
v_mul_u32_u24 v24, 12096, v23
v_lshl_add_u32 v24, v21, 6, v24
v_add_u32 v5, v24, v20
v_and_b32 v23, 2, v23
v_lshlrev_b32 v23, 4, v23
v_xor_b32 v5, v23, v5
s_add_u32 m0, s87, 0
s_nop 0
buffer_load_dwordx4 v5, s[8:11], s89 offen lds
v_add_u32 v21, 4, v22
v_mul_u32_u24 v23, 11, v21
v_lshrrev_b32 v23, 5, v23
v_mul_u32_u24 v24, 12096, v23
v_lshl_add_u32 v24, v21, 6, v24
v_add_u32 v6, v24, v20
v_and_b32 v23, 2, v23
v_lshlrev_b32 v23, 4, v23
v_xor_b32 v6, v23, v6
s_add_u32 m0, s87, 1024
s_nop 0
buffer_load_dwordx4 v6, s[8:11], s89 offen lds
v_add_u32 v21, 8, v22
v_mul_u32_u24 v23, 11, v21
v_lshrrev_b32 v23, 5, v23
v_mul_u32_u24 v24, 12096, v23
v_lshl_add_u32 v24, v21, 6, v24
v_add_u32 v7, v24, v20
v_and_b32 v23, 2, v23
v_lshlrev_b32 v23, 4, v23
v_xor_b32 v7, v23, v7
s_add_u32 m0, s87, 2048
s_nop 0
buffer_load_dwordx4 v7, s[8:11], s89 offen lds
s_add_u32 m0, s87, 3072
s_nop 0
buffer_load_dwordx4 v5, s[12:15], s89 offen lds
s_add_u32 m0, s87, 4096
s_nop 0
buffer_load_dwordx4 v6, s[12:15], s89 offen lds
s_add_u32 m0, s87, 5120
s_nop 0
buffer_load_dwordx4 v7, s[12:15], s89 offen lds
s_and_b32 s63, s54, 1
s_lshr_b32 s64, s54, 1
s_lshl2_add_u32 s66, s63, s64
s_lshl_b32 s61, s66, 5
s_add_u32 s61, s61, s55
s_bfe_u32 s64, s54, 0x10001
s_lshl1_add_u32 s63, s63, s64
s_and_b32 s64, s55, 7
s_lshl3_add_u32 s59, s63, s64
s_lshr_b32 s63, s54, 2
s_lshr_b32 s64, s55, 3
s_lshl2_add_u32 s60, s63, s64
s_mov_b32 s18, 20971520
s_mov_b32 s19, 0x20000
s_mov_b32 s22, 2621440
s_mov_b32 s23, 0x20000
s_mov_b32 s26, 2621440
s_mov_b32 s27, 0x20000
s_mov_b32 s30, 5120
s_mov_b32 s31, 0x20000
s_mov_b32 s34, 2621440
s_mov_b32 s35, 0x20000
s_mov_b32 s38, 1280
s_mov_b32 s39, 0x20000
s_mov_b32 s42, 2621440
s_mov_b32 s43, 0x20000
s_mov_b32 s46, 256
s_mov_b32 s47, 0x20000
s_mov_b32 s50, 1966080
s_mov_b32 s51, 0x20000
s_waitcnt lgkmcnt(0)
s_mov_b32 s90, 0
s_lshl2_add_u32 s63, s55, s53
s_sub_u32 s63, s63, 80
s_mul_i32 s65, s54, 48
s_add_u32 s62, s63, s65
s_lshr_b32 s92, s62, 3
s_and_b32 s64, s62, 3
s_lshl2_add_u32 s92, s92, s64
s_mul_i32 s92, s92, 10240
s_bfe_u32 s64, s62, 0x10002
s_mul_i32 s64, s64, 640
s_add_u32 s92, s92, s64
s_mul_i32 s91, s53, 8704
s_add_u32 s91, s91, 122880
v_add_u32 v151, 0, v0
v_mul_u32_u24 v152, 1639, v151
v_lshrrev_b32 v152, 16, v152
v_mul_u32_u24 v152, 640, v152
v_lshl_add_u32 v152, v151, 4, v152
s_add_u32 m0, s91, 0
s_nop 0
buffer_load_dwordx4 v152, s[48:51], s92 offen nt lds
v_add_u32 v151, 64, v0
v_mul_u32_u24 v152, 1639, v151
v_lshrrev_b32 v152, 16, v152
v_mul_u32_u24 v152, 640, v152
v_lshl_add_u32 v152, v151, 4, v152
s_add_u32 m0, s91, 1024
s_nop 0
buffer_load_dwordx4 v152, s[48:51], s92 offen nt lds
v_add_u32 v151, 128, v0
v_mul_u32_u24 v152, 1639, v151
v_lshrrev_b32 v152, 16, v152
v_mul_u32_u24 v152, 640, v152
v_lshl_add_u32 v152, v151, 4, v152
s_add_u32 m0, s91, 2048
s_nop 0
buffer_load_dwordx4 v152, s[48:51], s92 offen nt lds
v_add_u32 v151, 192, v0
v_mul_u32_u24 v152, 1639, v151
v_lshrrev_b32 v152, 16, v152
v_mul_u32_u24 v152, 640, v152
v_lshl_add_u32 v152, v151, 4, v152
s_add_u32 m0, s91, 3072
s_nop 0
buffer_load_dwordx4 v152, s[48:51], s92 offen nt lds
v_add_u32 v151, 256, v0
v_mul_u32_u24 v152, 1639, v151
v_lshrrev_b32 v152, 16, v152
v_mul_u32_u24 v152, 640, v152
v_lshl_add_u32 v152, v151, 4, v152
s_add_u32 m0, s91, 4096
s_nop 0
buffer_load_dwordx4 v152, s[48:51], s92 offen nt lds
s_lshl_b32 s88, s58, 7
s_mul_i32 s89, s58, 196608
s_add_u32 s58, s58, 1
s_cmp_eq_u32 s58, 10
s_cselect_b32 s58, 0, s58
s_add_u32 m0, s86, 40960
s_nop 0
buffer_load_dwordx4 v1, s[4:7], s88 offen lds
v_mov_b32 v56, 162304
s_add_u32 m0, s86, 41984
s_nop 0
buffer_load_dwordx4 v2, s[4:7], s88 offen lds
v_mov_b32 v58, 0
s_add_u32 m0, s86, 43008
s_add_u32 s88, s88, 20480
buffer_load_dwordx4 v1, s[4:7], s88 offen lds
v_mov_b32 v59, 0
s_add_u32 m0, s86, 44032
s_nop 0
buffer_load_dwordx4 v2, s[4:7], s88 offen lds
ds_write_b64 v56, v[58:59] offset:0
s_add_u32 m0, s87, 40960
s_nop 0
buffer_load_dwordx4 v5, s[8:11], s89 offen lds
ds_write_b64 v56, v[58:59] offset:8
s_add_u32 m0, s87, 41984
s_nop 0
buffer_load_dwordx4 v6, s[8:11], s89 offen lds
ds_write_b64 v56, v[58:59] offset:16
s_add_u32 m0, s87, 43008
s_nop 0
buffer_load_dwordx4 v7, s[8:11], s89 offen lds
s_waitcnt lgkmcnt(0)
s_waitcnt vmcnt(12)
s_barrier
s_add_u32 m0, s87, 44032
s_nop 0
buffer_load_dwordx4 v5, s[12:15], s89 offen lds
s_add_u32 m0, s87, 45056
s_nop 0
buffer_load_dwordx4 v6, s[12:15], s89 offen lds
s_add_u32 m0, s87, 46080
s_nop 0
buffer_load_dwordx4 v7, s[12:15], s89 offen lds
s_lshl_b32 s88, s58, 7
s_mul_i32 s89, s58, 196608
s_add_u32 s58, s58, 1
s_cmp_eq_u32 s58, 10
s_cselect_b32 s58, 0, s58
s_add_u32 m0, s86, 81920
s_nop 0
buffer_load_dwordx4 v1, s[4:7], s88 offen lds
s_add_u32 m0, s86, 82944
s_nop 0
buffer_load_dwordx4 v2, s[4:7], s88 offen lds
s_add_u32 m0, s86, 83968
s_add_u32 s88, s88, 20480
buffer_load_dwordx4 v1, s[4:7], s88 offen lds
s_add_u32 m0, s86, 84992
s_nop 0
buffer_load_dwordx4 v2, s[4:7], s88 offen lds
s_add_u32 m0, s87, 81920
s_nop 0
buffer_load_dwordx4 v5, s[8:11], s89 offen lds
s_add_u32 m0, s87, 82944
s_nop 0
buffer_load_dwordx4 v6, s[8:11], s89 offen lds
s_add_u32 m0, s87, 83968
s_nop 0
buffer_load_dwordx4 v7, s[8:11], s89 offen lds
s_add_u32 m0, s87, 84992
s_nop 0
buffer_load_dwordx4 v5, s[12:15], s89 offen lds
s_add_u32 m0, s87, 86016
s_nop 0
buffer_load_dwordx4 v6, s[12:15], s89 offen lds
s_add_u32 m0, s87, 87040
s_nop 0
buffer_load_dwordx4 v7, s[12:15], s89 offen lds
s_cmp_lg_u32 s53, 3
s_cbranch_scc1 L_vi_57
s_mov_b64 exec, 1
buffer_load_dword v58, v59, s[44:47], 0 offen sc1
s_mov_b64 exec, -1
L_vi_57:
s_waitcnt vmcnt(10)
s_barrier
s_lshl_b32 s88, s58, 7
s_mul_i32 s89, s58, 196608
s_add_u32 s58, s58, 1
s_cmp_eq_u32 s58, 10
s_cselect_b32 s58, 0, s58
s_add_u32 m0, s86, 0
s_nop 0
buffer_load_dwordx4 v1, s[4:7], s88 offen lds
s_add_u32 m0, s86, 1024
s_nop 0
buffer_load_dwordx4 v2, s[4:7], s88 offen lds
s_add_u32 m0, s86, 2048
s_add_u32 s88, s88, 20480
buffer_load_dwordx4 v1, s[4:7], s88 offen lds
s_add_u32 m0, s86, 3072
s_nop 0
buffer_load_dwordx4 v2, s[4:7], s88 offen lds
s_add_u32 m0, s87, 0
s_nop 0
buffer_load_dwordx4 v5, s[8:11], s89 offen lds
s_add_u32 m0, s87, 1024
s_nop 0
buffer_load_dwordx4 v6, s[8:11], s89 offen lds
s_add_u32 m0, s87, 2048
s_nop 0
buffer_load_dwordx4 v7, s[8:11], s89 offen lds
s_add_u32 m0, s87, 3072
s_nop 0
buffer_load_dwordx4 v5, s[12:15], s89 offen lds
s_add_u32 m0, s87, 4096
s_nop 0
buffer_load_dwordx4 v6, s[12:15], s89 offen lds
s_add_u32 m0, s87, 5120
s_nop 0
buffer_load_dwordx4 v7, s[12:15], s89 offen lds
s_waitcnt vmcnt(9)
s_cmp_lg_u32 s53, 3
s_cbranch_scc1 L_vcskip_60
s_mov_b64 exec, 1
s_mov_b32 s67, 0
L_vc_58:
v_cmp_le_u32 vcc, 1, v58
s_nop 0
s_cmp_eq_u64 vcc, exec
s_cbranch_scc1 L_vcok_59
s_sleep 8
buffer_load_dword v58, v59, s[44:47], 0 offen sc1
s_add_u32 s67, s67, 1
s_cmp_lt_u32 s67, 131072
s_waitcnt vmcnt(0)
s_cbranch_scc1 L_vc_58
L_vcok_59:
s_mov_b64 exec, -1
L_vcskip_60:
s_barrier
s_cmp_lg_u32 s53, 3
s_cbranch_scc1 L_w3_61
s_lshr_b32 s63, s61, 3
s_add_u32 s95, s63, 128
s_lshl_b32 s95, s95, 7
s_lshr_b32 s63, s57, 2
s_add_u32 s101, s63, 160
s_lshl_b32 s101, s101, 7
s_mov_b32 s98, 1
s_atomic_add s98, s[16:17], s95 offset:0
L_w3_61:
s_lshl_b32 s88, s58, 7
s_mul_i32 s89, s58, 196608
s_add_u32 s58, s58, 1
s_cmp_eq_u32 s58, 10
s_cselect_b32 s58, 0, s58
s_add_u32 m0, s86, 40960
s_nop 0
buffer_load_dwordx4 v1, s[4:7], s88 offen lds
v_bfe_u32 v20, v0, 2, 2
v_mul_u32_u24 v20, 640, v20
v_lshrrev_b32 v22, 4, v0
v_lshl_add_u32 v20, v22, 5, v20
v_and_b32 v21, 3, v0
v_lshl_add_u32 v20, v21, 3, v20
v_add_u32 v20, s91, v20
s_add_u32 m0, s86, 41984
s_nop 0
buffer_load_dwordx4 v2, s[4:7], s88 offen lds
s_bfe_u32 s94, s62, 0x10002
s_mul_i32 s94, s94, 196
s_lshr_b32 s64, s62, 3
s_add_u32 s94, s94, s64
s_mul_i32 s94, s94, 5120
s_and_b32 s64, s62, 3
s_add_u32 m0, s86, 43008
s_add_u32 s88, s88, 20480
buffer_load_dwordx4 v1, s[4:7], s88 offen lds
s_lshl_b32 s64, s64, 8
s_add_u32 s94, s94, s64
s_add_u32 s94, s94, 6553600
v_and_b32 v21, 15, v0
v_lshlrev_b32 v21, 4, v21
v_add_u32 v23, 0, v22
s_add_u32 m0, s86, 44032
s_nop 0
buffer_load_dwordx4 v2, s[4:7], s88 offen lds
v_mul_u32_u24 v150, 13, v23
v_lshrrev_b32 v150, 6, v150
v_mul_u32_u24 v150, 245760, v150
v_lshl_add_u32 v150, v23, 10, v150
v_add_u32 v150, v150, v21
v_add_u32 v23, 4, v22
s_add_u32 m0, s87, 40960
s_nop 0
buffer_load_dwordx4 v5, s[8:11], s89 offen lds
v_mul_u32_u24 v151, 13, v23
v_lshrrev_b32 v151, 6, v151
v_mul_u32_u24 v151, 245760, v151
v_lshl_add_u32 v151, v23, 10, v151
v_add_u32 v151, v151, v21
v_add_u32 v23, 8, v22
s_add_u32 m0, s87, 41984
s_nop 0
buffer_load_dwordx4 v6, s[8:11], s89 offen lds
v_mul_u32_u24 v152, 13, v23
v_lshrrev_b32 v152, 6, v152
v_mul_u32_u24 v152, 245760, v152
v_lshl_add_u32 v152, v23, 10, v152
v_add_u32 v152, v152, v21
v_add_u32 v23, 12, v22
v_mul_u32_u24 v153, 13, v23
s_add_u32 m0, s87, 43008
s_nop 0
buffer_load_dwordx4 v7, s[8:11], s89 offen lds
v_lshrrev_b32 v153, 6, v153
v_mul_u32_u24 v153, 245760, v153
v_lshl_add_u32 v153, v23, 10, v153
v_add_u32 v153, v153, v21
v_add_u32 v23, 16, v22
v_mul_u32_u24 v154, 13, v23
s_add_u32 m0, s87, 44032
s_nop 0
buffer_load_dwordx4 v5, s[12:15], s89 offen lds
v_lshrrev_b32 v154, 6, v154
v_mul_u32_u24 v154, 245760, v154
v_lshl_add_u32 v154, v23, 10, v154
v_add_u32 v154, v154, v21
ds_read_b64_tr_b16 v[96:97], v20 offset:0
s_add_u32 m0, s87, 45056
s_nop 0
buffer_load_dwordx4 v6, s[12:15], s89 offen lds
ds_read_b64_tr_b16 v[98:99], v20 offset:2560
ds_read_b64_tr_b16 v[100:101], v20 offset:128
ds_read_b64_tr_b16 v[102:103], v20 offset:2688
ds_read_b64_tr_b16 v[104:105], v20 offset:256
ds_read_b64_tr_b16 v[106:107], v20 offset:2816
ds_read_b64_tr_b16 v[108:109], v20 offset:384
s_add_u32 m0, s87, 46080
s_nop 0
buffer_load_dwordx4 v7, s[12:15], s89 offen lds
ds_read_b64_tr_b16 v[110:111], v20 offset:2944
ds_read_b64_tr_b16 v[112:113], v20 offset:512
ds_read_b64_tr_b16 v[114:115], v20 offset:3072
s_waitcnt lgkmcnt(0)
buffer_store_dwordx4 v[96:99], v150, s[16:19], s94 offen sc1
buffer_store_dwordx4 v[100:103], v151, s[16:19], s94 offen sc1
s_waitcnt vmcnt(12)
s_barrier
s_lshl_b32 s88, s58, 7
s_mul_i32 s89, s58, 196608
s_add_u32 s58, s58, 1
s_cmp_eq_u32 s58, 10
s_cselect_b32 s58, 0, s58
s_add_u32 m0, s86, 81920
s_nop 0
buffer_load_dwordx4 v1, s[4:7], s88 offen lds
buffer_store_dwordx4 v[104:107], v152, s[16:19], s94 offen sc1
s_add_u32 m0, s86, 82944
s_nop 0
buffer_load_dwordx4 v2, s[4:7], s88 offen lds
s_add_u32 m0, s86, 83968
s_add_u32 s88, s88, 20480
buffer_load_dwordx4 v1, s[4:7], s88 offen lds
s_add_u32 m0, s86, 84992
s_nop 0
buffer_load_dwordx4 v2, s[4:7], s88 offen lds
buffer_store_dwordx4 v[108:111], v153, s[16:19], s94 offen sc1
s_add_u32 m0, s87, 81920
s_nop 0
buffer_load_dwordx4 v5, s[8:11], s89 offen lds
s_add_u32 m0, s87, 82944
s_nop 0
buffer_load_dwordx4 v6, s[8:11], s89 offen lds
s_add_u32 m0, s87, 83968
s_nop 0
buffer_load_dwordx4 v7, s[8:11], s89 offen lds
buffer_store_dwordx4 v[112:115], v154, s[16:19], s94 offen sc1
s_add_u32 m0, s87, 84992
s_nop 0
buffer_load_dwordx4 v5, s[12:15], s89 offen lds
s_add_u32 m0, s87, 86016
s_nop 0
buffer_load_dwordx4 v6, s[12:15], s89 offen lds
s_add_u32 m0, s87, 87040
s_nop 0
buffer_load_dwordx4 v7, s[12:15], s89 offen lds
s_waitcnt vmcnt(15)
s_barrier
s_lshl_b32 s88, s58, 7
s_mul_i32 s89, s58, 196608
s_add_u32 s58, s58, 1
s_cmp_eq_u32 s58, 10
s_cselect_b32 s58, 0, s58
s_add_u32 m0, s86, 0
s_nop 0
buffer_load_dwordx4 v1, s[4:7], s88 offen lds
s_mul_i32 s93, s59, 81920
s_mul_i32 s65, s60, 160
s_add_u32 s93, s93, s65
s_add_u32 m0, s86, 1024
s_nop 0
buffer_load_dwordx4 v2, s[4:7], s88 offen lds
s_cmp_lg_u32 s53, 3
s_cbranch_scc1 L_xt_47
v_add_u32 v20, 0, v0
v_mul_u32_u24 v21, 6554, v20
v_lshrrev_b32 v21, 16, v21
v_mul_u32_u24 v21, 1120, v21
v_lshl_add_u32 v21, v20, 4, v21
s_mov_b32 m0, 148992
s_nop 0
buffer_load_dwordx4 v21, s[4:7], s93 offen lds
L_xt_47:
s_add_u32 m0, s86, 2048
s_add_u32 s88, s88, 20480
buffer_load_dwordx4 v1, s[4:7], s88 offen lds
s_add_u32 m0, s86, 3072
s_nop 0
buffer_load_dwordx4 v2, s[4:7], s88 offen lds
s_add_u32 m0, s87, 0
s_nop 0
buffer_load_dwordx4 v5, s[8:11], s89 offen lds
s_add_u32 m0, s87, 1024
s_nop 0
buffer_load_dwordx4 v6, s[8:11], s89 offen lds
s_cmp_lg_u32 s53, 3
s_cbranch_scc1 L_xt_48
v_add_u32 v20, 64, v0
v_mul_u32_u24 v21, 6554, v20
v_lshrrev_b32 v21, 16, v21
v_mul_u32_u24 v21, 1120, v21
v_lshl_add_u32 v21, v20, 4, v21
s_mov_b32 m0, 150016
s_nop 0
buffer_load_dwordx4 v21, s[4:7], s93 offen lds
L_xt_48:
s_add_u32 m0, s87, 2048
s_nop 0
buffer_load_dwordx4 v7, s[8:11], s89 offen lds
s_add_u32 m0, s87, 3072
s_nop 0
buffer_load_dwordx4 v5, s[12:15], s89 offen lds
s_add_u32 m0, s87, 4096
s_nop 0
buffer_load_dwordx4 v6, s[12:15], s89 offen lds
s_add_u32 m0, s87, 5120
s_nop 0
buffer_load_dwordx4 v7, s[12:15], s89 offen lds
s_waitcnt vmcnt(10)
s_lshr_b32 s63, s62, 3
s_mul_i32 s63, s63, 43
s_lshr_b32 s63, s63, 9
s_and_b32 s64, s62, 4
s_lshl2_add_u32 s63, s64, s63
s_add_u32 s96, s63, 196
s_lshl_b32 s96, s96, 7
s_mov_b32 s100, 1
s_atomic_add s100, s[16:17], s96 offset:0
s_atomic_add s100, s[16:17], s96 offset:512
s_atomic_add s100, s[16:17], s96 offset:1024
s_atomic_add s100, s[16:17], s96 offset:1536
s_barrier
s_lshl_b32 s88, s58, 7
s_mul_i32 s89, s58, 196608
s_add_u32 s58, s58, 1
s_cmp_eq_u32 s58, 10
s_cselect_b32 s58, 0, s58
s_add_u32 m0, s86, 40960
s_nop 0
buffer_load_dwordx4 v1, s[4:7], s88 offen lds
s_cmp_lg_u32 s53, 3
s_cbranch_scc1 L_xt_49
v_add_u32 v20, 128, v0
v_mul_u32_u24 v21, 6554, v20
v_lshrrev_b32 v21, 16, v21
v_mul_u32_u24 v21, 1120, v21
v_lshl_add_u32 v21, v20, 4, v21
s_mov_b32 m0, 151040
s_nop 0
buffer_load_dwordx4 v21, s[4:7], s93 offen lds
L_xt_49:
s_add_u32 m0, s86, 41984
s_nop 0
buffer_load_dwordx4 v2, s[4:7], s88 offen lds
s_add_u32 m0, s86, 43008
s_add_u32 s88, s88, 20480
buffer_load_dwordx4 v1, s[4:7], s88 offen lds
s_add_u32 m0, s86, 44032
s_nop 0
buffer_load_dwordx4 v2, s[4:7], s88 offen lds
s_cmp_lg_u32 s53, 3
s_cbranch_scc1 L_xt_50
v_add_u32 v20, 192, v0
v_mul_u32_u24 v21, 6554, v20
v_lshrrev_b32 v21, 16, v21
v_mul_u32_u24 v21, 1120, v21
v_lshl_add_u32 v21, v20, 4, v21
s_mov_b32 m0, 152064
s_nop 0
buffer_load_dwordx4 v21, s[4:7], s93 offen lds
L_xt_50:
s_add_u32 m0, s87, 40960
s_nop 0
buffer_load_dwordx4 v5, s[8:11], s89 offen lds
s_add_u32 m0, s87, 41984
s_nop 0
buffer_load_dwordx4 v6, s[8:11], s89 offen lds
s_add_u32 m0, s87, 43008
s_nop 0
buffer_load_dwordx4 v7, s[8:11], s89 offen lds
s_cmp_lg_u32 s53, 3
s_cbranch_scc1 L_xt_51
v_add_u32 v20, 256, v0
v_mul_u32_u24 v21, 6554, v20
v_lshrrev_b32 v21, 16, v21
v_mul_u32_u24 v21, 1120, v21
v_lshl_add_u32 v21, v20, 4, v21
s_mov_b32 m0, 153088
s_nop 0
buffer_load_dwordx4 v21, s[4:7], s93 offen lds
L_xt_51:
s_add_u32 m0, s87, 44032
s_nop 0
buffer_load_dwordx4 v5, s[12:15], s89 offen lds
s_add_u32 m0, s87, 45056
s_nop 0
buffer_load_dwordx4 v6, s[12:15], s89 offen lds
s_add_u32 m0, s87, 46080
s_nop 0
buffer_load_dwordx4 v7, s[12:15], s89 offen lds
s_mul_i32 s92, s53, 8704
s_add_u32 s92, s92, 122880
v_lshlrev_b32 v18, 4, v0
s_waitcnt vmcnt(10)
s_barrier
s_lshl_b32 s88, s58, 7
s_mul_i32 s89, s58, 196608
s_add_u32 s58, s58, 1
s_cmp_eq_u32 s58, 10
s_cselect_b32 s58, 0, s58
s_add_u32 m0, s86, 81920
s_nop 0
buffer_load_dwordx4 v1, s[4:7], s88 offen lds
s_cmp_lg_u32 s53, 3
s_cbranch_scc1 L_xt_52
v_add_u32 v20, 320, v0
v_mul_u32_u24 v21, 6554, v20
v_lshrrev_b32 v21, 16, v21
v_mul_u32_u24 v21, 1120, v21
v_lshl_add_u32 v21, v20, 4, v21
s_mov_b32 m0, 154112
s_nop 0
buffer_load_dwordx4 v21, s[4:7], s93 offen lds
L_xt_52:
s_add_u32 m0, s86, 82944
s_nop 0
buffer_load_dwordx4 v2, s[4:7], s88 offen lds
s_add_u32 m0, s86, 83968
s_add_u32 s88, s88, 20480
buffer_load_dwordx4 v1, s[4:7], s88 offen lds
s_add_u32 m0, s86, 84992
s_nop 0
buffer_load_dwordx4 v2, s[4:7], s88 offen lds
s_add_u32 m0, s87, 81920
s_nop 0
buffer_load_dwordx4 v5, s[8:11], s89 offen lds
s_add_u32 m0, s87, 82944
s_nop 0
buffer_load_dwordx4 v6, s[8:11], s89 offen lds
s_cmp_lg_u32 s53, 3
s_cbranch_scc1 L_xt_53
v_add_u32 v20, 384, v0
v_mul_u32_u24 v21, 6554, v20
v_lshrrev_b32 v21, 16, v21
v_mul_u32_u24 v21, 1120, v21
v_lshl_add_u32 v21, v20, 4, v21
s_mov_b32 m0, 155136
s_nop 0
buffer_load_dwordx4 v21, s[4:7], s93 offen lds
L_xt_53:
s_add_u32 m0, s87, 83968
s_nop 0
buffer_load_dwordx4 v7, s[8:11], s89 offen lds
s_add_u32 m0, s87, 84992
s_nop 0
buffer_load_dwordx4 v5, s[12:15], s89 offen lds
s_add_u32 m0, s87, 86016
s_nop 0
buffer_load_dwordx4 v6, s[12:15], s89 offen lds
s_add_u32 m0, s87, 87040
s_nop 0
buffer_load_dwordx4 v7, s[12:15], s89 offen lds
s_waitcnt vmcnt(10)
s_barrier
s_cmp_lg_u32 s53, 3
s_cbranch_scc1 L_w3_62
s_waitcnt lgkmcnt(0)
s_add_u32 s95, s56, 128
s_lshl_b32 s95, s95, 7
s_lshr_b32 s63, s57, 2
s_add_u32 s96, s63, 160
s_lshl_b32 s96, s96, 7
s_add_u32 s97, s59, 128
s_lshl_b32 s97, s97, 7
s_load_dword s98, s[16:17], s95 offset:0 glc
s_load_dword s99, s[16:17], s95 offset:128 glc
s_load_dword s100, s[16:17], s96 offset:0 glc
s_load_dword s101, s[16:17], s96 offset:128 glc
s_load_dword s3, s[16:17], s97 offset:0 glc
L_w3_62:
s_lshl_b32 s88, s58, 7
s_mul_i32 s89, s58, 196608
s_add_u32 s58, s58, 1
s_cmp_eq_u32 s58, 10
s_cselect_b32 s58, 0, s58
s_add_u32 m0, s86, 0
s_nop 0
buffer_load_dwordx4 v1, s[4:7], s88 offen lds
s_cmp_lg_u32 s53, 3
s_cbranch_scc1 L_xt_54
v_add_u32 v20, 448, v0
v_mul_u32_u24 v21, 6554, v20
v_lshrrev_b32 v21, 16, v21
v_mul_u32_u24 v21, 1120, v21
v_lshl_add_u32 v21, v20, 4, v21
s_mov_b32 m0, 156160
s_nop 0
buffer_load_dwordx4 v21, s[4:7], s93 offen lds
L_xt_54:
s_add_u32 m0, s86, 1024
s_nop 0
buffer_load_dwordx4 v2, s[4:7], s88 offen lds
s_add_u32 m0, s86, 2048
s_add_u32 s88, s88, 20480
buffer_load_dwordx4 v1, s[4:7], s88 offen lds
s_add_u32 m0, s86, 3072
s_nop 0
buffer_load_dwordx4 v2, s[4:7], s88 offen lds
s_cmp_lg_u32 s53, 3
s_cbranch_scc1 L_xt_55
v_add_u32 v20, 512, v0
v_mul_u32_u24 v21, 6554, v20
v_lshrrev_b32 v21, 16, v21
v_mul_u32_u24 v21, 1120, v21
v_lshl_add_u32 v21, v20, 4, v21
s_mov_b32 m0, 157184
s_nop 0
buffer_load_dwordx4 v21, s[4:7], s93 offen lds
L_xt_55:
s_add_u32 m0, s87, 0
s_nop 0
buffer_load_dwordx4 v5, s[8:11], s89 offen lds
s_add_u32 m0, s87, 1024
s_nop 0
buffer_load_dwordx4 v6, s[8:11], s89 offen lds
s_add_u32 m0, s87, 2048
s_nop 0
buffer_load_dwordx4 v7, s[8:11], s89 offen lds
s_cmp_lg_u32 s53, 3
s_cbranch_scc1 L_xt_56
v_add_u32 v20, 576, v0
v_mul_u32_u24 v21, 6554, v20
v_lshrrev_b32 v21, 16, v21
v_mul_u32_u24 v21, 1120, v21
v_lshl_add_u32 v21, v20, 4, v21
s_mov_b32 m0, 158208
s_nop 0
buffer_load_dwordx4 v21, s[4:7], s93 offen lds
L_xt_56:
s_add_u32 m0, s87, 3072
s_nop 0
buffer_load_dwordx4 v5, s[12:15], s89 offen lds
s_add_u32 m0, s87, 4096
s_nop 0
buffer_load_dwordx4 v6, s[12:15], s89 offen lds
s_add_u32 m0, s87, 5120
s_nop 0
buffer_load_dwordx4 v7, s[12:15], s89 offen lds
s_waitcnt vmcnt(10)
s_cmp_lg_u32 s53, 3
s_cbranch_scc1 L_w3_66
s_waitcnt lgkmcnt(0)
s_mov_b32 s67, 0
L_poll_63:
s_cmp_ge_u32 s98, 8
s_cbranch_scc0 L_again_64
s_cmp_ge_u32 s99, 8
s_cbranch_scc0 L_again_64
s_cmp_ge_u32 s100, 10
s_cbranch_scc0 L_again_64
s_cmp_ge_u32 s101, 10
s_cbranch_scc0 L_again_64
s_cmp_ge_u32 s3, 8
s_cbranch_scc1 L_pollok_65
L_again_64:
s_sleep 2
s_load_dword s98, s[16:17], s95 offset:0 glc
s_load_dword s99, s[16:17], s95 offset:128 glc
s_load_dword s100, s[16:17], s96 offset:0 glc
s_load_dword s101, s[16:17], s96 offset:128 glc
s_load_dword s3, s[16:17], s97 offset:0 glc
s_add_u32 s67, s67, 1
s_cmp_lt_u32 s67, 131072
s_waitcnt lgkmcnt(0)
s_cbranch_scc1 L_poll_63
L_pollok_65:
L_w3_66:
s_barrier
s_cmp_lg_u32 s53, 3
s_cbranch_scc1 L_w3_67
s_waitcnt lgkmcnt(0)
s_lshl_b32 s63, s54, 2
s_add_u32 s95, s63, 196
s_lshl_b32 s95, s95, 7
s_load_dword s98, s[16:17], s95 offset:0 glc
s_load_dword s99, s[16:17], s95 offset:128 glc
s_load_dword s100, s[16:17], s95 offset:256 glc
s_load_dword s101, s[16:17], s95 offset:384 glc
L_w3_67:
v_min_u32 v14, 31, v0
v_lshlrev_b32 v14, 3, v14
s_mul_i32 s64, s53, 256
v_add_u32 v14, s64, v14
s_lshl_b32 s63, s56, 9
s_add_u32 s63, s63, 40960
v_min_u32 v15, 47, v0
s_mul_i32 s64, s53, 48
v_add_u32 v15, s64, v15
v_lshlrev_b32 v15, 2, v15
s_lshl_b32 s64, s57, 7
s_add_u32 s64, s64, 57344
buffer_load_dwordx2 v[24:25], v14, s[16:19], s63 offen sc1
buffer_load_dword v26, v15, s[16:19], s64 offen sc1
s_add_u32 s64, s64, 12288
buffer_load_dword v27, v15, s[16:19], s64 offen sc1
s_add_u32 s64, s64, 12288
buffer_load_dword v28, v15, s[16:19], s64 offen sc1
s_add_u32 s64, s64, 12288
buffer_load_dword v29, v15, s[16:19], s64 offen sc1
s_add_u32 s64, s64, 12288
buffer_load_dword v30, v15, s[16:19], s64 offen sc1
s_add_u32 s64, s64, 12288
buffer_load_dword v31, v15, s[16:19], s64 offen sc1
s_add_u32 s64, s64, 12288
buffer_load_dword v32, v15, s[16:19], s64 offen sc1
s_add_u32 s64, s64, 12288
buffer_load_dword v33, v15, s[16:19], s64 offen sc1
s_add_u32 s64, s64, 12288
buffer_load_dword v34, v15, s[16:19], s64 offen sc1
s_add_u32 s64, s64, 12288
buffer_load_dword v35, v15, s[16:19], s64 offen sc1
s_waitcnt vmcnt(11)
s_cmp_lg_u32 s53, 3
s_cbranch_scc1 L_w3_71
s_waitcnt lgkmcnt(0)
s_mov_b32 s67, 0
L_poll_68:
s_cmp_ge_u32 s98, 48
s_cbranch_scc0 L_again_69
s_cmp_ge_u32 s99, 48
s_cbranch_scc0 L_again_69
s_cmp_ge_u32 s100, 48
s_cbranch_scc0 L_again_69
s_cmp_ge_u32 s101, 48
s_cbranch_scc1 L_pollok_70
L_again_69:
s_sleep 4
s_load_dword s98, s[16:17], s95 offset:0 glc
s_load_dword s99, s[16:17], s95 offset:128 glc
s_load_dword s100, s[16:17], s95 offset:256 glc
s_load_dword s101, s[16:17], s95 offset:384 glc
s_add_u32 s67, s67, 1
s_cmp_lt_u32 s67, 131072
s_waitcnt lgkmcnt(0)
s_cbranch_scc1 L_poll_68
L_pollok_70:
L_w3_71:
s_mul_i32 s100, s54, 3
s_lshr_b32 s100, s100, 1
s_mul_i32 s63, s53, 12
s_mul_i32 s64, s60, 49
s_add_u32 s64, s64, s63
s_mul_i32 s101, s64, 5120
s_add_u32 s101, s101, 6553600
s_mul_i32 s63, s53, 61440
s_sub_u32 s101, s101, s63
s_barrier
s_branch L_wpost
L_roleA_b:
s_and_b32 s63, s54, 1
s_lshr_b32 s64, s54, 1
s_lshl2_add_u32 s66, s63, s64
s_lshl_b32 s61, s66, 5
s_add_u32 s61, s61, s55
s_bfe_u32 s64, s54, 0x10001
s_lshl1_add_u32 s63, s63, s64
s_and_b32 s64, s55, 7
s_lshl3_add_u32 s59, s63, s64
s_lshr_b32 s63, s54, 2
s_lshr_b32 s64, s55, 3
s_lshl2_add_u32 s60, s63, s64
s_mov_b32 s6, 2621440
s_mov_b32 s7, 0x20000
s_mov_b32 s18, 20971520
s_mov_b32 s19, 0x20000
s_mov_b32 s46, 256
s_mov_b32 s47, 0x20000
s_waitcnt lgkmcnt(0)
s_setprio 2
v_lshrrev_b32 v156, 5, v0
s_lshl2_add_u32 s63, s61, s53
s_lshl_b32 s63, s63, 1
v_add_u32 v156, s63, v156
v_lshlrev_b32 v19, 3, v156
v_mul_u32_u24 v156, 1280, v156
v_and_b32 v157, 31, v0
v_lshl_add_u32 v156, v157, 3, v156
buffer_load_dwordx2 v[24:25], v156, s[4:7], 0 offen offset:0
buffer_load_dwordx2 v[26:27], v156, s[4:7], 0 offen offset:256
buffer_load_dwordx2 v[28:29], v156, s[4:7], 0 offen offset:512
buffer_load_dwordx2 v[30:31], v156, s[4:7], 0 offen offset:768
buffer_load_dwordx2 v[32:33], v156, s[4:7], 0 offen offset:1024
s_and_b32 s86, s53, 1
s_lshr_b32 s87, s53, 1
v_and_b32 v112, 15, v0
v_lshrrev_b32 v113, 4, v0
v_bfe_u32 v114, v0, 1, 3
v_xor_b32 v114, v114, v113
s_mul_i32 s63, s86, 8192
v_lshl_add_u32 v116, v112, 7, s63
v_lshl_add_u32 v1, v114, 4, v116
v_xor_b32 v2, 64, v1
v_lshlrev_b32 v112, 4, v112
v_lshrrev_b32 v114, 5, v0
v_lshl_add_u32 v112, v114, 8, v112
v_and_b32 v113, 1, v113
v_lshl_add_u32 v6, v113, 9, v112
v_lshl_add_u32 v7, v113, 10, v112
v_lshrrev_b32 v113, 5, v0
v_mul_u32_u24 v115, 6144, v113
v_bfe_u32 v112, v0, 4, 1
v_mul_u32_u24 v113, 1536, v112
v_add_u32 v115, v115, v113
v_bfe_u32 v113, v0, 2, 2
v_lshl_add_u32 v115, v113, 6, v115
v_and_b32 v113, 3, v0
v_lshl_add_u32 v115, v113, 3, v115
v_lshlrev_b32 v112, 5, v112
s_lshl2_add_u32 s64, s87, 0
s_lshr_b32 s65, s64, 1
s_and_b32 s64, s64, 1
s_lshl_b32 s64, s64, 5
v_xor_b32 v116, s64, v112
s_lshl_b32 s65, s65, 8
s_add_u32 s65, s65, 16384
v_add3_u32 v3, v115, v116, s65
s_lshl2_add_u32 s64, s87, 1
s_lshr_b32 s65, s64, 1
s_and_b32 s64, s64, 1
s_lshl_b32 s64, s64, 5
v_xor_b32 v116, s64, v112
s_lshl_b32 s65, s65, 8
s_add_u32 s65, s65, 16384
v_add3_u32 v4, v115, v116, s65
s_add_u32 s64, s87, 2
s_lshr_b32 s65, s64, 1
s_and_b32 s64, s64, 1
s_lshl_b32 s64, s64, 5
v_xor_b32 v116, s64, v112
s_lshl_b32 s65, s65, 8
s_add_u32 s65, s65, 16384
v_add3_u32 v5, v115, v116, s65
s_add_u32 s64, s56, s86
s_mul_i32 s64, s64, 49
s_lshr_b32 s65, s57, 1
s_add_u32 s64, s64, s65
s_lshl_b32 s64, s64, 12
s_add_u32 s64, s64, 8585216
s_lshl_b32 s65, s87, 13
s_add_u32 s88, s64, s65
s_lshl_b32 s65, s87, 9
s_add_u32 s64, s64, s65
s_add_u32 s89, s64, 4096
s_waitcnt vmcnt(0)
v_lshlrev_b32 v34, 16, v24
v_and_b32 v35, 0xffff0000, v24
v_lshlrev_b32 v36, 16, v25
v_and_b32 v37, 0xffff0000, v25
v_lshlrev_b32 v38, 16, v26
v_and_b32 v39, 0xffff0000, v26
v_lshlrev_b32 v40, 16, v27
v_and_b32 v41, 0xffff0000, v27
v_lshlrev_b32 v42, 16, v28
v_and_b32 v43, 0xffff0000, v28
v_lshlrev_b32 v44, 16, v29
v_and_b32 v45, 0xffff0000, v29
v_lshlrev_b32 v46, 16, v30
v_and_b32 v47, 0xffff0000, v30
v_lshlrev_b32 v48, 16, v31
v_and_b32 v49, 0xffff0000, v31
v_lshlrev_b32 v50, 16, v32
v_and_b32 v51, 0xffff0000, v32
v_lshlrev_b32 v52, 16, v33
v_and_b32 v53, 0xffff0000, v33
v_add_f32 v20, v34, v35
v_add_f32 v21, v36, v37
v_add_f32 v20, v20, v38
v_add_f32 v21, v21, v39
v_add_f32 v20, v20, v40
v_add_f32 v21, v21, v41
v_add_f32 v20, v20, v42
v_add_f32 v21, v21, v43
v_add_f32 v20, v20, v44
v_add_f32 v21, v21, v45
v_add_f32 v20, v20, v46
v_add_f32 v21, v21, v47
v_add_f32 v20, v20, v48
v_add_f32 v21, v21, v49
v_add_f32 v20, v20, v50
v_add_f32 v21, v21, v51
v_add_f32 v20, v20, v52
v_add_f32 v21, v21, v53
v_add_f32 v20, v20, v21
s_nop 1
v_add_f32_dpp v20, v20, v20 row_ror:8 row_mask:0xf bank_mask:0xf
s_nop 1
v_add_f32_dpp v20, v20, v20 row_ror:4 row_mask:0xf bank_mask:0xf
s_nop 1
v_add_f32_dpp v20, v20, v20 row_ror:2 row_mask:0xf bank_mask:0xf
s_nop 1
v_add_f32_dpp v20, v20, v20 row_ror:1 row_mask:0xf bank_mask:0xf
v_mov_b32 v21, v20
s_nop 1
v_permlane16_swap_b32 v20, v21
v_add_f32 v20, v20, v21
v_mul_f32 v20, 0x3acccccd, v20
v_sub_f32 v34, v34, v20
v_sub_f32 v35, v35, v20
v_sub_f32 v36, v36, v20
v_sub_f32 v37, v37, v20
v_sub_f32 v38, v38, v20
v_sub_f32 v39, v39, v20
v_sub_f32 v40, v40, v20
v_sub_f32 v41, v41, v20
v_sub_f32 v42, v42, v20
v_sub_f32 v43, v43, v20
v_sub_f32 v44, v44, v20
v_sub_f32 v45, v45, v20
v_sub_f32 v46, v46, v20
v_sub_f32 v47, v47, v20
v_sub_f32 v48, v48, v20
v_sub_f32 v49, v49, v20
v_sub_f32 v50, v50, v20
v_sub_f32 v51, v51, v20
v_sub_f32 v52, v52, v20
v_sub_f32 v53, v53, v20
v_mul_f32 v21, v34, v34
v_mul_f32 v22, v35, v35
v_fmac_f32 v21, v36, v36
v_fmac_f32 v22, v37, v37
v_fmac_f32 v21, v38, v38
v_fmac_f32 v22, v39, v39
v_fmac_f32 v21, v40, v40
v_fmac_f32 v22, v41, v41
v_fmac_f32 v21, v42, v42
v_fmac_f32 v22, v43, v43
v_fmac_f32 v21, v44, v44
v_fmac_f32 v22, v45, v45
v_fmac_f32 v21, v46, v46
v_fmac_f32 v22, v47, v47
v_fmac_f32 v21, v48, v48
v_fmac_f32 v22, v49, v49
v_fmac_f32 v21, v50, v50
v_fmac_f32 v22, v51, v51
v_fmac_f32 v21, v52, v52
v_fmac_f32 v22, v53, v53
v_add_f32 v21, v21, v22
s_nop 1
v_add_f32_dpp v21, v21, v21 row_ror:8 row_mask:0xf bank_mask:0xf
s_nop 1
v_add_f32_dpp v21, v21, v21 row_ror:4 row_mask:0xf bank_mask:0xf
s_nop 1
v_add_f32_dpp v21, v21, v21 row_ror:2 row_mask:0xf bank_mask:0xf
s_nop 1
v_add_f32_dpp v21, v21, v21 row_ror:1 row_mask:0xf bank_mask:0xf
v_mov_b32 v22, v21
s_nop 1
v_permlane16_swap_b32 v21, v22
v_add_f32 v21, v21, v22
v_mul_f32 v21, 0x3acccccd, v21
v_cvt_pk_bf16_f32 v22, v20, v21
v_lshlrev_b32 v20, 16, v22
v_and_b32 v21, 0xffff0000, v22
v_add_f32 v21, 0x3727c5ac, v21
v_cvt_pk_bf16_f32 v21, v21, v21
v_and_b32 v21, 0xffff0000, v21
v_sqrt_f32 v21, v21
s_nop 0
v_cvt_pk_bf16_f32 v21, v21, v21
v_and_b32 v21, 0xffff0000, v21
s_mov_b32 s63, 40960
s_mov_b32 exec_lo, 1
s_mov_b32 exec_hi, 1
buffer_store_dwordx2 v[20:21], v19, s[16:19], s63 offen sc1
s_mov_b64 exec, -1
s_setprio 0
s_barrier
ds_read_b64_tr_b16 v[96:97], v3 offset:0
ds_read_b64_tr_b16 v[98:99], v3 offset:768
ds_read_b128 v[80:83], v1 offset:0
ds_read_b128 v[84:87], v1 offset:2048
ds_read_b128 v[88:91], v1 offset:4096
ds_read_b128 v[92:95], v1 offset:6144
ds_read_b64_tr_b16 v[100:101], v3 offset:3072
ds_read_b64_tr_b16 v[102:103], v3 offset:3840
ds_read_b64_tr_b16 v[104:105], v4 offset:0
ds_read_b64_tr_b16 v[106:107], v4 offset:768
ds_read_b64_tr_b16 v[108:109], v4 offset:3072
ds_read_b64_tr_b16 v[110:111], v4 offset:3840
ds_read_b64_tr_b16 v[112:113], v5 offset:0
ds_read_b64_tr_b16 v[114:115], v5 offset:768
ds_read_b64_tr_b16 v[116:117], v5 offset:3072
ds_read_b64_tr_b16 v[118:119], v5 offset:3840
s_waitcnt lgkmcnt(0)
v_mfma_f32_16x16x32_bf16 v[160:163], v[96:99], v[80:83], 0
ds_read_b64_tr_b16 v[136:137], v3 offset:12288
v_mfma_f32_16x16x32_bf16 v[184:187], v[96:99], v[84:87], 0
ds_read_b64_tr_b16 v[138:139], v3 offset:13056
v_mfma_f32_16x16x32_bf16 v[208:211], v[96:99], v[88:91], 0
ds_read_b128 v[120:123], v2 offset:0
v_mfma_f32_16x16x32_bf16 v[232:235], v[96:99], v[92:95], 0
ds_read_b128 v[124:127], v2 offset:2048
v_mfma_f32_16x16x32_bf16 v[236:239], v[100:103], v[92:95], 0
ds_read_b128 v[128:131], v2 offset:4096
v_mfma_f32_16x16x32_bf16 v[212:215], v[100:103], v[88:91], 0
ds_read_b128 v[132:135], v2 offset:6144
v_mfma_f32_16x16x32_bf16 v[188:191], v[100:103], v[84:87], 0
ds_read_b64_tr_b16 v[140:141], v3 offset:15360
v_mfma_f32_16x16x32_bf16 v[164:167], v[100:103], v[80:83], 0
ds_read_b64_tr_b16 v[142:143], v3 offset:16128
v_mfma_f32_16x16x32_bf16 v[168:171], v[104:107], v[80:83], 0
ds_read_b64_tr_b16 v[144:145], v4 offset:12288
v_mfma_f32_16x16x32_bf16 v[192:195], v[104:107], v[84:87], 0
ds_read_b64_tr_b16 v[146:147], v4 offset:13056
v_mfma_f32_16x16x32_bf16 v[216:219], v[104:107], v[88:91], 0
ds_read_b64_tr_b16 v[148:149], v4 offset:15360
v_mfma_f32_16x16x32_bf16 v[240:243], v[104:107], v[92:95], 0
ds_read_b64_tr_b16 v[150:151], v4 offset:16128
v_mfma_f32_16x16x32_bf16 v[244:247], v[108:111], v[92:95], 0
ds_read_b64_tr_b16 v[152:153], v5 offset:12288
v_mfma_f32_16x16x32_bf16 v[220:223], v[108:111], v[88:91], 0
ds_read_b64_tr_b16 v[154:155], v5 offset:13056
v_mfma_f32_16x16x32_bf16 v[196:199], v[108:111], v[84:87], 0
ds_read_b64_tr_b16 v[156:157], v5 offset:15360
v_mfma_f32_16x16x32_bf16 v[172:175], v[108:111], v[80:83], 0
ds_read_b64_tr_b16 v[158:159], v5 offset:16128
v_mfma_f32_16x16x32_bf16 v[176:179], v[112:115], v[80:83], 0
v_add_u32 v1, 40960, v1
v_mfma_f32_16x16x32_bf16 v[200:203], v[112:115], v[84:87], 0
v_add_u32 v2, 40960, v2
v_mfma_f32_16x16x32_bf16 v[224:227], v[112:115], v[88:91], 0
v_add_u32 v3, 40960, v3
v_mfma_f32_16x16x32_bf16 v[248:251], v[112:115], v[92:95], 0
v_add_u32 v4, 40960, v4
v_mfma_f32_16x16x32_bf16 v[252:255], v[116:119], v[92:95], 0
v_add_u32 v5, 40960, v5
v_mfma_f32_16x16x32_bf16 v[228:231], v[116:119], v[88:91], 0
v_mfma_f32_16x16x32_bf16 v[204:207], v[116:119], v[84:87], 0
v_mfma_f32_16x16x32_bf16 v[180:183], v[116:119], v[80:83], 0
s_waitcnt lgkmcnt(0)
s_waitcnt vmcnt(0)
s_barrier
v_mfma_f32_16x16x32_bf16 v[160:163], v[136:139], v[120:123], v[160:163]
ds_read_b64_tr_b16 v[96:97], v3 offset:0
v_mfma_f32_16x16x32_bf16 v[184:187], v[136:139], v[124:127], v[184:187]
ds_read_b64_tr_b16 v[98:99], v3 offset:768
v_mfma_f32_16x16x32_bf16 v[208:211], v[136:139], v[128:131], v[208:211]
ds_read_b128 v[80:83], v1 offset:0
v_mfma_f32_16x16x32_bf16 v[232:235], v[136:139], v[132:135], v[232:235]
ds_read_b128 v[84:87], v1 offset:2048
v_mfma_f32_16x16x32_bf16 v[236:239], v[140:143], v[132:135], v[236:239]
ds_read_b128 v[88:91], v1 offset:4096
v_mfma_f32_16x16x32_bf16 v[212:215], v[140:143], v[128:131], v[212:215]
ds_read_b128 v[92:95], v1 offset:6144
v_mfma_f32_16x16x32_bf16 v[188:191], v[140:143], v[124:127], v[188:191]
ds_read_b64_tr_b16 v[100:101], v3 offset:3072
v_mfma_f32_16x16x32_bf16 v[164:167], v[140:143], v[120:123], v[164:167]
ds_read_b64_tr_b16 v[102:103], v3 offset:3840
v_mfma_f32_16x16x32_bf16 v[168:171], v[144:147], v[120:123], v[168:171]
ds_read_b64_tr_b16 v[104:105], v4 offset:0
v_mfma_f32_16x16x32_bf16 v[192:195], v[144:147], v[124:127], v[192:195]
ds_read_b64_tr_b16 v[106:107], v4 offset:768
v_mfma_f32_16x16x32_bf16 v[216:219], v[144:147], v[128:131], v[216:219]
ds_read_b64_tr_b16 v[108:109], v4 offset:3072
v_mfma_f32_16x16x32_bf16 v[240:243], v[144:147], v[132:135], v[240:243]
ds_read_b64_tr_b16 v[110:111], v4 offset:3840
v_mfma_f32_16x16x32_bf16 v[244:247], v[148:151], v[132:135], v[244:247]
ds_read_b64_tr_b16 v[112:113], v5 offset:0
v_mfma_f32_16x16x32_bf16 v[220:223], v[148:151], v[128:131], v[220:223]
ds_read_b64_tr_b16 v[114:115], v5 offset:768
v_mfma_f32_16x16x32_bf16 v[196:199], v[148:151], v[124:127], v[196:199]
ds_read_b64_tr_b16 v[116:117], v5 offset:3072
v_mfma_f32_16x16x32_bf16 v[172:175], v[148:151], v[120:123], v[172:175]
ds_read_b64_tr_b16 v[118:119], v5 offset:3840
v_mfma_f32_16x16x32_bf16 v[176:179], v[152:155], v[120:123], v[176:179]
v_mfma_f32_16x16x32_bf16 v[200:203], v[152:155], v[124:127], v[200:203]
v_mfma_f32_16x16x32_bf16 v[224:227], v[152:155], v[128:131], v[224:227]
v_mfma_f32_16x16x32_bf16 v[248:251], v[152:155], v[132:135], v[248:251]
v_mfma_f32_16x16x32_bf16 v[252:255], v[156:159], v[132:135], v[252:255]
v_mfma_f32_16x16x32_bf16 v[228:231], v[156:159], v[128:131], v[228:231]
v_mfma_f32_16x16x32_bf16 v[204:207], v[156:159], v[124:127], v[204:207]
v_mfma_f32_16x16x32_bf16 v[180:183], v[156:159], v[120:123], v[180:183]
s_waitcnt lgkmcnt(0)
v_mfma_f32_16x16x32_bf16 v[160:163], v[96:99], v[80:83], v[160:163]
ds_read_b64_tr_b16 v[136:137], v3 offset:12288
v_mfma_f32_16x16x32_bf16 v[184:187], v[96:99], v[84:87], v[184:187]
ds_read_b64_tr_b16 v[138:139], v3 offset:13056
v_mfma_f32_16x16x32_bf16 v[208:211], v[96:99], v[88:91], v[208:211]
ds_read_b128 v[120:123], v2 offset:0
v_mfma_f32_16x16x32_bf16 v[232:235], v[96:99], v[92:95], v[232:235]
ds_read_b128 v[124:127], v2 offset:2048
v_mfma_f32_16x16x32_bf16 v[236:239], v[100:103], v[92:95], v[236:239]
ds_read_b128 v[128:131], v2 offset:4096
v_mfma_f32_16x16x32_bf16 v[212:215], v[100:103], v[88:91], v[212:215]
ds_read_b128 v[132:135], v2 offset:6144
v_mfma_f32_16x16x32_bf16 v[188:191], v[100:103], v[84:87], v[188:191]
ds_read_b64_tr_b16 v[140:141], v3 offset:15360
v_mfma_f32_16x16x32_bf16 v[164:167], v[100:103], v[80:83], v[164:167]
ds_read_b64_tr_b16 v[142:143], v3 offset:16128
v_mfma_f32_16x16x32_bf16 v[168:171], v[104:107], v[80:83], v[168:171]
ds_read_b64_tr_b16 v[144:145], v4 offset:12288
v_mfma_f32_16x16x32_bf16 v[192:195], v[104:107], v[84:87], v[192:195]
ds_read_b64_tr_b16 v[146:147], v4 offset:13056
v_mfma_f32_16x16x32_bf16 v[216:219], v[104:107], v[88:91], v[216:219]
ds_read_b64_tr_b16 v[148:149], v4 offset:15360
v_mfma_f32_16x16x32_bf16 v[240:243], v[104:107], v[92:95], v[240:243]
ds_read_b64_tr_b16 v[150:151], v4 offset:16128
v_mfma_f32_16x16x32_bf16 v[244:247], v[108:111], v[92:95], v[244:247]
ds_read_b64_tr_b16 v[152:153], v5 offset:12288
v_mfma_f32_16x16x32_bf16 v[220:223], v[108:111], v[88:91], v[220:223]
ds_read_b64_tr_b16 v[154:155], v5 offset:13056
v_mfma_f32_16x16x32_bf16 v[196:199], v[108:111], v[84:87], v[196:199]
ds_read_b64_tr_b16 v[156:157], v5 offset:15360
v_mfma_f32_16x16x32_bf16 v[172:175], v[108:111], v[80:83], v[172:175]
ds_read_b64_tr_b16 v[158:159], v5 offset:16128
v_mfma_f32_16x16x32_bf16 v[176:179], v[112:115], v[80:83], v[176:179]
v_add_u32 v1, 40960, v1
v_mfma_f32_16x16x32_bf16 v[200:203], v[112:115], v[84:87], v[200:203]
v_add_u32 v2, 40960, v2
v_mfma_f32_16x16x32_bf16 v[224:227], v[112:115], v[88:91], v[224:227]
v_add_u32 v3, 40960, v3
v_mfma_f32_16x16x32_bf16 v[248:251], v[112:115], v[92:95], v[248:251]
v_add_u32 v4, 40960, v4
v_mfma_f32_16x16x32_bf16 v[252:255], v[116:119], v[92:95], v[252:255]
v_add_u32 v5, 40960, v5
v_mfma_f32_16x16x32_bf16 v[228:231], v[116:119], v[88:91], v[228:231]
v_mfma_f32_16x16x32_bf16 v[204:207], v[116:119], v[84:87], v[204:207]
v_mfma_f32_16x16x32_bf16 v[180:183], v[116:119], v[80:83], v[180:183]
s_waitcnt lgkmcnt(0)
s_barrier
v_mfma_f32_16x16x32_bf16 v[160:163], v[136:139], v[120:123], v[160:163]
ds_read_b64_tr_b16 v[96:97], v3 offset:0
v_mfma_f32_16x16x32_bf16 v[184:187], v[136:139], v[124:127], v[184:187]
ds_read_b64_tr_b16 v[98:99], v3 offset:768
v_mfma_f32_16x16x32_bf16 v[208:211], v[136:139], v[128:131], v[208:211]
ds_read_b128 v[80:83], v1 offset:0
v_mfma_f32_16x16x32_bf16 v[232:235], v[136:139], v[132:135], v[232:235]
ds_read_b128 v[84:87], v1 offset:2048
v_mfma_f32_16x16x32_bf16 v[236:239], v[140:143], v[132:135], v[236:239]
ds_read_b128 v[88:91], v1 offset:4096
v_mfma_f32_16x16x32_bf16 v[212:215], v[140:143], v[128:131], v[212:215]
ds_read_b128 v[92:95], v1 offset:6144
v_mfma_f32_16x16x32_bf16 v[188:191], v[140:143], v[124:127], v[188:191]
ds_read_b64_tr_b16 v[100:101], v3 offset:3072
v_mfma_f32_16x16x32_bf16 v[164:167], v[140:143], v[120:123], v[164:167]
ds_read_b64_tr_b16 v[102:103], v3 offset:3840
v_mfma_f32_16x16x32_bf16 v[168:171], v[144:147], v[120:123], v[168:171]
ds_read_b64_tr_b16 v[104:105], v4 offset:0
v_mfma_f32_16x16x32_bf16 v[192:195], v[144:147], v[124:127], v[192:195]
ds_read_b64_tr_b16 v[106:107], v4 offset:768
v_mfma_f32_16x16x32_bf16 v[216:219], v[144:147], v[128:131], v[216:219]
ds_read_b64_tr_b16 v[108:109], v4 offset:3072
v_mfma_f32_16x16x32_bf16 v[240:243], v[144:147], v[132:135], v[240:243]
ds_read_b64_tr_b16 v[110:111], v4 offset:3840
v_mfma_f32_16x16x32_bf16 v[244:247], v[148:151], v[132:135], v[244:247]
ds_read_b64_tr_b16 v[112:113], v5 offset:0
v_mfma_f32_16x16x32_bf16 v[220:223], v[148:151], v[128:131], v[220:223]
ds_read_b64_tr_b16 v[114:115], v5 offset:768
v_mfma_f32_16x16x32_bf16 v[196:199], v[148:151], v[124:127], v[196:199]
ds_read_b64_tr_b16 v[116:117], v5 offset:3072
v_mfma_f32_16x16x32_bf16 v[172:175], v[148:151], v[120:123], v[172:175]
ds_read_b64_tr_b16 v[118:119], v5 offset:3840
v_mfma_f32_16x16x32_bf16 v[176:179], v[152:155], v[120:123], v[176:179]
v_mfma_f32_16x16x32_bf16 v[200:203], v[152:155], v[124:127], v[200:203]
v_mfma_f32_16x16x32_bf16 v[224:227], v[152:155], v[128:131], v[224:227]
v_mfma_f32_16x16x32_bf16 v[248:251], v[152:155], v[132:135], v[248:251]
v_mfma_f32_16x16x32_bf16 v[252:255], v[156:159], v[132:135], v[252:255]
v_mfma_f32_16x16x32_bf16 v[228:231], v[156:159], v[128:131], v[228:231]
v_mfma_f32_16x16x32_bf16 v[204:207], v[156:159], v[124:127], v[204:207]
v_mfma_f32_16x16x32_bf16 v[180:183], v[156:159], v[120:123], v[180:183]
s_waitcnt lgkmcnt(0)
v_mfma_f32_16x16x32_bf16 v[160:163], v[96:99], v[80:83], v[160:163]
ds_read_b64_tr_b16 v[136:137], v3 offset:12288
v_mfma_f32_16x16x32_bf16 v[184:187], v[96:99], v[84:87], v[184:187]
ds_read_b64_tr_b16 v[138:139], v3 offset:13056
v_mfma_f32_16x16x32_bf16 v[208:211], v[96:99], v[88:91], v[208:211]
ds_read_b128 v[120:123], v2 offset:0
v_mfma_f32_16x16x32_bf16 v[232:235], v[96:99], v[92:95], v[232:235]
ds_read_b128 v[124:127], v2 offset:2048
v_mfma_f32_16x16x32_bf16 v[236:239], v[100:103], v[92:95], v[236:239]
ds_read_b128 v[128:131], v2 offset:4096
v_mfma_f32_16x16x32_bf16 v[212:215], v[100:103], v[88:91], v[212:215]
ds_read_b128 v[132:135], v2 offset:6144
v_mfma_f32_16x16x32_bf16 v[188:191], v[100:103], v[84:87], v[188:191]
ds_read_b64_tr_b16 v[140:141], v3 offset:15360
v_mfma_f32_16x16x32_bf16 v[164:167], v[100:103], v[80:83], v[164:167]
ds_read_b64_tr_b16 v[142:143], v3 offset:16128
v_mfma_f32_16x16x32_bf16 v[168:171], v[104:107], v[80:83], v[168:171]
ds_read_b64_tr_b16 v[144:145], v4 offset:12288
v_mfma_f32_16x16x32_bf16 v[192:195], v[104:107], v[84:87], v[192:195]
ds_read_b64_tr_b16 v[146:147], v4 offset:13056
v_mfma_f32_16x16x32_bf16 v[216:219], v[104:107], v[88:91], v[216:219]
ds_read_b64_tr_b16 v[148:149], v4 offset:15360
v_mfma_f32_16x16x32_bf16 v[240:243], v[104:107], v[92:95], v[240:243]
ds_read_b64_tr_b16 v[150:151], v4 offset:16128
v_mfma_f32_16x16x32_bf16 v[244:247], v[108:111], v[92:95], v[244:247]
ds_read_b64_tr_b16 v[152:153], v5 offset:12288
v_mfma_f32_16x16x32_bf16 v[220:223], v[108:111], v[88:91], v[220:223]
ds_read_b64_tr_b16 v[154:155], v5 offset:13056
v_mfma_f32_16x16x32_bf16 v[196:199], v[108:111], v[84:87], v[196:199]
ds_read_b64_tr_b16 v[156:157], v5 offset:15360
v_mfma_f32_16x16x32_bf16 v[172:175], v[108:111], v[80:83], v[172:175]
ds_read_b64_tr_b16 v[158:159], v5 offset:16128
v_mfma_f32_16x16x32_bf16 v[176:179], v[112:115], v[80:83], v[176:179]
v_subrev_u32 v1, 81920, v1
v_mfma_f32_16x16x32_bf16 v[200:203], v[112:115], v[84:87], v[200:203]
v_subrev_u32 v2, 81920, v2
v_mfma_f32_16x16x32_bf16 v[224:227], v[112:115], v[88:91], v[224:227]
v_subrev_u32 v3, 81920, v3
v_mfma_f32_16x16x32_bf16 v[248:251], v[112:115], v[92:95], v[248:251]
v_subrev_u32 v4, 81920, v4
v_mfma_f32_16x16x32_bf16 v[252:255], v[116:119], v[92:95], v[252:255]
v_subrev_u32 v5, 81920, v5
v_mfma_f32_16x16x32_bf16 v[228:231], v[116:119], v[88:91], v[228:231]
v_mfma_f32_16x16x32_bf16 v[204:207], v[116:119], v[84:87], v[204:207]
v_mfma_f32_16x16x32_bf16 v[180:183], v[116:119], v[80:83], v[180:183]
s_waitcnt lgkmcnt(0)
s_barrier
v_mfma_f32_16x16x32_bf16 v[160:163], v[136:139], v[120:123], v[160:163]
ds_read_b64_tr_b16 v[96:97], v3 offset:0
v_mfma_f32_16x16x32_bf16 v[184:187], v[136:139], v[124:127], v[184:187]
ds_read_b64_tr_b16 v[98:99], v3 offset:768
v_mfma_f32_16x16x32_bf16 v[208:211], v[136:139], v[128:131], v[208:211]
ds_read_b128 v[80:83], v1 offset:0
v_mfma_f32_16x16x32_bf16 v[232:235], v[136:139], v[132:135], v[232:235]
ds_read_b128 v[84:87], v1 offset:2048
v_mfma_f32_16x16x32_bf16 v[236:239], v[140:143], v[132:135], v[236:239]
ds_read_b128 v[88:91], v1 offset:4096
v_mfma_f32_16x16x32_bf16 v[212:215], v[140:143], v[128:131], v[212:215]
ds_read_b128 v[92:95], v1 offset:6144
v_mfma_f32_16x16x32_bf16 v[188:191], v[140:143], v[124:127], v[188:191]
ds_read_b64_tr_b16 v[100:101], v3 offset:3072
v_mfma_f32_16x16x32_bf16 v[164:167], v[140:143], v[120:123], v[164:167]
ds_read_b64_tr_b16 v[102:103], v3 offset:3840
v_mfma_f32_16x16x32_bf16 v[168:171], v[144:147], v[120:123], v[168:171]
ds_read_b64_tr_b16 v[104:105], v4 offset:0
v_mfma_f32_16x16x32_bf16 v[192:195], v[144:147], v[124:127], v[192:195]
ds_read_b64_tr_b16 v[106:107], v4 offset:768
v_mfma_f32_16x16x32_bf16 v[216:219], v[144:147], v[128:131], v[216:219]
ds_read_b64_tr_b16 v[108:109], v4 offset:3072
v_mfma_f32_16x16x32_bf16 v[240:243], v[144:147], v[132:135], v[240:243]
ds_read_b64_tr_b16 v[110:111], v4 offset:3840
v_mfma_f32_16x16x32_bf16 v[244:247], v[148:151], v[132:135], v[244:247]
ds_read_b64_tr_b16 v[112:113], v5 offset:0
v_mfma_f32_16x16x32_bf16 v[220:223], v[148:151], v[128:131], v[220:223]
ds_read_b64_tr_b16 v[114:115], v5 offset:768
v_mfma_f32_16x16x32_bf16 v[196:199], v[148:151], v[124:127], v[196:199]
ds_read_b64_tr_b16 v[116:117], v5 offset:3072
v_mfma_f32_16x16x32_bf16 v[172:175], v[148:151], v[120:123], v[172:175]
ds_read_b64_tr_b16 v[118:119], v5 offset:3840
v_mfma_f32_16x16x32_bf16 v[176:179], v[152:155], v[120:123], v[176:179]
v_mfma_f32_16x16x32_bf16 v[200:203], v[152:155], v[124:127], v[200:203]
v_mfma_f32_16x16x32_bf16 v[224:227], v[152:155], v[128:131], v[224:227]
v_mfma_f32_16x16x32_bf16 v[248:251], v[152:155], v[132:135], v[248:251]
v_mfma_f32_16x16x32_bf16 v[252:255], v[156:159], v[132:135], v[252:255]
v_mfma_f32_16x16x32_bf16 v[228:231], v[156:159], v[128:131], v[228:231]
v_mfma_f32_16x16x32_bf16 v[204:207], v[156:159], v[124:127], v[204:207]
v_mfma_f32_16x16x32_bf16 v[180:183], v[156:159], v[120:123], v[180:183]
s_waitcnt lgkmcnt(0)
v_mfma_f32_16x16x32_bf16 v[160:163], v[96:99], v[80:83], v[160:163]
ds_read_b64_tr_b16 v[136:137], v3 offset:12288
v_mfma_f32_16x16x32_bf16 v[184:187], v[96:99], v[84:87], v[184:187]
ds_read_b64_tr_b16 v[138:139], v3 offset:13056
v_mfma_f32_16x16x32_bf16 v[208:211], v[96:99], v[88:91], v[208:211]
ds_read_b128 v[120:123], v2 offset:0
v_mfma_f32_16x16x32_bf16 v[232:235], v[96:99], v[92:95], v[232:235]
ds_read_b128 v[124:127], v2 offset:2048
v_mfma_f32_16x16x32_bf16 v[236:239], v[100:103], v[92:95], v[236:239]
ds_read_b128 v[128:131], v2 offset:4096
v_mfma_f32_16x16x32_bf16 v[212:215], v[100:103], v[88:91], v[212:215]
ds_read_b128 v[132:135], v2 offset:6144
v_mfma_f32_16x16x32_bf16 v[188:191], v[100:103], v[84:87], v[188:191]
ds_read_b64_tr_b16 v[140:141], v3 offset:15360
v_mfma_f32_16x16x32_bf16 v[164:167], v[100:103], v[80:83], v[164:167]
ds_read_b64_tr_b16 v[142:143], v3 offset:16128
v_mfma_f32_16x16x32_bf16 v[168:171], v[104:107], v[80:83], v[168:171]
ds_read_b64_tr_b16 v[144:145], v4 offset:12288
v_mfma_f32_16x16x32_bf16 v[192:195], v[104:107], v[84:87], v[192:195]
ds_read_b64_tr_b16 v[146:147], v4 offset:13056
v_mfma_f32_16x16x32_bf16 v[216:219], v[104:107], v[88:91], v[216:219]
ds_read_b64_tr_b16 v[148:149], v4 offset:15360
v_mfma_f32_16x16x32_bf16 v[240:243], v[104:107], v[92:95], v[240:243]
ds_read_b64_tr_b16 v[150:151], v4 offset:16128
v_mfma_f32_16x16x32_bf16 v[244:247], v[108:111], v[92:95], v[244:247]
ds_read_b64_tr_b16 v[152:153], v5 offset:12288
v_mfma_f32_16x16x32_bf16 v[220:223], v[108:111], v[88:91], v[220:223]
ds_read_b64_tr_b16 v[154:155], v5 offset:13056
v_mfma_f32_16x16x32_bf16 v[196:199], v[108:111], v[84:87], v[196:199]
ds_read_b64_tr_b16 v[156:157], v5 offset:15360
v_mfma_f32_16x16x32_bf16 v[172:175], v[108:111], v[80:83], v[172:175]
ds_read_b64_tr_b16 v[158:159], v5 offset:16128
v_mfma_f32_16x16x32_bf16 v[176:179], v[112:115], v[80:83], v[176:179]
v_add_u32 v1, 40960, v1
v_mfma_f32_16x16x32_bf16 v[200:203], v[112:115], v[84:87], v[200:203]
v_add_u32 v2, 40960, v2
v_mfma_f32_16x16x32_bf16 v[224:227], v[112:115], v[88:91], v[224:227]
v_add_u32 v3, 40960, v3
v_mfma_f32_16x16x32_bf16 v[248:251], v[112:115], v[92:95], v[248:251]
v_add_u32 v4, 40960, v4
v_mfma_f32_16x16x32_bf16 v[252:255], v[116:119], v[92:95], v[252:255]
v_add_u32 v5, 40960, v5
v_mfma_f32_16x16x32_bf16 v[228:231], v[116:119], v[88:91], v[228:231]
v_mfma_f32_16x16x32_bf16 v[204:207], v[116:119], v[84:87], v[204:207]
v_mfma_f32_16x16x32_bf16 v[180:183], v[116:119], v[80:83], v[180:183]
s_waitcnt lgkmcnt(0)
s_barrier
v_mfma_f32_16x16x32_bf16 v[160:163], v[136:139], v[120:123], v[160:163]
ds_read_b64_tr_b16 v[96:97], v3 offset:0
v_mfma_f32_16x16x32_bf16 v[184:187], v[136:139], v[124:127], v[184:187]
ds_read_b64_tr_b16 v[98:99], v3 offset:768
v_mfma_f32_16x16x32_bf16 v[208:211], v[136:139], v[128:131], v[208:211]
ds_read_b128 v[80:83], v1 offset:0
v_mfma_f32_16x16x32_bf16 v[232:235], v[136:139], v[132:135], v[232:235]
ds_read_b128 v[84:87], v1 offset:2048
v_mfma_f32_16x16x32_bf16 v[236:239], v[140:143], v[132:135], v[236:239]
ds_read_b128 v[88:91], v1 offset:4096
v_mfma_f32_16x16x32_bf16 v[212:215], v[140:143], v[128:131], v[212:215]
ds_read_b128 v[92:95], v1 offset:6144
v_mfma_f32_16x16x32_bf16 v[188:191], v[140:143], v[124:127], v[188:191]
ds_read_b64_tr_b16 v[100:101], v3 offset:3072
v_mfma_f32_16x16x32_bf16 v[164:167], v[140:143], v[120:123], v[164:167]
ds_read_b64_tr_b16 v[102:103], v3 offset:3840
v_mfma_f32_16x16x32_bf16 v[168:171], v[144:147], v[120:123], v[168:171]
ds_read_b64_tr_b16 v[104:105], v4 offset:0
v_mfma_f32_16x16x32_bf16 v[192:195], v[144:147], v[124:127], v[192:195]
ds_read_b64_tr_b16 v[106:107], v4 offset:768
v_mfma_f32_16x16x32_bf16 v[216:219], v[144:147], v[128:131], v[216:219]
ds_read_b64_tr_b16 v[108:109], v4 offset:3072
v_mfma_f32_16x16x32_bf16 v[240:243], v[144:147], v[132:135], v[240:243]
ds_read_b64_tr_b16 v[110:111], v4 offset:3840
v_mfma_f32_16x16x32_bf16 v[244:247], v[148:151], v[132:135], v[244:247]
ds_read_b64_tr_b16 v[112:113], v5 offset:0
v_mfma_f32_16x16x32_bf16 v[220:223], v[148:151], v[128:131], v[220:223]
ds_read_b64_tr_b16 v[114:115], v5 offset:768
v_mfma_f32_16x16x32_bf16 v[196:199], v[148:151], v[124:127], v[196:199]
ds_read_b64_tr_b16 v[116:117], v5 offset:3072
v_mfma_f32_16x16x32_bf16 v[172:175], v[148:151], v[120:123], v[172:175]
ds_read_b64_tr_b16 v[118:119], v5 offset:3840
v_mfma_f32_16x16x32_bf16 v[176:179], v[152:155], v[120:123], v[176:179]
v_mfma_f32_16x16x32_bf16 v[200:203], v[152:155], v[124:127], v[200:203]
v_mfma_f32_16x16x32_bf16 v[224:227], v[152:155], v[128:131], v[224:227]
v_mfma_f32_16x16x32_bf16 v[248:251], v[152:155], v[132:135], v[248:251]
v_mfma_f32_16x16x32_bf16 v[252:255], v[156:159], v[132:135], v[252:255]
v_mfma_f32_16x16x32_bf16 v[228:231], v[156:159], v[128:131], v[228:231]
v_mfma_f32_16x16x32_bf16 v[204:207], v[156:159], v[124:127], v[204:207]
v_mfma_f32_16x16x32_bf16 v[180:183], v[156:159], v[120:123], v[180:183]
s_waitcnt lgkmcnt(0)
v_mfma_f32_16x16x32_bf16 v[160:163], v[96:99], v[80:83], v[160:163]
ds_read_b64_tr_b16 v[136:137], v3 offset:12288
v_mfma_f32_16x16x32_bf16 v[184:187], v[96:99], v[84:87], v[184:187]
ds_read_b64_tr_b16 v[138:139], v3 offset:13056
v_mfma_f32_16x16x32_bf16 v[208:211], v[96:99], v[88:91], v[208:211]
ds_read_b128 v[120:123], v2 offset:0
v_mfma_f32_16x16x32_bf16 v[232:235], v[96:99], v[92:95], v[232:235]
ds_read_b128 v[124:127], v2 offset:2048
v_mfma_f32_16x16x32_bf16 v[236:239], v[100:103], v[92:95], v[236:239]
ds_read_b128 v[128:131], v2 offset:4096
v_mfma_f32_16x16x32_bf16 v[212:215], v[100:103], v[88:91], v[212:215]
ds_read_b128 v[132:135], v2 offset:6144
v_mfma_f32_16x16x32_bf16 v[188:191], v[100:103], v[84:87], v[188:191]
ds_read_b64_tr_b16 v[140:141], v3 offset:15360
v_mfma_f32_16x16x32_bf16 v[164:167], v[100:103], v[80:83], v[164:167]
ds_read_b64_tr_b16 v[142:143], v3 offset:16128
v_mfma_f32_16x16x32_bf16 v[168:171], v[104:107], v[80:83], v[168:171]
ds_read_b64_tr_b16 v[144:145], v4 offset:12288
v_mfma_f32_16x16x32_bf16 v[192:195], v[104:107], v[84:87], v[192:195]
ds_read_b64_tr_b16 v[146:147], v4 offset:13056
v_mfma_f32_16x16x32_bf16 v[216:219], v[104:107], v[88:91], v[216:219]
ds_read_b64_tr_b16 v[148:149], v4 offset:15360
v_mfma_f32_16x16x32_bf16 v[240:243], v[104:107], v[92:95], v[240:243]
ds_read_b64_tr_b16 v[150:151], v4 offset:16128
v_mfma_f32_16x16x32_bf16 v[244:247], v[108:111], v[92:95], v[244:247]
ds_read_b64_tr_b16 v[152:153], v5 offset:12288
v_mfma_f32_16x16x32_bf16 v[220:223], v[108:111], v[88:91], v[220:223]
ds_read_b64_tr_b16 v[154:155], v5 offset:13056
v_mfma_f32_16x16x32_bf16 v[196:199], v[108:111], v[84:87], v[196:199]
ds_read_b64_tr_b16 v[156:157], v5 offset:15360
v_mfma_f32_16x16x32_bf16 v[172:175], v[108:111], v[80:83], v[172:175]
ds_read_b64_tr_b16 v[158:159], v5 offset:16128
v_mfma_f32_16x16x32_bf16 v[176:179], v[112:115], v[80:83], v[176:179]
v_add_u32 v1, 40960, v1
v_mfma_f32_16x16x32_bf16 v[200:203], v[112:115], v[84:87], v[200:203]
v_add_u32 v2, 40960, v2
v_mfma_f32_16x16x32_bf16 v[224:227], v[112:115], v[88:91], v[224:227]
v_add_u32 v3, 40960, v3
v_mfma_f32_16x16x32_bf16 v[248:251], v[112:115], v[92:95], v[248:251]
v_add_u32 v4, 40960, v4
v_mfma_f32_16x16x32_bf16 v[252:255], v[116:119], v[92:95], v[252:255]
v_add_u32 v5, 40960, v5
v_mfma_f32_16x16x32_bf16 v[228:231], v[116:119], v[88:91], v[228:231]
v_mfma_f32_16x16x32_bf16 v[204:207], v[116:119], v[84:87], v[204:207]
v_mfma_f32_16x16x32_bf16 v[180:183], v[116:119], v[80:83], v[180:183]
s_waitcnt lgkmcnt(0)
s_barrier
v_mfma_f32_16x16x32_bf16 v[160:163], v[136:139], v[120:123], v[160:163]
ds_read_b64_tr_b16 v[96:97], v3 offset:0
v_mfma_f32_16x16x32_bf16 v[184:187], v[136:139], v[124:127], v[184:187]
ds_read_b64_tr_b16 v[98:99], v3 offset:768
v_mfma_f32_16x16x32_bf16 v[208:211], v[136:139], v[128:131], v[208:211]
ds_read_b128 v[80:83], v1 offset:0
v_mfma_f32_16x16x32_bf16 v[232:235], v[136:139], v[132:135], v[232:235]
ds_read_b128 v[84:87], v1 offset:2048
v_mfma_f32_16x16x32_bf16 v[236:239], v[140:143], v[132:135], v[236:239]
ds_read_b128 v[88:91], v1 offset:4096
v_mfma_f32_16x16x32_bf16 v[212:215], v[140:143], v[128:131], v[212:215]
ds_read_b128 v[92:95], v1 offset:6144
v_mfma_f32_16x16x32_bf16 v[188:191], v[140:143], v[124:127], v[188:191]
ds_read_b64_tr_b16 v[100:101], v3 offset:3072
v_mfma_f32_16x16x32_bf16 v[164:167], v[140:143], v[120:123], v[164:167]
ds_read_b64_tr_b16 v[102:103], v3 offset:3840
v_mfma_f32_16x16x32_bf16 v[168:171], v[144:147], v[120:123], v[168:171]
ds_read_b64_tr_b16 v[104:105], v4 offset:0
v_mfma_f32_16x16x32_bf16 v[192:195], v[144:147], v[124:127], v[192:195]
ds_read_b64_tr_b16 v[106:107], v4 offset:768
v_mfma_f32_16x16x32_bf16 v[216:219], v[144:147], v[128:131], v[216:219]
ds_read_b64_tr_b16 v[108:109], v4 offset:3072
v_mfma_f32_16x16x32_bf16 v[240:243], v[144:147], v[132:135], v[240:243]
ds_read_b64_tr_b16 v[110:111], v4 offset:3840
v_mfma_f32_16x16x32_bf16 v[244:247], v[148:151], v[132:135], v[244:247]
ds_read_b64_tr_b16 v[112:113], v5 offset:0
v_mfma_f32_16x16x32_bf16 v[220:223], v[148:151], v[128:131], v[220:223]
ds_read_b64_tr_b16 v[114:115], v5 offset:768
v_mfma_f32_16x16x32_bf16 v[196:199], v[148:151], v[124:127], v[196:199]
ds_read_b64_tr_b16 v[116:117], v5 offset:3072
v_mfma_f32_16x16x32_bf16 v[172:175], v[148:151], v[120:123], v[172:175]
ds_read_b64_tr_b16 v[118:119], v5 offset:3840
v_mfma_f32_16x16x32_bf16 v[176:179], v[152:155], v[120:123], v[176:179]
v_mfma_f32_16x16x32_bf16 v[200:203], v[152:155], v[124:127], v[200:203]
v_mfma_f32_16x16x32_bf16 v[224:227], v[152:155], v[128:131], v[224:227]
v_mfma_f32_16x16x32_bf16 v[248:251], v[152:155], v[132:135], v[248:251]
v_mfma_f32_16x16x32_bf16 v[252:255], v[156:159], v[132:135], v[252:255]
v_mfma_f32_16x16x32_bf16 v[228:231], v[156:159], v[128:131], v[228:231]
v_mfma_f32_16x16x32_bf16 v[204:207], v[156:159], v[124:127], v[204:207]
v_mfma_f32_16x16x32_bf16 v[180:183], v[156:159], v[120:123], v[180:183]
s_waitcnt lgkmcnt(0)
v_mfma_f32_16x16x32_bf16 v[160:163], v[96:99], v[80:83], v[160:163]
ds_read_b64_tr_b16 v[136:137], v3 offset:12288
v_mfma_f32_16x16x32_bf16 v[184:187], v[96:99], v[84:87], v[184:187]
ds_read_b64_tr_b16 v[138:139], v3 offset:13056
v_mfma_f32_16x16x32_bf16 v[208:211], v[96:99], v[88:91], v[208:211]
ds_read_b128 v[120:123], v2 offset:0
v_mfma_f32_16x16x32_bf16 v[232:235], v[96:99], v[92:95], v[232:235]
ds_read_b128 v[124:127], v2 offset:2048
v_mfma_f32_16x16x32_bf16 v[236:239], v[100:103], v[92:95], v[236:239]
ds_read_b128 v[128:131], v2 offset:4096
v_mfma_f32_16x16x32_bf16 v[212:215], v[100:103], v[88:91], v[212:215]
ds_read_b128 v[132:135], v2 offset:6144
v_mfma_f32_16x16x32_bf16 v[188:191], v[100:103], v[84:87], v[188:191]
ds_read_b64_tr_b16 v[140:141], v3 offset:15360
v_mfma_f32_16x16x32_bf16 v[164:167], v[100:103], v[80:83], v[164:167]
ds_read_b64_tr_b16 v[142:143], v3 offset:16128
v_mfma_f32_16x16x32_bf16 v[168:171], v[104:107], v[80:83], v[168:171]
ds_read_b64_tr_b16 v[144:145], v4 offset:12288
v_mfma_f32_16x16x32_bf16 v[192:195], v[104:107], v[84:87], v[192:195]
ds_read_b64_tr_b16 v[146:147], v4 offset:13056
v_mfma_f32_16x16x32_bf16 v[216:219], v[104:107], v[88:91], v[216:219]
ds_read_b64_tr_b16 v[148:149], v4 offset:15360
v_mfma_f32_16x16x32_bf16 v[240:243], v[104:107], v[92:95], v[240:243]
ds_read_b64_tr_b16 v[150:151], v4 offset:16128
v_mfma_f32_16x16x32_bf16 v[244:247], v[108:111], v[92:95], v[244:247]
ds_read_b64_tr_b16 v[152:153], v5 offset:12288
v_mfma_f32_16x16x32_bf16 v[220:223], v[108:111], v[88:91], v[220:223]
ds_read_b64_tr_b16 v[154:155], v5 offset:13056
v_mfma_f32_16x16x32_bf16 v[196:199], v[108:111], v[84:87], v[196:199]
ds_read_b64_tr_b16 v[156:157], v5 offset:15360
v_mfma_f32_16x16x32_bf16 v[172:175], v[108:111], v[80:83], v[172:175]
ds_read_b64_tr_b16 v[158:159], v5 offset:16128
v_mfma_f32_16x16x32_bf16 v[176:179], v[112:115], v[80:83], v[176:179]
v_subrev_u32 v1, 81920, v1
v_mfma_f32_16x16x32_bf16 v[200:203], v[112:115], v[84:87], v[200:203]
v_subrev_u32 v2, 81920, v2
v_mfma_f32_16x16x32_bf16 v[224:227], v[112:115], v[88:91], v[224:227]
v_subrev_u32 v3, 81920, v3
v_mfma_f32_16x16x32_bf16 v[248:251], v[112:115], v[92:95], v[248:251]
v_subrev_u32 v4, 81920, v4
v_mfma_f32_16x16x32_bf16 v[252:255], v[116:119], v[92:95], v[252:255]
v_subrev_u32 v5, 81920, v5
v_mfma_f32_16x16x32_bf16 v[228:231], v[116:119], v[88:91], v[228:231]
v_mfma_f32_16x16x32_bf16 v[204:207], v[116:119], v[84:87], v[204:207]
v_mfma_f32_16x16x32_bf16 v[180:183], v[116:119], v[80:83], v[180:183]
s_waitcnt lgkmcnt(0)
s_barrier
v_mfma_f32_16x16x32_bf16 v[160:163], v[136:139], v[120:123], v[160:163]
ds_read_b64_tr_b16 v[96:97], v3 offset:0
v_mfma_f32_16x16x32_bf16 v[184:187], v[136:139], v[124:127], v[184:187]
ds_read_b64_tr_b16 v[98:99], v3 offset:768
v_mfma_f32_16x16x32_bf16 v[208:211], v[136:139], v[128:131], v[208:211]
ds_read_b128 v[80:83], v1 offset:0
v_mfma_f32_16x16x32_bf16 v[232:235], v[136:139], v[132:135], v[232:235]
ds_read_b128 v[84:87], v1 offset:2048
v_mfma_f32_16x16x32_bf16 v[236:239], v[140:143], v[132:135], v[236:239]
ds_read_b128 v[88:91], v1 offset:4096
v_mfma_f32_16x16x32_bf16 v[212:215], v[140:143], v[128:131], v[212:215]
ds_read_b128 v[92:95], v1 offset:6144
v_mfma_f32_16x16x32_bf16 v[188:191], v[140:143], v[124:127], v[188:191]
ds_read_b64_tr_b16 v[100:101], v3 offset:3072
v_mfma_f32_16x16x32_bf16 v[164:167], v[140:143], v[120:123], v[164:167]
ds_read_b64_tr_b16 v[102:103], v3 offset:3840
v_mfma_f32_16x16x32_bf16 v[168:171], v[144:147], v[120:123], v[168:171]
ds_read_b64_tr_b16 v[104:105], v4 offset:0
v_mfma_f32_16x16x32_bf16 v[192:195], v[144:147], v[124:127], v[192:195]
ds_read_b64_tr_b16 v[106:107], v4 offset:768
v_mfma_f32_16x16x32_bf16 v[216:219], v[144:147], v[128:131], v[216:219]
ds_read_b64_tr_b16 v[108:109], v4 offset:3072
v_mfma_f32_16x16x32_bf16 v[240:243], v[144:147], v[132:135], v[240:243]
ds_read_b64_tr_b16 v[110:111], v4 offset:3840
v_mfma_f32_16x16x32_bf16 v[244:247], v[148:151], v[132:135], v[244:247]
ds_read_b64_tr_b16 v[112:113], v5 offset:0
v_mfma_f32_16x16x32_bf16 v[220:223], v[148:151], v[128:131], v[220:223]
ds_read_b64_tr_b16 v[114:115], v5 offset:768
v_mfma_f32_16x16x32_bf16 v[196:199], v[148:151], v[124:127], v[196:199]
ds_read_b64_tr_b16 v[116:117], v5 offset:3072
v_mfma_f32_16x16x32_bf16 v[172:175], v[148:151], v[120:123], v[172:175]
ds_read_b64_tr_b16 v[118:119], v5 offset:3840
v_mfma_f32_16x16x32_bf16 v[176:179], v[152:155], v[120:123], v[176:179]
v_mfma_f32_16x16x32_bf16 v[200:203], v[152:155], v[124:127], v[200:203]
v_mfma_f32_16x16x32_bf16 v[224:227], v[152:155], v[128:131], v[224:227]
v_mfma_f32_16x16x32_bf16 v[248:251], v[152:155], v[132:135], v[248:251]
v_mfma_f32_16x16x32_bf16 v[252:255], v[156:159], v[132:135], v[252:255]
v_mfma_f32_16x16x32_bf16 v[228:231], v[156:159], v[128:131], v[228:231]
v_mfma_f32_16x16x32_bf16 v[204:207], v[156:159], v[124:127], v[204:207]
v_mfma_f32_16x16x32_bf16 v[180:183], v[156:159], v[120:123], v[180:183]
s_waitcnt lgkmcnt(0)
v_mfma_f32_16x16x32_bf16 v[160:163], v[96:99], v[80:83], v[160:163]
ds_read_b64_tr_b16 v[136:137], v3 offset:12288
v_mfma_f32_16x16x32_bf16 v[184:187], v[96:99], v[84:87], v[184:187]
ds_read_b64_tr_b16 v[138:139], v3 offset:13056
v_mfma_f32_16x16x32_bf16 v[208:211], v[96:99], v[88:91], v[208:211]
ds_read_b128 v[120:123], v2 offset:0
v_mfma_f32_16x16x32_bf16 v[232:235], v[96:99], v[92:95], v[232:235]
ds_read_b128 v[124:127], v2 offset:2048
v_mfma_f32_16x16x32_bf16 v[236:239], v[100:103], v[92:95], v[236:239]
ds_read_b128 v[128:131], v2 offset:4096
v_mfma_f32_16x16x32_bf16 v[212:215], v[100:103], v[88:91], v[212:215]
ds_read_b128 v[132:135], v2 offset:6144
v_mfma_f32_16x16x32_bf16 v[188:191], v[100:103], v[84:87], v[188:191]
ds_read_b64_tr_b16 v[140:141], v3 offset:15360
v_mfma_f32_16x16x32_bf16 v[164:167], v[100:103], v[80:83], v[164:167]
ds_read_b64_tr_b16 v[142:143], v3 offset:16128
v_mfma_f32_16x16x32_bf16 v[168:171], v[104:107], v[80:83], v[168:171]
ds_read_b64_tr_b16 v[144:145], v4 offset:12288
v_mfma_f32_16x16x32_bf16 v[192:195], v[104:107], v[84:87], v[192:195]
ds_read_b64_tr_b16 v[146:147], v4 offset:13056
v_mfma_f32_16x16x32_bf16 v[216:219], v[104:107], v[88:91], v[216:219]
ds_read_b64_tr_b16 v[148:149], v4 offset:15360
v_mfma_f32_16x16x32_bf16 v[240:243], v[104:107], v[92:95], v[240:243]
ds_read_b64_tr_b16 v[150:151], v4 offset:16128
v_mfma_f32_16x16x32_bf16 v[244:247], v[108:111], v[92:95], v[244:247]
ds_read_b64_tr_b16 v[152:153], v5 offset:12288
v_mfma_f32_16x16x32_bf16 v[220:223], v[108:111], v[88:91], v[220:223]
ds_read_b64_tr_b16 v[154:155], v5 offset:13056
v_mfma_f32_16x16x32_bf16 v[196:199], v[108:111], v[84:87], v[196:199]
ds_read_b64_tr_b16 v[156:157], v5 offset:15360
v_mfma_f32_16x16x32_bf16 v[172:175], v[108:111], v[80:83], v[172:175]
ds_read_b64_tr_b16 v[158:159], v5 offset:16128
v_mfma_f32_16x16x32_bf16 v[176:179], v[112:115], v[80:83], v[176:179]
v_add_u32 v1, 40960, v1
v_mfma_f32_16x16x32_bf16 v[200:203], v[112:115], v[84:87], v[200:203]
v_add_u32 v2, 40960, v2
v_mfma_f32_16x16x32_bf16 v[224:227], v[112:115], v[88:91], v[224:227]
v_add_u32 v3, 40960, v3
v_mfma_f32_16x16x32_bf16 v[248:251], v[112:115], v[92:95], v[248:251]
v_add_u32 v4, 40960, v4
v_mfma_f32_16x16x32_bf16 v[252:255], v[116:119], v[92:95], v[252:255]
v_add_u32 v5, 40960, v5
v_mfma_f32_16x16x32_bf16 v[228:231], v[116:119], v[88:91], v[228:231]
v_mfma_f32_16x16x32_bf16 v[204:207], v[116:119], v[84:87], v[204:207]
v_mfma_f32_16x16x32_bf16 v[180:183], v[116:119], v[80:83], v[180:183]
s_waitcnt lgkmcnt(0)
s_barrier
v_mfma_f32_16x16x32_bf16 v[160:163], v[136:139], v[120:123], v[160:163]
ds_read_b64_tr_b16 v[96:97], v3 offset:0
v_mfma_f32_16x16x32_bf16 v[184:187], v[136:139], v[124:127], v[184:187]
ds_read_b64_tr_b16 v[98:99], v3 offset:768
v_mfma_f32_16x16x32_bf16 v[208:211], v[136:139], v[128:131], v[208:211]
ds_read_b128 v[80:83], v1 offset:0
v_mfma_f32_16x16x32_bf16 v[232:235], v[136:139], v[132:135], v[232:235]
ds_read_b128 v[84:87], v1 offset:2048
v_mfma_f32_16x16x32_bf16 v[236:239], v[140:143], v[132:135], v[236:239]
ds_read_b128 v[88:91], v1 offset:4096
v_mfma_f32_16x16x32_bf16 v[212:215], v[140:143], v[128:131], v[212:215]
ds_read_b128 v[92:95], v1 offset:6144
v_mfma_f32_16x16x32_bf16 v[188:191], v[140:143], v[124:127], v[188:191]
ds_read_b64_tr_b16 v[100:101], v3 offset:3072
v_mfma_f32_16x16x32_bf16 v[164:167], v[140:143], v[120:123], v[164:167]
ds_read_b64_tr_b16 v[102:103], v3 offset:3840
v_mfma_f32_16x16x32_bf16 v[168:171], v[144:147], v[120:123], v[168:171]
ds_read_b64_tr_b16 v[104:105], v4 offset:0
v_mfma_f32_16x16x32_bf16 v[192:195], v[144:147], v[124:127], v[192:195]
ds_read_b64_tr_b16 v[106:107], v4 offset:768
v_mfma_f32_16x16x32_bf16 v[216:219], v[144:147], v[128:131], v[216:219]
ds_read_b64_tr_b16 v[108:109], v4 offset:3072
v_mfma_f32_16x16x32_bf16 v[240:243], v[144:147], v[132:135], v[240:243]
ds_read_b64_tr_b16 v[110:111], v4 offset:3840
v_mfma_f32_16x16x32_bf16 v[244:247], v[148:151], v[132:135], v[244:247]
ds_read_b64_tr_b16 v[112:113], v5 offset:0
v_mfma_f32_16x16x32_bf16 v[220:223], v[148:151], v[128:131], v[220:223]
ds_read_b64_tr_b16 v[114:115], v5 offset:768
v_mfma_f32_16x16x32_bf16 v[196:199], v[148:151], v[124:127], v[196:199]
ds_read_b64_tr_b16 v[116:117], v5 offset:3072
v_mfma_f32_16x16x32_bf16 v[172:175], v[148:151], v[120:123], v[172:175]
ds_read_b64_tr_b16 v[118:119], v5 offset:3840
v_mfma_f32_16x16x32_bf16 v[176:179], v[152:155], v[120:123], v[176:179]
v_mfma_f32_16x16x32_bf16 v[200:203], v[152:155], v[124:127], v[200:203]
v_mfma_f32_16x16x32_bf16 v[224:227], v[152:155], v[128:131], v[224:227]
v_mfma_f32_16x16x32_bf16 v[248:251], v[152:155], v[132:135], v[248:251]
v_mfma_f32_16x16x32_bf16 v[252:255], v[156:159], v[132:135], v[252:255]
v_mfma_f32_16x16x32_bf16 v[228:231], v[156:159], v[128:131], v[228:231]
v_mfma_f32_16x16x32_bf16 v[204:207], v[156:159], v[124:127], v[204:207]
v_mfma_f32_16x16x32_bf16 v[180:183], v[156:159], v[120:123], v[180:183]
s_waitcnt lgkmcnt(0)
v_mfma_f32_16x16x32_bf16 v[160:163], v[96:99], v[80:83], v[160:163]
ds_read_b64_tr_b16 v[136:137], v3 offset:12288
v_mfma_f32_16x16x32_bf16 v[184:187], v[96:99], v[84:87], v[184:187]
ds_read_b64_tr_b16 v[138:139], v3 offset:13056
v_mfma_f32_16x16x32_bf16 v[208:211], v[96:99], v[88:91], v[208:211]
ds_read_b128 v[120:123], v2 offset:0
v_mfma_f32_16x16x32_bf16 v[232:235], v[96:99], v[92:95], v[232:235]
ds_read_b128 v[124:127], v2 offset:2048
v_mfma_f32_16x16x32_bf16 v[236:239], v[100:103], v[92:95], v[236:239]
ds_read_b128 v[128:131], v2 offset:4096
v_mfma_f32_16x16x32_bf16 v[212:215], v[100:103], v[88:91], v[212:215]
ds_read_b128 v[132:135], v2 offset:6144
v_mfma_f32_16x16x32_bf16 v[188:191], v[100:103], v[84:87], v[188:191]
ds_read_b64_tr_b16 v[140:141], v3 offset:15360
v_mfma_f32_16x16x32_bf16 v[164:167], v[100:103], v[80:83], v[164:167]
ds_read_b64_tr_b16 v[142:143], v3 offset:16128
v_mfma_f32_16x16x32_bf16 v[168:171], v[104:107], v[80:83], v[168:171]
ds_read_b64_tr_b16 v[144:145], v4 offset:12288
v_mfma_f32_16x16x32_bf16 v[192:195], v[104:107], v[84:87], v[192:195]
ds_read_b64_tr_b16 v[146:147], v4 offset:13056
v_mfma_f32_16x16x32_bf16 v[216:219], v[104:107], v[88:91], v[216:219]
ds_read_b64_tr_b16 v[148:149], v4 offset:15360
v_mfma_f32_16x16x32_bf16 v[240:243], v[104:107], v[92:95], v[240:243]
ds_read_b64_tr_b16 v[150:151], v4 offset:16128
v_mfma_f32_16x16x32_bf16 v[244:247], v[108:111], v[92:95], v[244:247]
ds_read_b64_tr_b16 v[152:153], v5 offset:12288
v_mfma_f32_16x16x32_bf16 v[220:223], v[108:111], v[88:91], v[220:223]
ds_read_b64_tr_b16 v[154:155], v5 offset:13056
v_mfma_f32_16x16x32_bf16 v[196:199], v[108:111], v[84:87], v[196:199]
ds_read_b64_tr_b16 v[156:157], v5 offset:15360
v_mfma_f32_16x16x32_bf16 v[172:175], v[108:111], v[80:83], v[172:175]
ds_read_b64_tr_b16 v[158:159], v5 offset:16128
v_mfma_f32_16x16x32_bf16 v[176:179], v[112:115], v[80:83], v[176:179]
v_add_u32 v1, 40960, v1
v_mfma_f32_16x16x32_bf16 v[200:203], v[112:115], v[84:87], v[200:203]
v_add_u32 v2, 40960, v2
v_mfma_f32_16x16x32_bf16 v[224:227], v[112:115], v[88:91], v[224:227]
v_add_u32 v3, 40960, v3
v_mfma_f32_16x16x32_bf16 v[248:251], v[112:115], v[92:95], v[248:251]
v_add_u32 v4, 40960, v4
v_mfma_f32_16x16x32_bf16 v[252:255], v[116:119], v[92:95], v[252:255]
v_add_u32 v5, 40960, v5
v_mfma_f32_16x16x32_bf16 v[228:231], v[116:119], v[88:91], v[228:231]
v_mfma_f32_16x16x32_bf16 v[204:207], v[116:119], v[84:87], v[204:207]
v_mfma_f32_16x16x32_bf16 v[180:183], v[116:119], v[80:83], v[180:183]
s_waitcnt lgkmcnt(0)
s_barrier
v_mfma_f32_16x16x32_bf16 v[160:163], v[136:139], v[120:123], v[160:163]
ds_read_b64_tr_b16 v[96:97], v3 offset:0
ds_read_b64_tr_b16 v[98:99], v3 offset:768
v_mfma_f32_16x16x32_bf16 v[184:187], v[136:139], v[124:127], v[184:187]
ds_read_b128 v[80:83], v1 offset:0
ds_read_b128 v[84:87], v1 offset:2048
v_mfma_f32_16x16x32_bf16 v[208:211], v[136:139], v[128:131], v[208:211]
ds_read_b128 v[88:91], v1 offset:4096
ds_read_b128 v[92:95], v1 offset:6144
v_mfma_f32_16x16x32_bf16 v[232:235], v[136:139], v[132:135], v[232:235]
ds_read_b64_tr_b16 v[100:101], v3 offset:3072
ds_read_b64_tr_b16 v[102:103], v3 offset:3840
v_mfma_f32_16x16x32_bf16 v[236:239], v[140:143], v[132:135], v[236:239]
ds_read_b64_tr_b16 v[104:105], v4 offset:0
ds_read_b64_tr_b16 v[106:107], v4 offset:768
v_mfma_f32_16x16x32_bf16 v[212:215], v[140:143], v[128:131], v[212:215]
ds_read_b64_tr_b16 v[108:109], v4 offset:3072
ds_read_b64_tr_b16 v[110:111], v4 offset:3840
v_mfma_f32_16x16x32_bf16 v[188:191], v[140:143], v[124:127], v[188:191]
ds_read_b64_tr_b16 v[112:113], v5 offset:0
ds_read_b64_tr_b16 v[114:115], v5 offset:768
v_mfma_f32_16x16x32_bf16 v[164:167], v[140:143], v[120:123], v[164:167]
ds_read_b64_tr_b16 v[116:117], v5 offset:3072
ds_read_b64_tr_b16 v[118:119], v5 offset:3840
v_mfma_f32_16x16x32_bf16 v[168:171], v[144:147], v[120:123], v[168:171]
v_and_b32 v48, 15, v0
s_mul_i32 s63, s86, 512
v_mfma_f32_16x16x32_bf16 v[192:195], v[144:147], v[124:127], v[192:195]
s_add_u32 s63, s63, 159232
v_lshl_add_u32 v49, v48, 3, s63
v_mfma_f32_16x16x32_bf16 v[216:219], v[144:147], v[128:131], v[216:219]
s_lshl_b32 s63, s87, 10
s_add_u32 s63, s63, 160768
v_mfma_f32_16x16x32_bf16 v[240:243], v[144:147], v[132:135], v[240:243]
v_lshl_add_u32 v51, v48, 3, s63
s_lshl_b32 s63, s87, 8
v_mfma_f32_16x16x32_bf16 v[244:247], v[148:151], v[132:135], v[244:247]
s_add_u32 s63, s63, 161280
v_lshl_add_u32 v52, v48, 3, s63
v_mfma_f32_16x16x32_bf16 v[220:223], v[148:151], v[128:131], v[220:223]
v_mov_b32 v50, 162320
s_mul_i32 s91, s54, 3
v_mfma_f32_16x16x32_bf16 v[196:199], v[148:151], v[124:127], v[196:199]
s_lshr_b32 s91, s91, 1
s_mul_i32 s63, s53, 12
v_mfma_f32_16x16x32_bf16 v[172:175], v[148:151], v[120:123], v[172:175]
s_mul_i32 s64, s60, 49
s_add_u32 s64, s64, s63
v_mfma_f32_16x16x32_bf16 v[176:179], v[152:155], v[120:123], v[176:179]
s_mul_i32 s92, s64, 5120
s_add_u32 s92, s92, 6553600
v_mfma_f32_16x16x32_bf16 v[200:203], v[152:155], v[124:127], v[200:203]
v_mfma_f32_16x16x32_bf16 v[224:227], v[152:155], v[128:131], v[224:227]
v_mfma_f32_16x16x32_bf16 v[248:251], v[152:155], v[132:135], v[248:251]
v_mfma_f32_16x16x32_bf16 v[252:255], v[156:159], v[132:135], v[252:255]
v_mfma_f32_16x16x32_bf16 v[228:231], v[156:159], v[128:131], v[228:231]
v_mfma_f32_16x16x32_bf16 v[204:207], v[156:159], v[124:127], v[204:207]
v_mfma_f32_16x16x32_bf16 v[180:183], v[156:159], v[120:123], v[180:183]
s_waitcnt lgkmcnt(0)
v_mfma_f32_16x16x32_bf16 v[160:163], v[96:99], v[80:83], v[160:163]
ds_read_b64_tr_b16 v[136:137], v3 offset:12288
ds_read_b64_tr_b16 v[138:139], v3 offset:13056
v_mfma_f32_16x16x32_bf16 v[184:187], v[96:99], v[84:87], v[184:187]
ds_read_b128 v[120:123], v2 offset:0
ds_read_b128 v[124:127], v2 offset:2048
v_mfma_f32_16x16x32_bf16 v[208:211], v[96:99], v[88:91], v[208:211]
ds_read_b128 v[128:131], v2 offset:4096
ds_read_b128 v[132:135], v2 offset:6144
v_mfma_f32_16x16x32_bf16 v[232:235], v[96:99], v[92:95], v[232:235]
ds_read_b64_tr_b16 v[140:141], v3 offset:15360
ds_read_b64_tr_b16 v[142:143], v3 offset:16128
v_mfma_f32_16x16x32_bf16 v[236:239], v[100:103], v[92:95], v[236:239]
ds_read_b64_tr_b16 v[144:145], v4 offset:12288
ds_read_b64_tr_b16 v[146:147], v4 offset:13056
v_mfma_f32_16x16x32_bf16 v[212:215], v[100:103], v[88:91], v[212:215]
ds_read_b64_tr_b16 v[148:149], v4 offset:15360
ds_read_b64_tr_b16 v[150:151], v4 offset:16128
v_mfma_f32_16x16x32_bf16 v[188:191], v[100:103], v[84:87], v[188:191]
ds_read_b64_tr_b16 v[152:153], v5 offset:12288
ds_read_b64_tr_b16 v[154:155], v5 offset:13056
v_mfma_f32_16x16x32_bf16 v[164:167], v[100:103], v[80:83], v[164:167]
ds_read_b64_tr_b16 v[156:157], v5 offset:15360
ds_read_b64_tr_b16 v[158:159], v5 offset:16128
v_mfma_f32_16x16x32_bf16 v[168:171], v[104:107], v[80:83], v[168:171]
v_subrev_u32 v1, 81920, v1
v_subrev_u32 v2, 81920, v2
v_mfma_f32_16x16x32_bf16 v[192:195], v[104:107], v[84:87], v[192:195]
v_subrev_u32 v3, 81920, v3
v_subrev_u32 v4, 81920, v4
v_mfma_f32_16x16x32_bf16 v[216:219], v[104:107], v[88:91], v[216:219]
v_subrev_u32 v5, 81920, v5
s_mul_i32 s63, s53, 12
v_mfma_f32_16x16x32_bf16 v[240:243], v[104:107], v[92:95], v[240:243]
s_mul_i32 s64, s59, 49
s_add_u32 s64, s64, s63
v_mfma_f32_16x16x32_bf16 v[244:247], v[108:111], v[92:95], v[244:247]
s_lshl_b32 s93, s64, 12
s_add_u32 s93, s93, 8585216
v_mfma_f32_16x16x32_bf16 v[220:223], v[108:111], v[88:91], v[220:223]
s_add_u32 s63, s56, s86
s_mul_i32 s64, s57, 43
v_mfma_f32_16x16x32_bf16 v[196:199], v[108:111], v[84:87], v[196:199]
s_lshr_b32 s64, s64, 10
s_lshl2_add_u32 s63, s63, s64
v_mfma_f32_16x16x32_bf16 v[172:175], v[108:111], v[80:83], v[172:175]
s_add_u32 s96, s63, 0
s_lshl_b32 s96, s96, 7
v_mfma_f32_16x16x32_bf16 v[176:179], v[112:115], v[80:83], v[176:179]
s_mov_b32 s98, 38400
s_lshl2_add_u32 s63, s59, s53
v_mfma_f32_16x16x32_bf16 v[200:203], v[112:115], v[84:87], v[200:203]
s_add_u32 s63, s63, 0
s_lshl_b32 s99, s63, 7
v_mfma_f32_16x16x32_bf16 v[224:227], v[112:115], v[88:91], v[224:227]
s_mul_i32 s63, s59, 43
s_lshr_b32 s63, s63, 7
v_mfma_f32_16x16x32_bf16 v[248:251], v[112:115], v[92:95], v[248:251]
s_mul_i32 s63, s63, 3
s_sub_u32 s63, s59, s63
v_mfma_f32_16x16x32_bf16 v[252:255], v[116:119], v[92:95], v[252:255]
s_cmp_eq_u32 s63, 1
s_cselect_b32 s100, 24, 12
s_cmp_ge_u32 s59, 30
s_cselect_b32 s100, 8, s100
v_mfma_f32_16x16x32_bf16 v[228:231], v[116:119], v[88:91], v[228:231]
v_mfma_f32_16x16x32_bf16 v[204:207], v[116:119], v[84:87], v[204:207]
v_mfma_f32_16x16x32_bf16 v[180:183], v[116:119], v[80:83], v[180:183]
s_waitcnt lgkmcnt(0)
s_barrier
v_mfma_f32_16x16x32_bf16 v[160:163], v[136:139], v[120:123], v[160:163]
ds_read_b64_tr_b16 v[96:97], v3 offset:0
v_mfma_f32_16x16x32_bf16 v[184:187], v[136:139], v[124:127], v[184:187]
ds_read_b64_tr_b16 v[98:99], v3 offset:768
v_mfma_f32_16x16x32_bf16 v[208:211], v[136:139], v[128:131], v[208:211]
ds_read_b128 v[80:83], v1 offset:0
v_mfma_f32_16x16x32_bf16 v[232:235], v[136:139], v[132:135], v[232:235]
ds_read_b128 v[84:87], v1 offset:2048
v_mfma_f32_16x16x32_bf16 v[236:239], v[140:143], v[132:135], v[236:239]
ds_read_b128 v[88:91], v1 offset:4096
v_mfma_f32_16x16x32_bf16 v[212:215], v[140:143], v[128:131], v[212:215]
ds_read_b128 v[92:95], v1 offset:6144
v_mfma_f32_16x16x32_bf16 v[188:191], v[140:143], v[124:127], v[188:191]
ds_read_b64_tr_b16 v[100:101], v3 offset:3072
v_mfma_f32_16x16x32_bf16 v[164:167], v[140:143], v[120:123], v[164:167]
ds_read_b64_tr_b16 v[102:103], v3 offset:3840
v_mfma_f32_16x16x32_bf16 v[168:171], v[144:147], v[120:123], v[168:171]
ds_read_b64_tr_b16 v[104:105], v4 offset:0
v_mfma_f32_16x16x32_bf16 v[192:195], v[144:147], v[124:127], v[192:195]
ds_read_b64_tr_b16 v[106:107], v4 offset:768
v_mfma_f32_16x16x32_bf16 v[216:219], v[144:147], v[128:131], v[216:219]
ds_read_b64_tr_b16 v[108:109], v4 offset:3072
v_mfma_f32_16x16x32_bf16 v[240:243], v[144:147], v[132:135], v[240:243]
ds_read_b64_tr_b16 v[110:111], v4 offset:3840
v_mfma_f32_16x16x32_bf16 v[244:247], v[148:151], v[132:135], v[244:247]
ds_read_b64_tr_b16 v[112:113], v5 offset:0
v_mfma_f32_16x16x32_bf16 v[220:223], v[148:151], v[128:131], v[220:223]
ds_read_b64_tr_b16 v[114:115], v5 offset:768
v_mfma_f32_16x16x32_bf16 v[196:199], v[148:151], v[124:127], v[196:199]
ds_read_b64_tr_b16 v[116:117], v5 offset:3072
v_mfma_f32_16x16x32_bf16 v[172:175], v[148:151], v[120:123], v[172:175]
ds_read_b64_tr_b16 v[118:119], v5 offset:3840
v_mfma_f32_16x16x32_bf16 v[176:179], v[152:155], v[120:123], v[176:179]
v_mfma_f32_16x16x32_bf16 v[200:203], v[152:155], v[124:127], v[200:203]
v_mfma_f32_16x16x32_bf16 v[224:227], v[152:155], v[128:131], v[224:227]
v_mfma_f32_16x16x32_bf16 v[248:251], v[152:155], v[132:135], v[248:251]
v_mfma_f32_16x16x32_bf16 v[252:255], v[156:159], v[132:135], v[252:255]
v_mfma_f32_16x16x32_bf16 v[228:231], v[156:159], v[128:131], v[228:231]
v_mfma_f32_16x16x32_bf16 v[204:207], v[156:159], v[124:127], v[204:207]
v_mfma_f32_16x16x32_bf16 v[180:183], v[156:159], v[120:123], v[180:183]
s_waitcnt lgkmcnt(0)
s_setprio 2
v_mfma_f32_16x16x32_bf16 v[160:163], v[96:99], v[80:83], v[160:163]
ds_read_b64_tr_b16 v[136:137], v3 offset:12288
ds_read_b64_tr_b16 v[138:139], v3 offset:13056
v_mfma_f32_16x16x32_bf16 v[184:187], v[96:99], v[84:87], v[184:187]
ds_read_b128 v[120:123], v2 offset:0
ds_read_b128 v[124:127], v2 offset:2048
v_mfma_f32_16x16x32_bf16 v[208:211], v[96:99], v[88:91], v[208:211]
ds_read_b128 v[128:131], v2 offset:4096
ds_read_b128 v[132:135], v2 offset:6144
v_mfma_f32_16x16x32_bf16 v[232:235], v[96:99], v[92:95], v[232:235]
ds_read_b64_tr_b16 v[140:141], v3 offset:15360
ds_read_b64_tr_b16 v[142:143], v3 offset:16128
v_mfma_f32_16x16x32_bf16 v[236:239], v[100:103], v[92:95], v[236:239]
ds_read_b64_tr_b16 v[144:145], v4 offset:12288
ds_read_b64_tr_b16 v[146:147], v4 offset:13056
v_mfma_f32_16x16x32_bf16 v[212:215], v[100:103], v[88:91], v[212:215]
ds_read_b64_tr_b16 v[148:149], v4 offset:15360
ds_read_b64_tr_b16 v[150:151], v4 offset:16128
v_mfma_f32_16x16x32_bf16 v[188:191], v[100:103], v[84:87], v[188:191]
ds_read_b64_tr_b16 v[152:153], v5 offset:12288
ds_read_b64_tr_b16 v[154:155], v5 offset:13056
v_mfma_f32_16x16x32_bf16 v[164:167], v[100:103], v[80:83], v[164:167]
ds_read_b64_tr_b16 v[156:157], v5 offset:15360
ds_read_b64_tr_b16 v[158:159], v5 offset:16128
v_mfma_f32_16x16x32_bf16 v[168:171], v[104:107], v[80:83], v[168:171]
ds_read_b32 v8, v50
v_mfma_f32_16x16x32_bf16 v[192:195], v[104:107], v[84:87], v[192:195]
s_waitcnt lgkmcnt(0)
v_readfirstlane_b32 s63, v8
s_nop 0
s_cmp_eq_u32 s63, 4
s_cbranch_scc1 L_ggo_72
s_mov_b32 s67, 0
L_lf_73:
ds_read_b32 v8, v50
s_add_u32 s67, s67, 1
s_waitcnt lgkmcnt(0)
v_readfirstlane_b32 s63, v8
s_nop 0
s_cmp_eq_u32 s63, 4
s_cbranch_scc1 L_ggo_72
s_sleep 1
s_cmp_lt_u32 s67, 2097152
s_cbranch_scc1 L_lf_73
L_ggo_72:
v_mfma_f32_16x16x32_bf16 v[216:219], v[104:107], v[88:91], v[216:219]
ds_read_b64 v[12:13], v51 offset:0
ds_read_b64 v[14:15], v51 offset:128
v_mfma_f32_16x16x32_bf16 v[240:243], v[104:107], v[92:95], v[240:243]
ds_read_b64 v[16:17], v51 offset:256
ds_read_b64 v[18:19], v51 offset:384
v_mfma_f32_16x16x32_bf16 v[244:247], v[108:111], v[92:95], v[244:247]
ds_read_b64 v[20:21], v52 offset:0
ds_read_b64 v[22:23], v52 offset:128
v_mfma_f32_16x16x32_bf16 v[220:223], v[108:111], v[88:91], v[220:223]
ds_read_b64 v[24:25], v49 offset:0
ds_read_b64 v[26:27], v49 offset:128
v_mfma_f32_16x16x32_bf16 v[196:199], v[108:111], v[84:87], v[196:199]
ds_read_b64 v[28:29], v49 offset:256
ds_read_b64 v[30:31], v49 offset:384
v_mfma_f32_16x16x32_bf16 v[172:175], v[108:111], v[80:83], v[172:175]
v_mfma_f32_16x16x32_bf16 v[176:179], v[112:115], v[80:83], v[176:179]
s_waitcnt lgkmcnt(0)
s_mov_b32 exec_lo, 0xffff0000
v_mov_b32 v12, 0
v_mov_b32 v13, 0
s_mov_b32 exec_lo, -1
v_mfma_f32_16x16x32_bf16 v[200:203], v[112:115], v[84:87], v[200:203]
s_mov_b32 exec_lo, 0xffff0000
v_mov_b32 v14, 0
v_mov_b32 v15, 0
s_mov_b32 exec_lo, -1
s_mov_b32 exec_lo, 0xffff0000
v_mov_b32 v16, 0
v_mov_b32 v17, 0
s_mov_b32 exec_lo, -1
v_mfma_f32_16x16x32_bf16 v[224:227], v[112:115], v[88:91], v[224:227]
s_mov_b32 exec_lo, 0xffff0000
v_mov_b32 v18, 0
v_mov_b32 v19, 0
s_mov_b32 exec_lo, -1
s_mov_b32 exec_lo, 0xffff0000
v_mov_b32 v20, 0
v_mov_b32 v21, 0
s_mov_b32 exec_lo, -1
v_mfma_f32_16x16x32_bf16 v[248:251], v[112:115], v[92:95], v[248:251]
s_mov_b32 exec_lo, 0xffff0000
v_mov_b32 v22, 0
v_mov_b32 v23, 0
s_mov_b32 exec_lo, -1
v_cvt_pk_bf16_f32 v32, -v24, -v24
v_mfma_f32_16x16x32_bf16 v[252:255], v[116:119], v[92:95], v[252:255]
v_cvt_pk_bf16_f32 v33, -v24, -v24
v_cvt_pk_bf16_f32 v34, -v26, -v26
v_mfma_f32_16x16x32_bf16 v[228:231], v[116:119], v[88:91], v[228:231]
v_cvt_pk_bf16_f32 v35, -v26, -v26
v_cvt_pk_bf16_f32 v36, -v28, -v28
v_mfma_f32_16x16x32_bf16 v[204:207], v[116:119], v[84:87], v[204:207]
v_cvt_pk_bf16_f32 v37, -v28, -v28
v_cvt_pk_bf16_f32 v38, -v30, -v30
v_mfma_f32_16x16x32_bf16 v[180:183], v[116:119], v[80:83], v[180:183]
v_cvt_pk_bf16_f32 v39, -v30, -v30
v_mov_b32 v48, 162312
v_mov_b32 v49, 1
s_waitcnt lgkmcnt(0)
s_mov_b64 exec, 1
ds_add_u32 v48, v49
s_mov_b64 exec, -1
v_mfma_f32_16x16x32_bf16 v[160:163], v[136:139], v[120:123], v[160:163]
v_rcp_f32 v40, v25
v_mul_f32 v44, v25, v25
v_mfma_f32_16x16x32_bf16 v[164:167], v[140:143], v[120:123], v[164:167]
v_mul_f32 v40, 0xbfb8aa3b, v40
v_rcp_f32 v41, v27
v_mfma_f32_16x16x32_bf16 v[168:171], v[144:147], v[120:123], v[168:171]
v_mul_f32 v45, v27, v27
v_mul_f32 v41, 0xbfb8aa3b, v41
v_mfma_f32_16x16x32_bf16 v[172:175], v[148:151], v[120:123], v[172:175]
v_rcp_f32 v42, v29
v_mul_f32 v46, v29, v29
v_mfma_f32_16x16x16_bf16 v[160:163], v[12:13], v[32:33], v[160:163]
v_mul_f32 v42, 0xbfb8aa3b, v42
v_rcp_f32 v43, v31
v_mfma_f32_16x16x16_bf16 v[164:167], v[14:15], v[32:33], v[164:167]
v_mul_f32 v47, v31, v31
v_mul_f32 v43, 0xbfb8aa3b, v43
v_mfma_f32_16x16x16_bf16 v[168:171], v[16:17], v[32:33], v[168:171]
v_mfma_f32_16x16x16_bf16 v[172:175], v[18:19], v[32:33], v[172:175]
v_mfma_f32_16x16x32_bf16 v[184:187], v[136:139], v[124:127], v[184:187]
v_mfma_f32_16x16x32_bf16 v[188:191], v[140:143], v[124:127], v[188:191]
v_mfma_f32_16x16x32_bf16 v[192:195], v[144:147], v[124:127], v[192:195]
v_mfma_f32_16x16x32_bf16 v[196:199], v[148:151], v[124:127], v[196:199]
v_mfma_f32_16x16x16_bf16 v[184:187], v[12:13], v[34:35], v[184:187]
v_mul_f32 v108, v160, v40
v_mul_f32 v109, v161, v40
v_mfma_f32_16x16x16_bf16 v[188:191], v[14:15], v[34:35], v[188:191]
v_mul_f32 v110, v162, v40
v_mul_f32 v111, v163, v40
v_mfma_f32_16x16x16_bf16 v[192:195], v[16:17], v[34:35], v[192:195]
v_mul_f32 v112, v168, v40
v_mul_f32 v113, v169, v40
v_mfma_f32_16x16x16_bf16 v[196:199], v[18:19], v[34:35], v[196:199]
v_mul_f32 v114, v170, v40
v_mul_f32 v115, v171, v40
v_mfma_f32_16x16x32_bf16 v[208:211], v[136:139], v[128:131], v[208:211]
v_exp_f32 v108, v108
v_mul_f32 v160, v160, v164
v_mfma_f32_16x16x32_bf16 v[212:215], v[140:143], v[128:131], v[212:215]
v_exp_f32 v109, v109
v_mul_f32 v161, v161, v165
v_mfma_f32_16x16x32_bf16 v[216:219], v[144:147], v[128:131], v[216:219]
v_exp_f32 v110, v110
v_mul_f32 v162, v162, v166
v_mfma_f32_16x16x32_bf16 v[220:223], v[148:151], v[128:131], v[220:223]
v_exp_f32 v111, v111
v_mul_f32 v163, v163, v167
v_mfma_f32_16x16x16_bf16 v[208:211], v[12:13], v[36:37], v[208:211]
v_exp_f32 v112, v112
v_mul_f32 v168, v168, v172
v_mfma_f32_16x16x16_bf16 v[212:215], v[14:15], v[36:37], v[212:215]
v_exp_f32 v113, v113
v_mul_f32 v169, v169, v173
v_mfma_f32_16x16x16_bf16 v[216:219], v[16:17], v[36:37], v[216:219]
v_exp_f32 v114, v114
v_mul_f32 v170, v170, v174
v_mfma_f32_16x16x16_bf16 v[220:223], v[18:19], v[36:37], v[220:223]
v_exp_f32 v115, v115
v_mul_f32 v171, v171, v175
v_mfma_f32_16x16x32_bf16 v[232:235], v[136:139], v[132:135], v[232:235]
v_fma_f32 v108, v108, v44, v44
v_fma_f32 v109, v109, v44, v44
v_mfma_f32_16x16x32_bf16 v[236:239], v[140:143], v[132:135], v[236:239]
v_fma_f32 v110, v110, v44, v44
v_fma_f32 v111, v111, v44, v44
v_mfma_f32_16x16x32_bf16 v[240:243], v[144:147], v[132:135], v[240:243]
v_fma_f32 v112, v112, v44, v44
v_fma_f32 v113, v113, v44, v44
v_mfma_f32_16x16x32_bf16 v[244:247], v[148:151], v[132:135], v[244:247]
v_fma_f32 v114, v114, v44, v44
v_fma_f32 v115, v115, v44, v44
v_mfma_f32_16x16x16_bf16 v[232:235], v[12:13], v[38:39], v[232:235]
v_rcp_f32 v108, v108
v_rcp_f32 v109, v109
v_mfma_f32_16x16x16_bf16 v[236:239], v[14:15], v[38:39], v[236:239]
v_rcp_f32 v110, v110
v_rcp_f32 v111, v111
v_mfma_f32_16x16x16_bf16 v[240:243], v[16:17], v[38:39], v[240:243]
v_rcp_f32 v112, v112
v_rcp_f32 v113, v113
v_mfma_f32_16x16x16_bf16 v[244:247], v[18:19], v[38:39], v[244:247]
v_rcp_f32 v114, v114
v_rcp_f32 v115, v115
v_mfma_f32_16x16x32_bf16 v[176:179], v[152:155], v[120:123], v[176:179]
v_mul_f32 v160, v160, v108
v_mul_f32 v161, v161, v109
v_mfma_f32_16x16x32_bf16 v[180:183], v[156:159], v[120:123], v[180:183]
v_mul_f32 v162, v162, v110
v_mul_f32 v163, v163, v111
v_mfma_f32_16x16x32_bf16 v[200:203], v[152:155], v[124:127], v[200:203]
v_mul_f32 v168, v168, v112
v_mul_f32 v169, v169, v113
v_mfma_f32_16x16x32_bf16 v[204:207], v[156:159], v[124:127], v[204:207]
v_mul_f32 v170, v170, v114
v_mul_f32 v171, v171, v115
v_mfma_f32_16x16x16_bf16 v[176:179], v[20:21], v[32:33], v[176:179]
v_cvt_pk_bf16_f32 v84, v160, v161
v_cvt_pk_bf16_f32 v86, v168, v169
v_mfma_f32_16x16x16_bf16 v[180:183], v[22:23], v[32:33], v[180:183]
v_cvt_pk_bf16_f32 v85, v162, v163
v_cvt_pk_bf16_f32 v87, v170, v171
v_mfma_f32_16x16x16_bf16 v[200:203], v[20:21], v[34:35], v[200:203]
v_permlane16_swap_b32 v84, v86
v_permlane16_swap_b32 v85, v87
v_mfma_f32_16x16x16_bf16 v[204:207], v[22:23], v[34:35], v[204:207]
buffer_store_dwordx4 v[84:87], v6, s[16:19], s88 offen offset:0 sc1
v_mul_f32 v108, v184, v41
v_mfma_f32_16x16x32_bf16 v[224:227], v[152:155], v[128:131], v[224:227]
v_mul_f32 v109, v185, v41
v_mul_f32 v110, v186, v41
v_mfma_f32_16x16x32_bf16 v[228:231], v[156:159], v[128:131], v[228:231]
v_mul_f32 v111, v187, v41
v_mul_f32 v112, v192, v41
v_mfma_f32_16x16x32_bf16 v[248:251], v[152:155], v[132:135], v[248:251]
v_mul_f32 v113, v193, v41
v_mul_f32 v114, v194, v41
v_mfma_f32_16x16x32_bf16 v[252:255], v[156:159], v[132:135], v[252:255]
v_mul_f32 v115, v195, v41
v_exp_f32 v108, v108
v_mfma_f32_16x16x16_bf16 v[224:227], v[20:21], v[36:37], v[224:227]
v_mul_f32 v184, v184, v188
v_exp_f32 v109, v109
v_mfma_f32_16x16x16_bf16 v[228:231], v[22:23], v[36:37], v[228:231]
v_mul_f32 v185, v185, v189
v_exp_f32 v110, v110
v_mfma_f32_16x16x16_bf16 v[248:251], v[20:21], v[38:39], v[248:251]
v_mul_f32 v186, v186, v190
v_exp_f32 v111, v111
v_mfma_f32_16x16x16_bf16 v[252:255], v[22:23], v[38:39], v[252:255]
v_mul_f32 v187, v187, v191
v_exp_f32 v112, v112
v_mul_f32 v192, v192, v196
v_exp_f32 v113, v113
v_mul_f32 v193, v193, v197
v_exp_f32 v114, v114
v_mul_f32 v194, v194, v198
v_exp_f32 v115, v115
v_mul_f32 v195, v195, v199
v_fma_f32 v108, v108, v45, v45
v_fma_f32 v109, v109, v45, v45
v_fma_f32 v110, v110, v45, v45
v_fma_f32 v111, v111, v45, v45
v_fma_f32 v112, v112, v45, v45
v_fma_f32 v113, v113, v45, v45
v_fma_f32 v114, v114, v45, v45
v_fma_f32 v115, v115, v45, v45
v_rcp_f32 v108, v108
v_rcp_f32 v109, v109
v_rcp_f32 v110, v110
v_rcp_f32 v111, v111
v_rcp_f32 v112, v112
v_rcp_f32 v113, v113
v_rcp_f32 v114, v114
v_rcp_f32 v115, v115
v_mul_f32 v184, v184, v108
v_mul_f32 v185, v185, v109
v_mul_f32 v186, v186, v110
v_mul_f32 v187, v187, v111
v_mul_f32 v192, v192, v112
v_mul_f32 v193, v193, v113
v_mul_f32 v194, v194, v114
v_mul_f32 v195, v195, v115
v_cvt_pk_bf16_f32 v88, v184, v185
v_cvt_pk_bf16_f32 v90, v192, v193
v_cvt_pk_bf16_f32 v89, v186, v187
v_cvt_pk_bf16_f32 v91, v194, v195
v_permlane16_swap_b32 v88, v90
s_nop 0
v_permlane16_swap_b32 v89, v91
buffer_store_dwordx4 v[88:91], v6, s[16:19], s88 offen offset:1024 sc1
v_mul_f32 v108, v208, v42
v_mul_f32 v109, v209, v42
v_mul_f32 v110, v210, v42
v_mul_f32 v111, v211, v42
v_mul_f32 v112, v216, v42
v_mul_f32 v113, v217, v42
v_mul_f32 v114, v218, v42
v_mul_f32 v115, v219, v42
v_exp_f32 v108, v108
v_mul_f32 v208, v208, v212
v_exp_f32 v109, v109
v_mul_f32 v209, v209, v213
v_exp_f32 v110, v110
v_mul_f32 v210, v210, v214
v_exp_f32 v111, v111
v_mul_f32 v211, v211, v215
v_exp_f32 v112, v112
v_mul_f32 v216, v216, v220
v_exp_f32 v113, v113
v_mul_f32 v217, v217, v221
v_exp_f32 v114, v114
v_mul_f32 v218, v218, v222
v_exp_f32 v115, v115
v_mul_f32 v219, v219, v223
v_fma_f32 v108, v108, v46, v46
v_fma_f32 v109, v109, v46, v46
v_fma_f32 v110, v110, v46, v46
v_fma_f32 v111, v111, v46, v46
v_fma_f32 v112, v112, v46, v46
v_fma_f32 v113, v113, v46, v46
v_fma_f32 v114, v114, v46, v46
v_fma_f32 v115, v115, v46, v46
v_rcp_f32 v108, v108
v_rcp_f32 v109, v109
v_rcp_f32 v110, v110
v_rcp_f32 v111, v111
v_rcp_f32 v112, v112
v_rcp_f32 v113, v113
v_rcp_f32 v114, v114
v_rcp_f32 v115, v115
v_mul_f32 v208, v208, v108
v_mul_f32 v209, v209, v109
v_mul_f32 v210, v210, v110
v_mul_f32 v211, v211, v111
v_mul_f32 v216, v216, v112
v_mul_f32 v217, v217, v113
v_mul_f32 v218, v218, v114
v_mul_f32 v219, v219, v115
v_cvt_pk_bf16_f32 v92, v208, v209
v_cvt_pk_bf16_f32 v94, v216, v217
v_cvt_pk_bf16_f32 v93, v210, v211
v_cvt_pk_bf16_f32 v95, v218, v219
v_permlane16_swap_b32 v92, v94
s_nop 0
v_permlane16_swap_b32 v93, v95
buffer_store_dwordx4 v[92:95], v6, s[16:19], s88 offen offset:2048 sc1
v_mul_f32 v108, v232, v43
v_mul_f32 v109, v233, v43
v_mul_f32 v110, v234, v43
v_mul_f32 v111, v235, v43
v_mul_f32 v112, v240, v43
v_mul_f32 v113, v241, v43
v_mul_f32 v114, v242, v43
v_mul_f32 v115, v243, v43
v_exp_f32 v108, v108
v_mul_f32 v232, v232, v236
v_exp_f32 v109, v109
v_mul_f32 v233, v233, v237
v_exp_f32 v110, v110
v_mul_f32 v234, v234, v238
v_exp_f32 v111, v111
v_mul_f32 v235, v235, v239
v_exp_f32 v112, v112
v_mul_f32 v240, v240, v244
v_exp_f32 v113, v113
v_mul_f32 v241, v241, v245
v_exp_f32 v114, v114
v_mul_f32 v242, v242, v246
v_exp_f32 v115, v115
v_mul_f32 v243, v243, v247
v_fma_f32 v108, v108, v47, v47
v_fma_f32 v109, v109, v47, v47
v_fma_f32 v110, v110, v47, v47
v_fma_f32 v111, v111, v47, v47
v_fma_f32 v112, v112, v47, v47
v_fma_f32 v113, v113, v47, v47
v_fma_f32 v114, v114, v47, v47
v_fma_f32 v115, v115, v47, v47
v_rcp_f32 v108, v108
v_rcp_f32 v109, v109
v_rcp_f32 v110, v110
v_rcp_f32 v111, v111
v_rcp_f32 v112, v112
v_rcp_f32 v113, v113
v_rcp_f32 v114, v114
v_rcp_f32 v115, v115
v_mul_f32 v232, v232, v108
v_mul_f32 v233, v233, v109
v_mul_f32 v234, v234, v110
v_mul_f32 v235, v235, v111
v_mul_f32 v240, v240, v112
v_mul_f32 v241, v241, v113
v_mul_f32 v242, v242, v114
v_mul_f32 v243, v243, v115
v_cvt_pk_bf16_f32 v96, v232, v233
v_cvt_pk_bf16_f32 v98, v240, v241
v_cvt_pk_bf16_f32 v97, v234, v235
v_cvt_pk_bf16_f32 v99, v242, v243
v_permlane16_swap_b32 v96, v98
s_nop 0
v_permlane16_swap_b32 v97, v99
buffer_store_dwordx4 v[96:99], v6, s[16:19], s88 offen offset:3072 sc1
v_mul_f32 v108, v176, v40
v_mul_f32 v109, v177, v40
v_mul_f32 v110, v178, v40
v_mul_f32 v111, v179, v40
v_mul_f32 v112, v200, v41
v_mul_f32 v113, v201, v41
v_mul_f32 v114, v202, v41
v_mul_f32 v115, v203, v41
v_exp_f32 v108, v108
v_mul_f32 v176, v176, v180
v_exp_f32 v109, v109
v_mul_f32 v177, v177, v181
v_exp_f32 v110, v110
v_mul_f32 v178, v178, v182
v_exp_f32 v111, v111
v_mul_f32 v179, v179, v183
v_exp_f32 v112, v112
v_mul_f32 v200, v200, v204
v_exp_f32 v113, v113
v_mul_f32 v201, v201, v205
v_exp_f32 v114, v114
v_mul_f32 v202, v202, v206
v_exp_f32 v115, v115
v_mul_f32 v203, v203, v207
v_fma_f32 v108, v108, v44, v44
v_fma_f32 v109, v109, v44, v44
v_fma_f32 v110, v110, v44, v44
v_fma_f32 v111, v111, v44, v44
v_fma_f32 v112, v112, v45, v45
v_fma_f32 v113, v113, v45, v45
v_fma_f32 v114, v114, v45, v45
v_fma_f32 v115, v115, v45, v45
v_rcp_f32 v108, v108
v_rcp_f32 v109, v109
v_rcp_f32 v110, v110
v_rcp_f32 v111, v111
v_rcp_f32 v112, v112
v_rcp_f32 v113, v113
v_rcp_f32 v114, v114
v_rcp_f32 v115, v115
v_mul_f32 v176, v176, v108
v_mul_f32 v177, v177, v109
v_mul_f32 v178, v178, v110
v_mul_f32 v179, v179, v111
v_mul_f32 v200, v200, v112
v_mul_f32 v201, v201, v113
v_mul_f32 v202, v202, v114
v_mul_f32 v203, v203, v115
v_cvt_pk_bf16_f32 v100, v176, v177
v_cvt_pk_bf16_f32 v102, v200, v201
v_cvt_pk_bf16_f32 v101, v178, v179
v_cvt_pk_bf16_f32 v103, v202, v203
v_permlane16_swap_b32 v100, v102
s_nop 0
v_permlane16_swap_b32 v101, v103
buffer_store_dwordx4 v[100:103], v7, s[16:19], s89 offen offset:0 sc1
v_mul_f32 v108, v224, v42
v_mul_f32 v109, v225, v42
v_mul_f32 v110, v226, v42
v_mul_f32 v111, v227, v42
v_mul_f32 v112, v248, v43
v_mul_f32 v113, v249, v43
v_mul_f32 v114, v250, v43
v_mul_f32 v115, v251, v43
v_exp_f32 v108, v108
v_mul_f32 v224, v224, v228
v_exp_f32 v109, v109
v_mul_f32 v225, v225, v229
v_exp_f32 v110, v110
v_mul_f32 v226, v226, v230
v_exp_f32 v111, v111
v_mul_f32 v227, v227, v231
v_exp_f32 v112, v112
v_mul_f32 v248, v248, v252
v_exp_f32 v113, v113
v_mul_f32 v249, v249, v253
v_exp_f32 v114, v114
v_mul_f32 v250, v250, v254
v_exp_f32 v115, v115
v_mul_f32 v251, v251, v255
v_fma_f32 v108, v108, v46, v46
v_fma_f32 v109, v109, v46, v46
v_fma_f32 v110, v110, v46, v46
v_fma_f32 v111, v111, v46, v46
v_fma_f32 v112, v112, v47, v47
v_fma_f32 v113, v113, v47, v47
v_fma_f32 v114, v114, v47, v47
v_fma_f32 v115, v115, v47, v47
v_rcp_f32 v108, v108
v_rcp_f32 v109, v109
v_rcp_f32 v110, v110
v_rcp_f32 v111, v111
v_rcp_f32 v112, v112
v_rcp_f32 v113, v113
v_rcp_f32 v114, v114
v_rcp_f32 v115, v115
v_mul_f32 v224, v224, v108
v_mul_f32 v225, v225, v109
v_mul_f32 v226, v226, v110
v_mul_f32 v227, v227, v111
v_mul_f32 v248, v248, v112
v_mul_f32 v249, v249, v113
v_mul_f32 v250, v250, v114
v_mul_f32 v251, v251, v115
v_cvt_pk_bf16_f32 v104, v224, v225
v_cvt_pk_bf16_f32 v106, v248, v249
v_cvt_pk_bf16_f32 v105, v226, v227
v_cvt_pk_bf16_f32 v107, v250, v251
v_permlane16_swap_b32 v104, v106
s_nop 0
v_permlane16_swap_b32 v105, v107
buffer_store_dwordx4 v[104:107], v7, s[16:19], s89 offen offset:2048 sc1
s_branch L_down
L_end:
s_endpgm
.section .rodata,"a"
.p2align 6
.amdhsa_kernel parallel_sum__ssm_conv_h3__swiglu_ffn__prompt_kernel
  .amdhsa_next_free_vgpr 256
  .amdhsa_next_free_sgpr 102
  .amdhsa_accum_offset 256
  .amdhsa_group_segment_fixed_size 0
  .amdhsa_kernarg_size 104
  .amdhsa_user_sgpr_count 2
  .amdhsa_user_sgpr_kernarg_segment_ptr 1
  .amdhsa_system_sgpr_workgroup_id_x 1
  .amdhsa_float_denorm_mode_32 3
.end_amdhsa_kernel
```
